```python
import torch

def _softmax(x, axis=-1):
    return torch.softmax(x, dim=axis)
def _gelu(x):
    return torch.nn.functional.gelu(x, approximate="tanh")
def _silu(x):
    return torch.nn.functional.silu(x)
def _sigmoid(x):
    return torch.sigmoid(x)
def _layernorm(x, axis=-1, eps=1e-5):
    m = x.mean(dim=axis, keepdim=True)
    v = x.var(dim=axis, keepdim=True, unbiased=False)
    return (x - m) / torch.sqrt(v + eps)
def _scatter_add(tgt, idx, src, axis=0):
    return tgt.clone().index_add_(axis, idx, src)
def _segment_sum(src, seg, n):
    out = torch.zeros((n,) + src.shape[1:], dtype=src.dtype)
    return out.index_add_(0, seg, src)
def _pad(x, pw):
    flat = tuple(v for pair in reversed(pw) for v in pair)
    return torch.nn.functional.pad(x, flat)

kernel_name = 'sequential_preLN__softmax_full_mha__dense_activation_relu__prompt'

def setup_inputs():

    _w = (lambda a: (lambda t: t.to(torch.bfloat16) if t.is_floating_point() else t)(torch.as_tensor(a)))
    def _A_setup():
        B, S, D = 1, 2048, 448
        return {
            "x": _w((lambda *s: torch.randn(*s, dtype=torch.bfloat16) * 0.05)(B, S, D)),
            "wqkv": _w((lambda *s: torch.randn(*s, dtype=torch.bfloat16) * 0.05)(D, 3 * D)),
            "wo": _w((lambda *s: torch.randn(*s, dtype=torch.bfloat16) * 0.05)(D, D)),
        }
    _A_in = _A_setup()

    def _B_setup():
        B, S, D, Dff = 1, 2048, 448, 1792
        return {
            "x": _w((lambda *s: torch.randn(*s, dtype=torch.bfloat16) * 0.05)(B, S, D)),
            "w1": _w((lambda *s: torch.randn(*s, dtype=torch.bfloat16) * 0.05)(D, Dff)),
            "w2": _w((lambda *s: torch.randn(*s, dtype=torch.bfloat16) * 0.05)(Dff, D)),
        }
    _B_in = _B_setup()

    return {
        "A_x": _A_in["x"],
        "A_wqkv": _A_in["wqkv"],
        "A_wo": _A_in["wo"],
        "B_x": _B_in["x"],
        "B_w1": _B_in["w1"],
        "B_w2": _B_in["w2"],
    }

def reference(A_x, A_wqkv, A_wo, B_x, B_w1, B_w2):
    def _A_ref(x, wqkv, wo):
        B, S, D = x.shape
        H = 16; Dh = D // H
        qkv = (lambda x, *d: x.permute(*d))((x @ wqkv).reshape(B, S, 3, H, Dh), 2, 0, 3, 1, 4)
        q, k, v = qkv[0], qkv[1], qkv[2]
        scale = Dh ** -0.5
        scores = torch.einsum("bhqd,bhkd->bhqk", q, k) * scale
        p = _softmax(scores, axis=-1)
        o = torch.einsum("bhqk,bhkd->bhqd", p, v)
        return (lambda x, *d: x.permute(*d))(o, 0, 2, 1, 3).reshape(B, S, D) @ wo

    def _B_ref(x, w1, w2):
        h = torch.einsum("bsd,df->bsf", x, w1)
        zero = torch.zeros_like(h)
        h = torch.maximum(h, zero)
        return torch.einsum("bsf,fd->bsd", h, w2)

    x = A_x
    h = x + _A_ref(_layernorm(x, axis=-1), A_wqkv, A_wo)
    h2 = h + _B_ref(_layernorm(h, axis=-1), B_w1, B_w2)
    return h2
```

```asm
; @launch kernel=kp_kernel grid=(256,1,1) block=(256,1,1) lds=163840
.amdgcn_target "amdgcn-amd-amdhsa--gfx950"
.text
.globl kp_kernel
.p2align 12
.p2align 8
.type kp_kernel,@function
kp_kernel:
  s_cmp_ge_u32 s2, 256
  s_cbranch_scc1 P_END
  s_load_dwordx16 s[16:31], s[0:1], 0
  s_load_dwordx2 s[32:33], s[0:1], 64
  v_and_b32 v1, 63, v0
  v_lshrrev_b32 v2, 6, v0
  s_nop 0
  v_readfirstlane_b32 s4, v2
  s_and_b32 s5, s2, 7
  s_lshr_b32 s6, s2, 3
  s_lshr_b32 s3, s5, 1
  s_lshl_b32 s3, s3, 2
  s_and_b32 s10, s6, 3
  s_add_u32 s3, s3, s10
  s_and_b32 s70, s5, 1
  s_lshl_b32 s7, s70, 3
  s_lshr_b32 s13, s6, 2
  s_add_u32 s7, s7, s13
  s_lshl_b32 s10, s10, 1
  s_add_u32 s34, s10, s13
  s_mul_i32 s10, s34, 37
  s_lshr_b32 s10, s10, 8
  s_mul_i32 s10, s10, 7
  s_sub_u32 s34, s34, s10
  s_sub_u32 s10, 4, s70
  s_cmp_gt_u32 s13, s10
  s_subb_u32 s66, s13, 0
  s_cmp_eq_u32 s13, s10
  s_cselect_b32 s67, 1073741824, 0
  s_cselect_b32 s66, 7, s66
  s_mul_i32 s64, s70, 7
  s_add_u32 s64, s64, s66
  s_add_u32 s64, s64, 7
  s_lshl_b32 s64, s64, 7
  s_add_u32 s64, s64, s67
  s_cmp_ge_u32 s4, 2
  s_cbranch_scc1 F_H
F_LD:
  s_mul_i32 s13, s4, 2
  s_lshl_b32 s8, s3, 2
  s_add_u32 s8, s8, s13
  s_mul_i32 s8, s8, 28672
  s_add_u32 s72, s8, 896
  s_lshl_b32 s10, s34, 7
  s_add_u32 s8, s8, s10
  s_mul_i32 s11, s13, 43008
  s_add_u32 s73, s11, 1204224
  s_mul_i32 s10, s34, 172032
  s_add_u32 s11, s11, s10
  s_mul_i32 s9, s13, 20480
  s_lshl_b32 s12, s13, 11
  s_add_u32 s12, s12, 81920
  v_lshrrev_b32 v12, 3, v1
  v_mul_u32_u24 v14, 896, v12
  v_bfe_u32 v3, v1, 4, 2
  v_and_b32 v13, 7, v1
  v_xor_b32 v3, v3, v13
  v_lshlrev_b32 v3, 4, v3
  v_add_u32 v128, v14, v3
  v_xor_b32 v129, 64, v128
  v_mul_u32_u24 v12, 2688, v12
  v_lshlrev_b32 v13, 4, v13
  v_and_b32 v3, 16, v1
  v_lshlrev_b32 v3, 2, v3
  v_xor_b32 v13, v13, v3
  v_add3_u32 v130, v12, v13, s64
  v_add_u32 v131, 21504, v130
  s_waitcnt lgkmcnt(0)
  s_mov_b32 s40, s16
  s_mov_b32 s41, s17
  s_mov_b32 s42, 1835008
  s_mov_b32 s43, 0x20000
  s_mov_b32 s44, s18
  s_mov_b32 s45, s19
  s_mov_b32 s46, 1204224
  s_mov_b32 s47, 0x20000
  s_add_u32 m0, s9, 0
  s_add_u32 s10, s8, 0
  buffer_load_dwordx4 v128, s[40:43], s10 offen lds
  s_add_u32 m0, s9, 1024
  s_add_u32 s10, s8, 7168
  buffer_load_dwordx4 v128, s[40:43], s10 offen lds
  s_add_u32 m0, s9, 2048
  s_add_u32 s10, s8, 14336
  buffer_load_dwordx4 v129, s[40:43], s10 offen lds
  s_add_u32 m0, s9, 3072
  s_add_u32 s10, s8, 21504
  buffer_load_dwordx4 v129, s[40:43], s10 offen lds
  s_add_u32 m0, s9, 20480
  s_add_u32 s10, s8, 28672
  buffer_load_dwordx4 v128, s[40:43], s10 offen lds
  s_add_u32 m0, s9, 21504
  s_add_u32 s10, s8, 35840
  buffer_load_dwordx4 v128, s[40:43], s10 offen lds
  s_add_u32 m0, s9, 22528
  s_add_u32 s10, s8, 43008
  buffer_load_dwordx4 v129, s[40:43], s10 offen lds
  s_add_u32 m0, s9, 23552
  s_add_u32 s10, s8, 50176
  buffer_load_dwordx4 v129, s[40:43], s10 offen lds
  s_add_u32 s8, s8, 128
  s_cmp_eq_u32 s8, s72
  s_cselect_b32 s10, 896, 0
  s_sub_u32 s8, s8, s10
  s_add_u32 m0, s12, 0
  s_nop 0
  buffer_load_dwordx4 v130, s[44:47], s11 offen lds
  s_add_u32 m0, s12, 1024
  s_nop 0
  buffer_load_dwordx4 v131, s[44:47], s11 offen lds
  s_add_u32 m0, s12, 2048
  s_add_u32 s10, s11, 43008
  buffer_load_dwordx4 v130, s[44:47], s10 offen lds
  s_add_u32 m0, s12, 3072
  s_add_u32 s10, s11, 43008
  buffer_load_dwordx4 v131, s[44:47], s10 offen lds
  s_add_u32 s11, s11, 172032
  s_cmp_eq_u32 s11, s73
  s_cselect_b32 s10, 1204224, 0
  s_sub_u32 s11, s11, s10
  s_branch F_SET
F_H:
  s_getpc_b64 s[10:11]
F_PC:
  s_lshl_b32 s13, s6, 1
  s_add_u32 s13, s13, s4
  s_mul_i32 s8, s13, 9363
  s_lshr_b32 s8, s8, 16
  s_mul_i32 s8, s8, 7
  s_sub_u32 s13, s13, s8
  s_lshl_b32 s13, s13, 13
  v_lshlrev_b32 v12, 7, v1
  v_add_u32 v12, s13, v12
  v_min_u32 v12, P_END-F_PC, v12
  v_mov_b32 v13, s11
  v_add_co_u32 v12, vcc, s10, v12
  s_nop 1
  v_addc_co_u32 v13, vcc, 0, v13, vcc
  global_load_dword v255, v[12:13], off
  s_mov_b64 exec, 0
  s_cmp_eq_u32 s4, 2
  s_cbranch_scc1 W1
  s_branch W2
F_H1:
  s_mov_b64 exec, -1
  v_lshrrev_b32 v12, 3, v1
  v_mul_u32_u24 v14, 896, v12
  v_bfe_u32 v3, v1, 4, 2
  v_and_b32 v13, 7, v1
  v_xor_b32 v3, v3, v13
  v_lshlrev_b32 v3, 4, v3
  v_add_u32 v128, v14, v3
  v_xor_b32 v129, 64, v128
  v_mul_u32_u24 v12, 2688, v12
  v_lshlrev_b32 v13, 4, v13
  v_and_b32 v3, 16, v1
  v_lshlrev_b32 v3, 2, v3
  v_xor_b32 v13, v13, v3
  v_add3_u32 v130, v12, v13, s64
  v_add_u32 v131, 21504, v130
  s_waitcnt lgkmcnt(0)
  s_mov_b32 s40, s16
  s_mov_b32 s41, s17
  s_mov_b32 s42, 1835008
  s_mov_b32 s43, 0x20000
  s_mov_b32 s44, s18
  s_mov_b32 s45, s19
  s_mov_b32 s46, 1204224
  s_mov_b32 s47, 0x20000
  s_cmp_ge_u32 s2, 16
  s_cbranch_scc1 F_SET
  s_cmp_lg_u32 s4, 3
  s_cbranch_scc1 F_SET
  s_waitcnt lgkmcnt(0)
  s_mov_b32 s36, s32
  s_mov_b32 s37, s33
  s_mov_b32 s38, 0x10000000
  s_mov_b32 s39, 0x20000
  v_lshlrev_b32 v2, 4, v1
  s_lshl_b32 s10, s2, 12
  s_add_u32 s10, s10, 15728640
  v_mov_b32 v236, -1
  v_mov_b32 v237, -1
  v_mov_b32 v238, -1
  v_mov_b32 v239, -1
  buffer_store_dwordx4 v[236:239], v2, s[36:39], s10 offen offset:0 sc1
  buffer_store_dwordx4 v[236:239], v2, s[36:39], s10 offen offset:1024 sc1
  buffer_store_dwordx4 v[236:239], v2, s[36:39], s10 offen offset:2048 sc1
W1:
  s_cbranch_execz W3
  buffer_store_dwordx4 v[236:239], v2, s[36:39], s10 offen offset:3072 sc1
  v_lshlrev_b32 v12, 7, v1
  s_lshl_b32 s10, s2, 14
  s_add_u32 s10, s10, 15794176
  s_add_u32 s13, s10, 8192
  s_mov_b32 exec_hi, 3
  buffer_store_dword v236, v12, s[36:39], s10 offen sc1
  buffer_store_dword v236, v12, s[36:39], s13 offen sc1
  s_mov_b32 exec_hi, -1
F_SET:
  s_waitcnt lgkmcnt(0)
  s_mov_b32 s36, s32
  s_mov_b32 s37, s33
  s_mov_b32 s38, 0x10000000
  s_mov_b32 s39, 0x20000
  v_lshlrev_b32 v2, 4, v1
  v_mov_b32 v192, 1065369472
  v_mov_b32 v193, 1065369472
  v_mov_b32 v136, 0
  v_mov_b32 v137, 0
  v_mov_b32 v138, 0
  v_mov_b32 v139, 0
  v_mov_b32 v140, 0
  v_mov_b32 v141, 0
  v_mov_b32 v142, 0
  v_mov_b32 v143, 0
  v_mov_b32 v144, 0
  v_mov_b32 v145, 0
  v_mov_b32 v146, 0
  v_mov_b32 v147, 0
  v_mov_b32 v4, 0
  v_mov_b32 v5, 0
  v_mov_b32 v6, 0
  v_mov_b32 v7, 0
  v_mov_b32 v8, 0
  v_mov_b32 v9, 0
  v_mov_b32 v10, 0
  v_mov_b32 v11, 0
  v_mov_b32 v236, -1
  v_mov_b32 v237, -1
  v_mov_b32 v238, -1
  v_mov_b32 v239, -1
  v_lshrrev_b32 v12, 5, v1
  v_lshlrev_b32 v12, 3, v12
  v_bfe_u32 v3, v1, 2, 2
  v_add_u32 v12, v12, v3
  v_and_b32 v3, 16, v1
  v_lshlrev_b32 v3, 1, v3
  v_and_b32 v13, 1, v1
  v_lshlrev_b32 v13, 4, v13
  v_and_b32 v14, 2, v1
  v_lshlrev_b32 v14, 2, v14
  v_or3_b32 v13, v13, v14, v3
  v_and_b32 v14, 3, v1
  v_lshlrev_b32 v14, 3, v14
  v_or_b32 v14, v14, v3
  s_cmp_lg_u32 s70, 0
  s_cselect_b64 s[74:75], -1, 0
  v_and_b32 v3, 8, v1
  v_lshlrev_b32 v3, 3, v3
  v_cndmask_b32 v14, v13, v14, s[74:75]
  v_lshl_add_u32 v13, v12, 6, v13
  v_lshl_add_u32 v14, v12, 7, v14
  v_add_u32 v14, v14, v3
  s_xor_b32 s10, s4, 0
  s_lshl_b32 s13, s10, 11
  s_add_u32 s13, s13, 81920
  v_add_u32 v212, s13, v14
  v_xor_b32 v216, 64, v212
  s_lshl_b32 s13, s10, 10
  s_add_u32 s13, s13, 122880
  v_add_u32 v220, s13, v13
  s_xor_b32 s10, s4, 1
  s_lshl_b32 s13, s10, 11
  s_add_u32 s13, s13, 81920
  v_add_u32 v213, s13, v14
  v_xor_b32 v217, 64, v213
  s_lshl_b32 s13, s10, 10
  s_add_u32 s13, s13, 122880
  v_add_u32 v221, s13, v13
  s_xor_b32 s10, s4, 2
  s_lshl_b32 s13, s10, 11
  s_add_u32 s13, s13, 81920
  v_add_u32 v214, s13, v14
  v_xor_b32 v218, 64, v214
  s_lshl_b32 s13, s10, 10
  s_add_u32 s13, s13, 122880
  v_add_u32 v222, s13, v13
  s_xor_b32 s10, s4, 3
  s_lshl_b32 s13, s10, 11
  s_add_u32 s13, s13, 81920
  v_add_u32 v215, s13, v14
  v_xor_b32 v219, 64, v215
  s_lshl_b32 s13, s10, 10
  s_add_u32 s13, s13, 122880
  v_add_u32 v223, s13, v13
  v_and_b32 v12, 31, v1
  v_bfe_u32 v3, v1, 1, 2
  v_bfe_u32 v13, v1, 4, 1
  v_lshlrev_b32 v13, 2, v13
  v_or_b32 v3, v3, v13
  v_lshrrev_b32 v13, 5, v1
  v_xor_b32 v3, v3, v13
  v_lshlrev_b32 v3, 4, v3
  v_lshlrev_b32 v12, 7, v12
  v_add_u32 v12, v12, v3
  s_mul_i32 s13, s4, 20480
  s_xor_b32 s10, s4, 0
  s_lshl_b32 s10, s10, 5
  v_xor_b32 v3, s10, v12
  v_add_u32 v208, s13, v3
  s_xor_b32 s10, s4, 1
  s_lshl_b32 s10, s10, 5
  v_xor_b32 v3, s10, v12
  v_add_u32 v209, s13, v3
  s_xor_b32 s10, s4, 2
  s_lshl_b32 s10, s10, 5
  v_xor_b32 v3, s10, v12
  v_add_u32 v210, s13, v3
  s_xor_b32 s10, s4, 3
  s_lshl_b32 s10, s10, 5
  v_xor_b32 v3, s10, v12
  v_add_u32 v211, s13, v3
  v_add_u32 v133, 151552, v2
  s_min_u32 s10, s4, 2
  s_lshl_b32 s10, s10, 10
  v_add_u32 v13, s10, v133
  ds_write_b128 v13, v[236:239]
  s_cmp_ge_u32 s4, 2
  s_cbranch_scc1 F_T
F_L2:
  s_add_u32 m0, s9, 4096
  s_add_u32 s10, s8, 0
  buffer_load_dwordx4 v128, s[40:43], s10 offen lds
  s_add_u32 m0, s9, 5120
  s_add_u32 s10, s8, 7168
  buffer_load_dwordx4 v128, s[40:43], s10 offen lds
  s_add_u32 m0, s9, 6144
  s_add_u32 s10, s8, 14336
  buffer_load_dwordx4 v129, s[40:43], s10 offen lds
  s_add_u32 m0, s9, 7168
  s_add_u32 s10, s8, 21504
  buffer_load_dwordx4 v129, s[40:43], s10 offen lds
  s_add_u32 m0, s9, 24576
  s_add_u32 s10, s8, 28672
  buffer_load_dwordx4 v128, s[40:43], s10 offen lds
  s_add_u32 m0, s9, 25600
  s_add_u32 s10, s8, 35840
  buffer_load_dwordx4 v128, s[40:43], s10 offen lds
  s_add_u32 m0, s9, 26624
  s_add_u32 s10, s8, 43008
  buffer_load_dwordx4 v129, s[40:43], s10 offen lds
  s_add_u32 m0, s9, 27648
  s_add_u32 s10, s8, 50176
  buffer_load_dwordx4 v129, s[40:43], s10 offen lds
  s_add_u32 s8, s8, 128
  s_cmp_eq_u32 s8, s72
  s_cselect_b32 s10, 896, 0
  s_sub_u32 s8, s8, s10
  s_add_u32 m0, s12, 8192
  s_nop 0
  buffer_load_dwordx4 v130, s[44:47], s11 offen lds
  s_add_u32 m0, s12, 9216
  s_nop 0
  buffer_load_dwordx4 v131, s[44:47], s11 offen lds
  s_add_u32 m0, s12, 10240
  s_add_u32 s10, s11, 43008
  buffer_load_dwordx4 v130, s[44:47], s10 offen lds
  s_add_u32 m0, s12, 11264
  s_add_u32 s10, s11, 43008
  buffer_load_dwordx4 v131, s[44:47], s10 offen lds
  s_add_u32 s11, s11, 172032
  s_cmp_eq_u32 s11, s73
  s_cselect_b32 s10, 1204224, 0
  s_sub_u32 s11, s11, s10
  s_add_u32 m0, s9, 8192
  s_add_u32 s10, s8, 0
  buffer_load_dwordx4 v128, s[40:43], s10 offen lds
  s_add_u32 m0, s9, 9216
  s_add_u32 s10, s8, 7168
  buffer_load_dwordx4 v128, s[40:43], s10 offen lds
  s_add_u32 m0, s9, 10240
  s_add_u32 s10, s8, 14336
  buffer_load_dwordx4 v129, s[40:43], s10 offen lds
  s_add_u32 m0, s9, 11264
W2:
  s_cbranch_execz F_H1
  s_add_u32 s10, s8, 21504
  buffer_load_dwordx4 v129, s[40:43], s10 offen lds
  s_add_u32 m0, s9, 28672
  s_add_u32 s10, s8, 28672
  buffer_load_dwordx4 v128, s[40:43], s10 offen lds
  s_add_u32 m0, s9, 29696
  s_add_u32 s10, s8, 35840
  buffer_load_dwordx4 v128, s[40:43], s10 offen lds
  s_add_u32 m0, s9, 30720
  s_add_u32 s10, s8, 43008
  buffer_load_dwordx4 v129, s[40:43], s10 offen lds
  s_add_u32 m0, s9, 31744
  s_add_u32 s10, s8, 50176
  buffer_load_dwordx4 v129, s[40:43], s10 offen lds
  s_add_u32 s8, s8, 128
  s_cmp_eq_u32 s8, s72
  s_cselect_b32 s10, 896, 0
  s_sub_u32 s8, s8, s10
  s_add_u32 m0, s12, 16384
  s_nop 0
  buffer_load_dwordx4 v130, s[44:47], s11 offen lds
  s_add_u32 m0, s12, 17408
  s_nop 0
  buffer_load_dwordx4 v131, s[44:47], s11 offen lds
  s_add_u32 m0, s12, 18432
  s_add_u32 s10, s11, 43008
  buffer_load_dwordx4 v130, s[44:47], s10 offen lds
  s_add_u32 m0, s12, 19456
  s_add_u32 s10, s11, 43008
  buffer_load_dwordx4 v131, s[44:47], s10 offen lds
  s_add_u32 s11, s11, 172032
  s_cmp_eq_u32 s11, s73
  s_cselect_b32 s10, 1204224, 0
  s_sub_u32 s11, s11, s10
F_T:
  s_and_b32 s61, s2, 0xf0
  s_and_b32 s10, s2, 7
  s_lshl_b32 s10, s10, 1
  s_add_u32 s61, s61, s10
  s_bfe_u32 s10, s2, 0x10003
  s_add_u32 s61, s61, s10
  s_mov_b32 s52, 256
  s_mov_b32 s53, 512
  s_mov_b64 s[56:57], 0
  s_mov_b32 s71, 16
  s_mov_b32 s59, 16
  s_cmp_ge_u32 s61, 112
  s_cbranch_scc1 K1_J1
  s_mov_b32 s48, s24
  s_mov_b32 s49, s25
  s_mov_b32 s50, 1605632
  s_mov_b32 s51, 0x20000
  s_bfe_u32 s55, s61, 0x10001
  s_and_b32 s10, s61, 1
  s_lshr_b32 s54, s61, 2
  s_lshl_b32 s54, s54, 1
  s_add_u32 s54, s54, s10
  s_mov_b32 s5, 3584
  s_lshl_b32 s6, s54, 6
  s_sub_u32 s65, 4, s55
  s_lshl_b32 s60, s55, 4
  s_mul_i32 s62, s4, s65
  s_lshl_b32 s10, s55, 4
  s_add_u32 s62, s62, s10
  s_mul_i32 s58, s54, 29696
  s_add_u32 s58, s58, 10485760
  s_lshl_b32 s64, s62, 10
  s_add_u32 s64, s64, s58
  s_lshr_b32 s10, s54, 1
  s_lshl_b32 s10, s10, 6
  s_and_b32 s13, s54, 1
  s_lshl_b32 s13, s13, 3
  s_add_u32 s10, s10, s13
  s_lshl_b32 s55, s55, 2
  s_add_u32 s55, s55, s10
  s_add_u32 s55, s55, s4
  s_branch K1_JC
K1_J1:
  s_cmp_ge_u32 s61, 210
  s_cbranch_scc1 K1_J2
  s_mov_b32 s48, s26
  s_mov_b32 s49, s27
  s_mov_b32 s50, 1605632
  s_mov_b32 s51, 0x20000
  s_sub_u32 s54, s61, 112
  s_mul_i32 s55, s54, 4682
  s_lshr_b32 s55, s55, 16
  s_mul_i32 s10, s55, 14
  s_sub_u32 s10, s54, s10
  s_lshl_b32 s13, s55, 1
  s_sub_u32 s13, s10, s13
  s_add_u32 s71, s13, 12
  s_sub_u32 s14, s10, 2
  s_cmp_lt_i32 s13, 0
  s_cselect_b32 s14, s10, s14
  s_cmp_lt_u32 s13, 2
  s_cselect_b32 s14, s71, s14
  s_sub_u32 s54, s54, s10
  s_add_u32 s54, s54, s14
  s_mov_b32 s5, 896
  s_lshl_b32 s6, s10, 6
  s_mov_b32 s65, 4
  s_lshl_b32 s60, s55, 4
  s_lshl_b32 s10, s4, 2
  s_add_u32 s62, s60, s10
  s_lshl_b32 s64, s54, 14
  s_lshl_b32 s10, s4, 12
  s_add_u32 s64, s64, s10
  s_add_u32 s64, s64, 12582912
  s_mov_b32 s52, 512
  s_mov_b32 s53, 256
  s_mov_b32 s71, 16
  s_lshl_b32 s55, s55, 8
  s_mul_i32 s10, s14, 11
  s_lshr_b32 s10, s10, 5
  s_mul_i32 s10, s10, 52
  s_lshl_b32 s13, s14, 2
  s_add_u32 s10, s10, s13
  s_add_u32 s10, s10, s4
  s_add_u32 s10, s10, 20
  s_and_b32 s13, s4, 2
  s_add_u32 s13, s13, s14
  s_lshl_b32 s13, s13, 6
  s_and_b32 s58, s4, 1
  s_add_u32 s13, s13, s58
  s_sub_u32 s13, s13, 736
  s_cmp_lt_u32 s14, 12
  s_cselect_b32 s10, s10, s13
  s_add_u32 s55, s55, s10
  s_branch K1_JC
K1_J2:
  s_mov_b32 s48, s20
  s_mov_b32 s49, s21
  s_mov_b32 s50, 401408
  s_mov_b32 s51, 0x20000
  s_sub_u32 s54, s61, 210
  s_cmp_ge_u32 s61, 238
  s_cselect_b32 s71, 0, s54
  s_cselect_b32 s69, 0, -1
  s_bfe_u32 s55, s71, 0x10001
  s_and_b32 s10, s71, 1
  s_lshr_b32 s54, s71, 2
  s_lshl_b32 s54, s54, 1
  s_add_u32 s54, s54, s10
  s_mov_b32 s5, 896
  s_lshl_b32 s6, s54, 6
  s_and_b32 s65, s69, 4
  s_lshl_b32 s62, s4, 2
  s_lshl_b32 s60, s55, 4
  s_add_u32 s62, s62, s60
  s_lshl_b32 s64, s54, 5
  s_add_u32 s64, s64, s62
  s_lshl_b32 s64, s64, 10
  s_add_u32 s64, s64, 14680064
  s_mov_b32 s52, 512
  s_mov_b32 s53, 256
  s_mov_b32 s57, -1
  s_mov_b32 s71, 14
  s_mov_b32 s59, 12
  s_lshr_b32 s10, s54, 1
  s_lshl_b32 s10, s10, 1
  s_add_u32 s55, s55, s10
  s_lshl_b32 s55, s55, 1
  s_lshr_b32 s10, s4, 1
  s_add_u32 s55, s55, s10
  s_lshl_b32 s55, s55, 6
  s_and_b32 s13, s54, 1
  s_lshl_b32 s13, s13, 1
  s_and_b32 s10, s4, 1
  s_add_u32 s10, s10, s13
  s_add_u32 s55, s55, s10
  s_add_u32 s55, s55, 16
  s_lshl_b32 s10, s61, 2
  s_add_u32 s10, s10, s4
  s_add_u32 s10, s10, 1096
  s_cmp_eq_u32 s65, 0
  s_cselect_b32 s55, s10, s55
K1_JC:
  s_lshl_b32 s63, s5, 4
  s_mul_i32 s62, s62, s71
  s_mul_i32 s62, s62, s5
  s_add_u32 s62, s62, s6
  s_mul_i32 s59, s59, s5
  v_lshrrev_b32 v3, 2, v1
  v_mul_lo_u32 v3, v3, s5
  v_and_b32 v12, 3, v1
  v_lshlrev_b32 v12, 4, v12
  v_add3_u32 v200, v3, v12, s62
  v_add_u32 v201, s63, v200
  v_add_u32 v202, s59, v201
  v_add_u32 v203, s63, v202
  s_mul_i32 s101, s4, 20480
  s_add_u32 s101, s101, 8192
  s_lshl_b32 s55, s55, 7
  s_add_u32 s55, s55, 15794176
W3:
  s_cbranch_execz F_H1
  v_mov_b32 v235, s55
  v_lshrrev_b32 v12, 5, v1
  v_mul_lo_u32 v12, v12, s53
  v_bfe_u32 v3, v1, 2, 2
  v_lshlrev_b32 v3, 6, v3
  v_add_u32 v12, v12, v3
  v_bfe_u32 v3, v1, 4, 1
  v_lshlrev_b32 v3, 5, v3
  v_add_u32 v12, v12, v3
  v_and_b32 v3, 3, v1
  v_lshlrev_b32 v3, 3, v3
  v_add3_u32 v229, v12, v3, s101
  v_add_u32 v230, s52, v229
  s_cmp_eq_u32 s65, 0
  s_cselect_b32 s10, 1073741824, s64
  v_add_u32 v231, s10, v2
  s_cmp_lg_u32 s65, 4
  s_cselect_b32 s10, 1073741824, s64
  v_add_u32 v232, s10, v2
  v_cndmask_b32 v233, -1, 0, s[56:57]
  s_add_u32 s35, s34, 3
  s_cmp_ge_u32 s35, 7
  s_cselect_b32 s10, 7, 0
  s_sub_u32 s35, s35, s10
  s_lshl_b32 s8, s3, 2
  s_add_u32 s8, s8, s4
  s_mul_i32 s8, s8, 28672
  s_add_u32 s72, s8, 896
  s_lshl_b32 s10, s35, 7
  s_add_u32 s8, s8, s10
  s_mul_i32 s11, s4, 43008
  s_add_u32 s73, s11, 1204224
  s_mul_i32 s10, s34, 172032
  s_add_u32 s71, s11, s10
  s_lshl_b32 s65, s4, 10
  s_add_u32 s65, s65, 122880
  s_mul_i32 s10, s35, 172032
  s_add_u32 s11, s11, s10
  s_mul_i32 s9, s4, 20480
  s_lshl_b32 s12, s4, 11
  s_add_u32 s12, s12, 81920
  s_mov_b32 s100, 0x07060302
  s_mov_b32 s74, 0xaaaaaaaa
  s_mov_b32 s75, 0xaaaaaaaa
  s_lshl_b32 s10, s3, 2
  s_add_u32 s10, s10, s4
  s_mul_i32 s14, s10, 61440
  s_add_u32 s14, s14, 2097152
  s_lshl_b32 s10, s3, 4
  s_lshl_b32 s13, s70, 3
  s_add_u32 s10, s10, s13
  s_add_u32 s10, s10, s66
  s_lshl_b32 s10, s10, 6
  s_add_u32 s69, s10, 15728640
  s_cmp_eq_u32 s4, 0
  s_cselect_b32 s60, 0xffff, 0
  s_mov_b32 s61, 0
  s_mul_i32 s68, s7, 7
  s_lshr_b32 s68, s68, 1
  s_lshl_b32 s10, s68, 4
  v_lshrrev_b32 v3, 2, v1
  v_mul_u32_u24 v3, 2688, v3
  v_and_b32 v13, 3, v1
  v_lshlrev_b32 v13, 4, v13
  v_add3_u32 v132, v3, v13, s10
  s_lshr_b32 s10, s68, 3
  s_add_u32 s13, s68, 3
  s_lshr_b32 s13, s13, 3
  v_mov_b32 v3, s10
  v_mov_b32 v13, s13
  v_cndmask_b32 v3, v3, v13, s[74:75]
  v_and_b32 v13, 2, v1
  v_lshl_add_u32 v3, v13, 2, v3
  v_lshlrev_b32 v3, 6, v3
  v_add_u32 v225, 15728640, v3
  s_cmp_lt_u32 s4, 2
  s_cbranch_scc1 F_NR
  s_mov_b64 exec, 0
  s_lshl_b32 s10, s70, 1
  s_add_u32 s10, s10, s4
  s_cmp_eq_u32 s10, 2
  s_cbranch_scc1 W4
  s_cmp_eq_u32 s10, 3
  s_cbranch_scc1 W5
  s_cmp_eq_u32 s10, 4
  s_cbranch_scc1 W9
  s_branch W10
F_H2:
  s_mov_b64 exec, -1
  s_cmp_ge_u32 s2, 16
  s_cbranch_scc1 F_NR
  s_cmp_lg_u32 s4, 3
  s_cbranch_scc1 F_NR
  s_lshl_b32 s10, s2, 4
  s_mov_b64 exec, 1
  v_mov_b32 v12, s10
  s_waitcnt vmcnt(0)
  global_store_dword v12, v236, s[30:31] sc1
  s_mov_b64 exec, -1
F_NR:
  s_cmp_lg_u32 s70, 0
  s_cbranch_scc1 F_PN
F_PT:
  s_lshl_b32 s10, s66, 12
  s_add_u32 s10, s10, s67
  v_add_u32 v134, s10, v2
  v_add_u32 v135, 2048, v134
  v_mov_b32 v228, 1073741824
  s_waitcnt vmcnt(24) lgkmcnt(0)
  s_barrier
F_BODYT:
  ds_read_b128 a[0:3], v208 offset:0
  ds_read_b64_tr_b16 v[64:65], v212 offset:0
  ds_read_b64_tr_b16 v[66:67], v212 offset:512
  ds_read_b64_tr_b16 v[68:69], v216 offset:0
  ds_read_b64_tr_b16 v[70:71], v216 offset:512
  ds_read_b128 a[4:7], v209 offset:0
  ds_read_b64_tr_b16 v[72:73], v213 offset:0
  ds_read_b64_tr_b16 v[74:75], v213 offset:512
  ds_read_b64_tr_b16 v[76:77], v217 offset:0
  ds_read_b64_tr_b16 v[78:79], v217 offset:512
  s_waitcnt lgkmcnt(5)
  v_mfma_f32_32x32x16_bf16 v[32:47], v[64:67], a[0:3], 0
  ds_read_b128 a[8:11], v210 offset:0
  ds_read_b64_tr_b16 v[80:81], v214 offset:0
  ds_read_b64_tr_b16 v[82:83], v214 offset:512
  s_add_u32 m0, s9, 12288
  s_add_u32 s10, s8, 0
  buffer_load_dwordx4 v128, s[40:43], s10 offen lds
  s_add_u32 m0, s9, 13312
  s_add_u32 s10, s8, 7168
  buffer_load_dwordx4 v128, s[40:43], s10 offen lds
  v_mfma_f32_4x4x4_16b_bf16 v[4:7], v[192:193], a[0:1], v[4:7]
  v_mfma_f32_4x4x4_16b_bf16 v[8:11], a[0:1], a[0:1], v[8:11]
  v_mfma_f32_4x4x4_16b_bf16 v[136:139], v[192:193], v[64:65], v[136:139]
  s_nop 1
  v_mfma_f32_4x4x4_16b_bf16 v[136:139], v[192:193], v[66:67], v[136:139]
  v_mfma_f32_32x32x16_bf16 v[48:63], v[68:71], a[0:3], 0
  ds_read_b64_tr_b16 v[84:85], v218 offset:0
  ds_read_b64_tr_b16 v[86:87], v218 offset:512
  s_add_u32 m0, s9, 14336
  s_add_u32 s10, s8, 14336
  buffer_load_dwordx4 v129, s[40:43], s10 offen lds
  s_add_u32 m0, s9, 15360
  s_add_u32 s10, s8, 21504
  buffer_load_dwordx4 v129, s[40:43], s10 offen lds
  s_add_u32 s8, s8, 128
  s_cmp_eq_u32 s8, s72
  s_cselect_b32 s10, 896, 0
  s_sub_u32 s8, s8, s10
  v_mfma_f32_4x4x4_16b_bf16 v[4:7], v[192:193], a[2:3], v[4:7]
  v_mfma_f32_4x4x4_16b_bf16 v[8:11], a[2:3], a[2:3], v[8:11]
  v_mfma_f32_4x4x4_16b_bf16 v[140:143], v[192:193], v[68:69], v[140:143]
  s_nop 1
  v_mfma_f32_4x4x4_16b_bf16 v[140:143], v[192:193], v[70:71], v[140:143]
  s_waitcnt lgkmcnt(5)
  v_mfma_f32_32x32x16_bf16 v[32:47], v[72:75], a[4:7], v[32:47]
  ds_read_b128 a[12:15], v211 offset:0
  ds_read_b64_tr_b16 v[88:89], v215 offset:0
  ds_read_b64_tr_b16 v[90:91], v215 offset:512
  s_add_u32 m0, s12, 24576
  s_nop 0
  buffer_load_dwordx4 v130, s[44:47], s11 offen lds
  s_add_u32 m0, s12, 25600
  s_nop 0
  buffer_load_dwordx4 v131, s[44:47], s11 offen lds
  s_add_u32 s11, s11, 172032
  s_cmp_eq_u32 s11, s73
  s_cselect_b32 s10, 1204224, 0
  s_sub_u32 s11, s11, s10
  v_mfma_f32_4x4x4_16b_bf16 v[4:7], v[192:193], a[4:5], v[4:7]
  v_mfma_f32_4x4x4_16b_bf16 v[8:11], a[4:5], a[4:5], v[8:11]
  v_mfma_f32_32x32x16_bf16 v[48:63], v[76:79], a[4:7], v[48:63]
  ds_read_b64_tr_b16 v[92:93], v219 offset:0
  ds_read_b64_tr_b16 v[94:95], v219 offset:512
  buffer_store_dwordx4 v[196:199], v228, s[36:39], s14 offen sc1
W4:
  s_cbranch_execz W6
  buffer_store_dwordx4 v[236:239], v134, s[36:39], s14 offen offset:0 sc1
  v_mfma_f32_4x4x4_16b_bf16 v[4:7], v[192:193], a[6:7], v[4:7]
  v_mfma_f32_4x4x4_16b_bf16 v[8:11], a[6:7], a[6:7], v[8:11]
  s_waitcnt vmcnt(20) lgkmcnt(0)
  s_barrier
  v_mfma_f32_32x32x16_bf16 v[32:47], v[80:83], a[8:11], v[32:47]
  ds_read_b128 a[16:19], v208 offset:4096
  ds_read_b64_tr_b16 v[64:65], v212 offset:8192
  ds_read_b64_tr_b16 v[66:67], v212 offset:8704
  buffer_store_dwordx4 v[236:239], v134, s[36:39], s14 offen offset:1024 sc1
  buffer_store_dwordx4 v[236:239], v135, s[36:39], s14 offen offset:0 sc1
  v_mfma_f32_4x4x4_16b_bf16 v[4:7], v[192:193], a[8:9], v[4:7]
  v_mfma_f32_4x4x4_16b_bf16 v[8:11], a[8:9], a[8:9], v[8:11]
  v_mfma_f32_32x32x16_bf16 v[48:63], v[84:87], a[8:11], v[48:63]
  ds_read_b64_tr_b16 v[68:69], v216 offset:8192
  ds_read_b64_tr_b16 v[70:71], v216 offset:8704
  buffer_store_dwordx4 v[236:239], v135, s[36:39], s14 offen offset:1024 sc1
  s_add_u32 m0, s9, 16384
  s_add_u32 s10, s8, 0
  buffer_load_dwordx4 v128, s[40:43], s10 offen lds
  v_mfma_f32_4x4x4_16b_bf16 v[4:7], v[192:193], a[10:11], v[4:7]
  v_mfma_f32_4x4x4_16b_bf16 v[8:11], a[10:11], a[10:11], v[8:11]
  s_waitcnt lgkmcnt(5)
  v_mfma_f32_32x32x16_bf16 v[32:47], v[88:91], a[12:15], v[32:47]
  ds_read_b128 a[20:23], v209 offset:4096
  ds_read_b64_tr_b16 v[72:73], v213 offset:8192
  ds_read_b64_tr_b16 v[74:75], v213 offset:8704
  s_add_u32 m0, s9, 17408
  s_add_u32 s10, s8, 7168
  buffer_load_dwordx4 v128, s[40:43], s10 offen lds
  s_add_u32 m0, s9, 18432
  s_add_u32 s10, s8, 14336
  buffer_load_dwordx4 v129, s[40:43], s10 offen lds
  v_mfma_f32_4x4x4_16b_bf16 v[4:7], v[192:193], a[12:13], v[4:7]
  v_mfma_f32_4x4x4_16b_bf16 v[8:11], a[12:13], a[12:13], v[8:11]
  v_mfma_f32_32x32x16_bf16 v[48:63], v[92:95], a[12:15], v[48:63]
  ds_read_b64_tr_b16 v[76:77], v217 offset:8192
  ds_read_b64_tr_b16 v[78:79], v217 offset:8704
  s_add_u32 m0, s9, 19456
  s_add_u32 s10, s8, 21504
  buffer_load_dwordx4 v129, s[40:43], s10 offen lds
  s_add_u32 s8, s8, 128
  s_cmp_eq_u32 s8, s72
  s_cselect_b32 s10, 896, 0
  s_sub_u32 s8, s8, s10
  s_add_u32 m0, s12, 32768
  s_nop 0
  buffer_load_dwordx4 v130, s[44:47], s11 offen lds
  v_mfma_f32_4x4x4_16b_bf16 v[4:7], v[192:193], a[14:15], v[4:7]
  v_mfma_f32_4x4x4_16b_bf16 v[8:11], a[14:15], a[14:15], v[8:11]
  s_waitcnt lgkmcnt(5)
  v_mfma_f32_32x32x16_bf16 v[32:47], v[64:67], a[16:19], v[32:47]
  ds_read_b128 a[24:27], v210 offset:4096
  ds_read_b64_tr_b16 v[80:81], v214 offset:8192
  ds_read_b64_tr_b16 v[82:83], v214 offset:8704
  s_add_u32 m0, s12, 33792
  s_nop 0
  buffer_load_dwordx4 v131, s[44:47], s11 offen lds
  s_add_u32 s11, s11, 172032
  s_cmp_eq_u32 s11, s73
  s_cselect_b32 s10, 1204224, 0
  s_sub_u32 s11, s11, s10
  s_add_u32 m0, s9, 0
  s_add_u32 s10, s8, 0
  buffer_load_dwordx4 v128, s[40:43], s10 offen lds
  v_mfma_f32_4x4x4_16b_bf16 v[4:7], v[192:193], a[16:17], v[4:7]
  v_mfma_f32_4x4x4_16b_bf16 v[8:11], a[16:17], a[16:17], v[8:11]
  v_mfma_f32_4x4x4_16b_bf16 v[136:139], v[192:193], v[64:65], v[136:139]
  s_nop 1
  v_mfma_f32_4x4x4_16b_bf16 v[136:139], v[192:193], v[66:67], v[136:139]
  v_mfma_f32_32x32x16_bf16 v[48:63], v[68:71], a[16:19], v[48:63]
  ds_read_b64_tr_b16 v[84:85], v218 offset:8192
  ds_read_b64_tr_b16 v[86:87], v218 offset:8704
  s_add_u32 m0, s9, 1024
  s_add_u32 s10, s8, 7168
  buffer_load_dwordx4 v128, s[40:43], s10 offen lds
  s_add_u32 m0, s9, 2048
  s_add_u32 s10, s8, 14336
  buffer_load_dwordx4 v129, s[40:43], s10 offen lds
  v_mfma_f32_4x4x4_16b_bf16 v[4:7], v[192:193], a[18:19], v[4:7]
  v_mfma_f32_4x4x4_16b_bf16 v[8:11], a[18:19], a[18:19], v[8:11]
  v_mfma_f32_4x4x4_16b_bf16 v[140:143], v[192:193], v[68:69], v[140:143]
  s_nop 1
  v_mfma_f32_4x4x4_16b_bf16 v[140:143], v[192:193], v[70:71], v[140:143]
  s_waitcnt lgkmcnt(5)
  v_mfma_f32_32x32x16_bf16 v[32:47], v[72:75], a[20:23], v[32:47]
  ds_read_b128 a[28:31], v211 offset:4096
  ds_read_b64_tr_b16 v[88:89], v215 offset:8192
  ds_read_b64_tr_b16 v[90:91], v215 offset:8704
  s_add_u32 m0, s9, 3072
  s_add_u32 s10, s8, 21504
  buffer_load_dwordx4 v129, s[40:43], s10 offen lds
  s_add_u32 s8, s8, 128
  s_cmp_eq_u32 s8, s72
  s_cselect_b32 s10, 896, 0
  s_sub_u32 s8, s8, s10
  s_add_u32 m0, s12, 0
  s_nop 0
  buffer_load_dwordx4 v130, s[44:47], s11 offen lds
  v_mfma_f32_4x4x4_16b_bf16 v[4:7], v[192:193], a[20:21], v[4:7]
  v_mfma_f32_4x4x4_16b_bf16 v[8:11], a[20:21], a[20:21], v[8:11]
  v_mfma_f32_32x32x16_bf16 v[48:63], v[76:79], a[20:23], v[48:63]
  ds_read_b64_tr_b16 v[92:93], v219 offset:8192
  ds_read_b64_tr_b16 v[94:95], v219 offset:8704
  s_add_u32 m0, s12, 1024
  s_nop 0
  buffer_load_dwordx4 v131, s[44:47], s11 offen lds
  s_add_u32 s11, s11, 172032
  s_cmp_eq_u32 s11, s73
  s_cselect_b32 s10, 1204224, 0
  s_sub_u32 s11, s11, s10
  v_mfma_f32_4x4x4_16b_bf16 v[4:7], v[192:193], a[22:23], v[4:7]
  v_mfma_f32_4x4x4_16b_bf16 v[8:11], a[22:23], a[22:23], v[8:11]
  s_waitcnt vmcnt(23) lgkmcnt(0)
  s_barrier
  s_mov_b64 exec, s[60:61]
  global_load_dword v227, v2, s[30:31] sc1
  s_mov_b64 exec, -1
  v_mfma_f32_32x32x16_bf16 v[32:47], v[80:83], a[24:27], v[32:47]
  ds_read_b128 a[32:35], v208 offset:8192
  ds_read_b64_tr_b16 v[64:65], v212 offset:16384
  ds_read_b64_tr_b16 v[66:67], v212 offset:16896
  s_add_u32 m0, s9, 4096
  s_add_u32 s10, s8, 0
  buffer_load_dwordx4 v128, s[40:43], s10 offen lds
  s_add_u32 m0, s9, 5120
  s_add_u32 s10, s8, 7168
  buffer_load_dwordx4 v128, s[40:43], s10 offen lds
  v_mfma_f32_4x4x4_16b_bf16 v[4:7], v[192:193], a[24:25], v[4:7]
  v_mfma_f32_4x4x4_16b_bf16 v[8:11], a[24:25], a[24:25], v[8:11]
  v_mfma_f32_32x32x16_bf16 v[48:63], v[84:87], a[24:27], v[48:63]
  ds_read_b64_tr_b16 v[68:69], v216 offset:16384
  ds_read_b64_tr_b16 v[70:71], v216 offset:16896
  s_add_u32 m0, s9, 6144
  s_add_u32 s10, s8, 14336
  buffer_load_dwordx4 v129, s[40:43], s10 offen lds
  s_add_u32 m0, s9, 7168
  s_add_u32 s10, s8, 21504
  buffer_load_dwordx4 v129, s[40:43], s10 offen lds
  s_add_u32 s8, s8, 128
  s_cmp_eq_u32 s8, s72
  s_cselect_b32 s10, 896, 0
W5:
  s_cbranch_execz W7
  s_sub_u32 s8, s8, s10
  v_mfma_f32_4x4x4_16b_bf16 v[4:7], v[192:193], a[26:27], v[4:7]
  v_mfma_f32_4x4x4_16b_bf16 v[8:11], a[26:27], a[26:27], v[8:11]
  s_waitcnt lgkmcnt(5)
  v_mfma_f32_32x32x16_bf16 v[32:47], v[88:91], a[28:31], v[32:47]
  ds_read_b128 a[36:39], v209 offset:8192
  ds_read_b64_tr_b16 v[72:73], v213 offset:16384
  ds_read_b64_tr_b16 v[74:75], v213 offset:16896
  s_add_u32 m0, s12, 8192
  s_nop 0
  buffer_load_dwordx4 v130, s[44:47], s11 offen lds
  s_add_u32 m0, s12, 9216
  s_nop 0
  buffer_load_dwordx4 v131, s[44:47], s11 offen lds
  s_add_u32 s11, s11, 172032
  s_cmp_eq_u32 s11, s73
  s_cselect_b32 s10, 1204224, 0
  s_sub_u32 s11, s11, s10
  v_mfma_f32_4x4x4_16b_bf16 v[4:7], v[192:193], a[28:29], v[4:7]
  v_mfma_f32_4x4x4_16b_bf16 v[8:11], a[28:29], a[28:29], v[8:11]
  v_mfma_f32_32x32x16_bf16 v[48:63], v[92:95], a[28:31], v[48:63]
  ds_read_b64_tr_b16 v[76:77], v217 offset:16384
  ds_read_b64_tr_b16 v[78:79], v217 offset:16896
  s_add_u32 m0, s65, 0
  s_nop 0
  buffer_load_dwordx4 v132, s[44:47], s71 offen lds
  s_add_u32 s71, s71, 172032
  s_cmp_eq_u32 s71, s73
  s_cselect_b32 s10, 1204224, 0
  s_sub_u32 s71, s71, s10
  s_add_u32 m0, s65, 4096
  s_nop 0
  buffer_load_dwordx4 v132, s[44:47], s71 offen lds
  s_add_u32 s71, s71, 172032
  s_cmp_eq_u32 s71, s73
  s_cselect_b32 s10, 1204224, 0
  s_sub_u32 s71, s71, s10
  v_mfma_f32_4x4x4_16b_bf16 v[4:7], v[192:193], a[30:31], v[4:7]
  v_mfma_f32_4x4x4_16b_bf16 v[8:11], a[30:31], a[30:31], v[8:11]
  s_waitcnt lgkmcnt(5)
  v_mfma_f32_32x32x16_bf16 v[32:47], v[64:67], a[32:35], v[32:47]
  ds_read_b128 a[40:43], v210 offset:8192
  ds_read_b64_tr_b16 v[80:81], v214 offset:16384
  ds_read_b64_tr_b16 v[82:83], v214 offset:16896
  s_add_u32 m0, s65, 8192
  s_nop 0
  buffer_load_dwordx4 v132, s[44:47], s71 offen lds
  s_add_u32 s71, s71, 172032
  s_cmp_eq_u32 s71, s73
  s_cselect_b32 s10, 1204224, 0
  s_sub_u32 s71, s71, s10
  s_add_u32 m0, s65, 12288
  s_nop 0
  buffer_load_dwordx4 v132, s[44:47], s71 offen lds
  s_add_u32 s71, s71, 172032
  s_cmp_eq_u32 s71, s73
  s_cselect_b32 s10, 1204224, 0
  s_sub_u32 s71, s71, s10
  v_mfma_f32_4x4x4_16b_bf16 v[4:7], v[192:193], a[32:33], v[4:7]
  v_mfma_f32_4x4x4_16b_bf16 v[8:11], a[32:33], a[32:33], v[8:11]
  v_mfma_f32_4x4x4_16b_bf16 v[136:139], v[192:193], v[64:65], v[136:139]
  s_nop 1
  v_mfma_f32_4x4x4_16b_bf16 v[136:139], v[192:193], v[66:67], v[136:139]
  v_mfma_f32_32x32x16_bf16 v[48:63], v[68:71], a[32:35], v[48:63]
  ds_read_b64_tr_b16 v[84:85], v218 offset:16384
  ds_read_b64_tr_b16 v[86:87], v218 offset:16896
  s_add_u32 m0, s65, 16384
  s_nop 0
  buffer_load_dwordx4 v132, s[44:47], s71 offen lds
  s_add_u32 s71, s71, 172032
  s_cmp_eq_u32 s71, s73
  s_cselect_b32 s10, 1204224, 0
  s_sub_u32 s71, s71, s10
  s_add_u32 m0, s65, 20480
  s_nop 0
  buffer_load_dwordx4 v132, s[44:47], s71 offen lds
  s_add_u32 s71, s71, 172032
  s_cmp_eq_u32 s71, s73
  s_cselect_b32 s10, 1204224, 0
  s_sub_u32 s71, s71, s10
  v_mfma_f32_4x4x4_16b_bf16 v[4:7], v[192:193], a[34:35], v[4:7]
  v_mfma_f32_4x4x4_16b_bf16 v[8:11], a[34:35], a[34:35], v[8:11]
  v_mfma_f32_4x4x4_16b_bf16 v[140:143], v[192:193], v[68:69], v[140:143]
  s_nop 1
  v_mfma_f32_4x4x4_16b_bf16 v[140:143], v[192:193], v[70:71], v[140:143]
  s_waitcnt lgkmcnt(5)
  v_mfma_f32_32x32x16_bf16 v[32:47], v[72:75], a[36:39], v[32:47]
  ds_read_b128 a[44:47], v211 offset:8192
  ds_read_b64_tr_b16 v[88:89], v215 offset:16384
  ds_read_b64_tr_b16 v[90:91], v215 offset:16896
  s_add_u32 m0, s65, 24576
  s_nop 0
  buffer_load_dwordx4 v132, s[44:47], s71 offen lds
  s_add_u32 s71, s71, 172032
  s_cmp_eq_u32 s71, s73
  s_cselect_b32 s10, 1204224, 0
  s_sub_u32 s71, s71, s10
  v_mfma_f32_4x4x4_16b_bf16 v[4:7], v[192:193], a[36:37], v[4:7]
  v_mfma_f32_4x4x4_16b_bf16 v[8:11], a[36:37], a[36:37], v[8:11]
  v_mfma_f32_32x32x16_bf16 v[48:63], v[76:79], a[36:39], v[48:63]
  ds_read_b64_tr_b16 v[92:93], v219 offset:16384
  ds_read_b64_tr_b16 v[94:95], v219 offset:16896
  v_mfma_f32_4x4x4_16b_bf16 v[4:7], v[192:193], a[38:39], v[4:7]
  v_mfma_f32_4x4x4_16b_bf16 v[8:11], a[38:39], a[38:39], v[8:11]
  s_waitcnt vmcnt(13) lgkmcnt(0)
  s_barrier
  s_cmp_lg_u32 s4, 0
  s_cbranch_scc1 F_NQT
  s_mov_b64 exec, s[60:61]
  v_cmp_eq_u32 vcc, 0, v227
  s_nop 1
  s_cbranch_vccnz F_NQT
  s_mov_b64 exec, 1
  buffer_store_dword v2, v2, s[36:39], s69 offen sc1
  s_mov_b32 s60, 0
F_NQT:
  s_mov_b64 exec, s[60:61]
  global_load_dword v227, v2, s[30:31] sc1
  s_mov_b64 exec, -1
  v_mfma_f32_32x32x16_bf16 v[32:47], v[80:83], a[40:43], v[32:47]
  ds_read_b128 a[48:51], v208 offset:12288
  ds_read_b64_tr_b16 v[64:65], v212 offset:24576
  ds_read_b64_tr_b16 v[66:67], v212 offset:25088
  v_mfma_f32_4x4x4_16b_bf16 v[4:7], v[192:193], a[40:41], v[4:7]
  v_mfma_f32_4x4x4_16b_bf16 v[8:11], a[40:41], a[40:41], v[8:11]
  v_mfma_f32_32x32x16_bf16 v[48:63], v[84:87], a[40:43], v[48:63]
  ds_read_b64_tr_b16 v[68:69], v216 offset:24576
  ds_read_b64_tr_b16 v[70:71], v216 offset:25088
  v_mfma_f32_4x4x4_16b_bf16 v[4:7], v[192:193], a[42:43], v[4:7]
  v_mfma_f32_4x4x4_16b_bf16 v[8:11], a[42:43], a[42:43], v[8:11]
  s_waitcnt lgkmcnt(5)
  v_mfma_f32_32x32x16_bf16 v[32:47], v[88:91], a[44:47], v[32:47]
  ds_read_b128 a[52:55], v209 offset:12288
  ds_read_b64_tr_b16 v[72:73], v213 offset:24576
  ds_read_b64_tr_b16 v[74:75], v213 offset:25088
  v_mfma_f32_4x4x4_16b_bf16 v[4:7], v[192:193], a[44:45], v[4:7]
  v_mfma_f32_4x4x4_16b_bf16 v[8:11], a[44:45], a[44:45], v[8:11]
  v_mfma_f32_32x32x16_bf16 v[48:63], v[92:95], a[44:47], v[48:63]
  ds_read_b64_tr_b16 v[76:77], v217 offset:24576
  ds_read_b64_tr_b16 v[78:79], v217 offset:25088
  v_mfma_f32_4x4x4_16b_bf16 v[4:7], v[192:193], a[46:47], v[4:7]
  v_mfma_f32_4x4x4_16b_bf16 v[8:11], a[46:47], a[46:47], v[8:11]
  s_waitcnt lgkmcnt(5)
  v_mfma_f32_32x32x16_bf16 v[32:47], v[64:67], a[48:51], v[32:47]
  ds_read_b128 a[56:59], v210 offset:12288
  ds_read_b64_tr_b16 v[80:81], v214 offset:24576
  ds_read_b64_tr_b16 v[82:83], v214 offset:25088
  s_add_u32 m0, s101, 0
  s_nop 0
  buffer_load_dwordx4 v200, s[48:51], 0 offen lds
  s_add_u32 m0, s101, 1024
  s_nop 0
  buffer_load_dwordx4 v201, s[48:51], 0 offen lds
W6:
  s_cbranch_execz W8
  v_mfma_f32_4x4x4_16b_bf16 v[4:7], v[192:193], a[48:49], v[4:7]
  v_mfma_f32_4x4x4_16b_bf16 v[8:11], a[48:49], a[48:49], v[8:11]
  v_mfma_f32_4x4x4_16b_bf16 v[136:139], v[192:193], v[64:65], v[136:139]
  s_nop 1
  v_mfma_f32_4x4x4_16b_bf16 v[136:139], v[192:193], v[66:67], v[136:139]
  v_mfma_f32_32x32x16_bf16 v[48:63], v[68:71], a[48:51], v[48:63]
  ds_read_b64_tr_b16 v[84:85], v218 offset:24576
  ds_read_b64_tr_b16 v[86:87], v218 offset:25088
  s_add_u32 m0, s101, 2048
  s_nop 0
  buffer_load_dwordx4 v202, s[48:51], 0 offen lds
  s_add_u32 m0, s101, 3072
  s_nop 0
  buffer_load_dwordx4 v203, s[48:51], 0 offen lds
  v_mfma_f32_4x4x4_16b_bf16 v[4:7], v[192:193], a[50:51], v[4:7]
  v_mfma_f32_4x4x4_16b_bf16 v[8:11], a[50:51], a[50:51], v[8:11]
  v_mfma_f32_4x4x4_16b_bf16 v[140:143], v[192:193], v[68:69], v[140:143]
  s_nop 1
  v_mfma_f32_4x4x4_16b_bf16 v[140:143], v[192:193], v[70:71], v[140:143]
  s_waitcnt lgkmcnt(5)
  v_mfma_f32_32x32x16_bf16 v[32:47], v[72:75], a[52:55], v[32:47]
  ds_read_b128 a[60:63], v211 offset:12288
  ds_read_b64_tr_b16 v[88:89], v215 offset:24576
  ds_read_b64_tr_b16 v[90:91], v215 offset:25088
  v_mfma_f32_4x4x4_16b_bf16 v[4:7], v[192:193], a[52:53], v[4:7]
  v_mfma_f32_4x4x4_16b_bf16 v[8:11], a[52:53], a[52:53], v[8:11]
  v_mfma_f32_32x32x16_bf16 v[48:63], v[76:79], a[52:55], v[48:63]
  ds_read_b64_tr_b16 v[92:93], v219 offset:24576
  ds_read_b64_tr_b16 v[94:95], v219 offset:25088
  v_mfma_f32_4x4x4_16b_bf16 v[4:7], v[192:193], a[54:55], v[4:7]
  v_mfma_f32_4x4x4_16b_bf16 v[8:11], a[54:55], a[54:55], v[8:11]
  s_waitcnt vmcnt(25) lgkmcnt(0)
  s_barrier
  s_cmp_eq_u32 s60, 0
  s_cbranch_scc1 F_NPT
  s_mov_b64 exec, s[60:61]
  s_movk_i32 s13, 2000
  s_waitcnt vmcnt(4)
F_L0T:
  v_cmp_eq_u32 vcc, 0, v227
  s_nop 1
  s_cbranch_vccz F_L0KT
  s_sleep 8
  global_load_dword v227, v2, s[30:31] sc1
  s_sub_u32 s13, s13, 1
  s_cmp_eq_u32 s13, 0
  s_cbranch_scc1 P_END
  s_waitcnt vmcnt(0)
  s_branch F_L0T
F_L0KT:
  s_mov_b64 exec, 1
  buffer_store_dword v2, v2, s[36:39], s69 offen sc1
  s_mov_b64 exec, -1
F_NPT:
  v_mfma_f32_32x32x16_bf16 v[32:47], v[80:83], a[56:59], v[32:47]
  ds_read_b128 a[64:67], v208 offset:16384
  ds_read_b64_tr_b16 v[64:65], v212 offset:32768
  ds_read_b64_tr_b16 v[66:67], v212 offset:33280
  v_mfma_f32_4x4x4_16b_bf16 v[4:7], v[192:193], a[56:57], v[4:7]
  v_mfma_f32_4x4x4_16b_bf16 v[8:11], a[56:57], a[56:57], v[8:11]
  v_mfma_f32_32x32x16_bf16 v[48:63], v[84:87], a[56:59], v[48:63]
  ds_read_b64_tr_b16 v[68:69], v216 offset:32768
  ds_read_b64_tr_b16 v[70:71], v216 offset:33280
  v_mfma_f32_4x4x4_16b_bf16 v[4:7], v[192:193], a[58:59], v[4:7]
  v_mfma_f32_4x4x4_16b_bf16 v[8:11], a[58:59], a[58:59], v[8:11]
  s_waitcnt lgkmcnt(5)
  v_mfma_f32_32x32x16_bf16 v[32:47], v[88:91], a[60:63], v[32:47]
  ds_read_b128 a[68:71], v209 offset:16384
  ds_read_b64_tr_b16 v[72:73], v213 offset:32768
  ds_read_b64_tr_b16 v[74:75], v213 offset:33280
  v_mfma_f32_4x4x4_16b_bf16 v[4:7], v[192:193], a[60:61], v[4:7]
  v_mfma_f32_4x4x4_16b_bf16 v[8:11], a[60:61], a[60:61], v[8:11]
  v_mfma_f32_32x32x16_bf16 v[48:63], v[92:95], a[60:63], v[48:63]
  ds_read_b64_tr_b16 v[76:77], v217 offset:32768
  ds_read_b64_tr_b16 v[78:79], v217 offset:33280
  v_mfma_f32_4x4x4_16b_bf16 v[4:7], v[192:193], a[62:63], v[4:7]
  v_mfma_f32_4x4x4_16b_bf16 v[8:11], a[62:63], a[62:63], v[8:11]
  s_waitcnt lgkmcnt(5)
  v_mfma_f32_32x32x16_bf16 v[32:47], v[64:67], a[64:67], v[32:47]
  ds_read_b128 a[72:75], v210 offset:16384
  ds_read_b64_tr_b16 v[80:81], v214 offset:32768
  ds_read_b64_tr_b16 v[82:83], v214 offset:33280
  v_mfma_f32_4x4x4_16b_bf16 v[4:7], v[192:193], a[64:65], v[4:7]
  v_mfma_f32_4x4x4_16b_bf16 v[8:11], a[64:65], a[64:65], v[8:11]
  v_mfma_f32_4x4x4_16b_bf16 v[136:139], v[192:193], v[64:65], v[136:139]
  s_nop 1
  v_mfma_f32_4x4x4_16b_bf16 v[136:139], v[192:193], v[66:67], v[136:139]
  v_mfma_f32_32x32x16_bf16 v[48:63], v[68:71], a[64:67], v[48:63]
  ds_read_b64_tr_b16 v[84:85], v218 offset:32768
  ds_read_b64_tr_b16 v[86:87], v218 offset:33280
  v_mfma_f32_4x4x4_16b_bf16 v[4:7], v[192:193], a[66:67], v[4:7]
  v_mfma_f32_4x4x4_16b_bf16 v[8:11], a[66:67], a[66:67], v[8:11]
  v_mfma_f32_4x4x4_16b_bf16 v[140:143], v[192:193], v[68:69], v[140:143]
  s_nop 1
  v_mfma_f32_4x4x4_16b_bf16 v[140:143], v[192:193], v[70:71], v[140:143]
  s_waitcnt lgkmcnt(5)
  v_mfma_f32_32x32x16_bf16 v[32:47], v[72:75], a[68:71], v[32:47]
  ds_read_b128 a[76:79], v211 offset:16384
  ds_read_b64_tr_b16 v[88:89], v215 offset:32768
  ds_read_b64_tr_b16 v[90:91], v215 offset:33280
  v_mfma_f32_4x4x4_16b_bf16 v[4:7], v[192:193], a[68:69], v[4:7]
  v_mfma_f32_4x4x4_16b_bf16 v[8:11], a[68:69], a[68:69], v[8:11]
  v_mfma_f32_32x32x16_bf16 v[48:63], v[76:79], a[68:71], v[48:63]
  ds_read_b64_tr_b16 v[92:93], v219 offset:32768
  ds_read_b64_tr_b16 v[94:95], v219 offset:33280
  v_mfma_f32_4x4x4_16b_bf16 v[4:7], v[192:193], a[70:71], v[4:7]
  v_mfma_f32_4x4x4_16b_bf16 v[8:11], a[70:71], a[70:71], v[8:11]
  s_waitcnt vmcnt(5) lgkmcnt(0)
  s_barrier
  v_mfma_f32_32x32x16_bf16 v[32:47], v[80:83], a[72:75], v[32:47]
  ds_read_b128 a[80:83], v208 offset:0
  ds_read_b64_tr_b16 v[64:65], v212 offset:0
  ds_read_b64_tr_b16 v[66:67], v212 offset:512
  v_mfma_f32_4x4x4_16b_bf16 v[4:7], v[192:193], a[72:73], v[4:7]
  v_mfma_f32_4x4x4_16b_bf16 v[8:11], a[72:73], a[72:73], v[8:11]
  v_mfma_f32_32x32x16_bf16 v[48:63], v[84:87], a[72:75], v[48:63]
  ds_read_b64_tr_b16 v[68:69], v216 offset:0
  ds_read_b64_tr_b16 v[70:71], v216 offset:512
  v_mfma_f32_4x4x4_16b_bf16 v[4:7], v[192:193], a[74:75], v[4:7]
  v_mfma_f32_4x4x4_16b_bf16 v[8:11], a[74:75], a[74:75], v[8:11]
  s_waitcnt lgkmcnt(5)
  v_mfma_f32_32x32x16_bf16 v[32:47], v[88:91], a[76:79], v[32:47]
  ds_read_b128 a[84:87], v209 offset:0
  ds_read_b64_tr_b16 v[72:73], v213 offset:0
  ds_read_b64_tr_b16 v[74:75], v213 offset:512
  v_mfma_f32_4x4x4_16b_bf16 v[4:7], v[192:193], a[76:77], v[4:7]
  v_mfma_f32_4x4x4_16b_bf16 v[8:11], a[76:77], a[76:77], v[8:11]
  v_mfma_f32_32x32x16_bf16 v[48:63], v[92:95], a[76:79], v[48:63]
  ds_read_b64_tr_b16 v[76:77], v217 offset:0
  ds_read_b64_tr_b16 v[78:79], v217 offset:512
  v_mfma_f32_4x4x4_16b_bf16 v[4:7], v[192:193], a[78:79], v[4:7]
  v_mfma_f32_4x4x4_16b_bf16 v[8:11], a[78:79], a[78:79], v[8:11]
  s_waitcnt lgkmcnt(5)
  v_mfma_f32_32x32x16_bf16 v[32:47], v[64:67], a[80:83], v[32:47]
  ds_read_b128 a[88:91], v210 offset:0
  ds_read_b64_tr_b16 v[80:81], v214 offset:0
  ds_read_b64_tr_b16 v[82:83], v214 offset:512
  v_mfma_f32_4x4x4_16b_bf16 v[4:7], v[192:193], a[80:81], v[4:7]
  v_mfma_f32_4x4x4_16b_bf16 v[8:11], a[80:81], a[80:81], v[8:11]
  v_mfma_f32_4x4x4_16b_bf16 v[136:139], v[192:193], v[64:65], v[136:139]
  s_nop 1
  v_mfma_f32_4x4x4_16b_bf16 v[136:139], v[192:193], v[66:67], v[136:139]
  v_mfma_f32_32x32x16_bf16 v[48:63], v[68:71], a[80:83], v[48:63]
  ds_read_b64_tr_b16 v[84:85], v218 offset:0
  ds_read_b64_tr_b16 v[86:87], v218 offset:512
  v_mfma_f32_4x4x4_16b_bf16 v[4:7], v[192:193], a[82:83], v[4:7]
  v_mfma_f32_4x4x4_16b_bf16 v[8:11], a[82:83], a[82:83], v[8:11]
W7:
  s_cbranch_execz W15
  v_mfma_f32_4x4x4_16b_bf16 v[140:143], v[192:193], v[68:69], v[140:143]
  s_nop 1
  v_mfma_f32_4x4x4_16b_bf16 v[140:143], v[192:193], v[70:71], v[140:143]
  s_waitcnt lgkmcnt(5)
  v_mfma_f32_32x32x16_bf16 v[32:47], v[72:75], a[84:87], v[32:47]
  ds_read_b128 a[92:95], v211 offset:0
  ds_read_b64_tr_b16 v[88:89], v215 offset:0
  ds_read_b64_tr_b16 v[90:91], v215 offset:512
  v_mfma_f32_4x4x4_16b_bf16 v[4:7], v[192:193], a[84:85], v[4:7]
  v_mfma_f32_4x4x4_16b_bf16 v[8:11], a[84:85], a[84:85], v[8:11]
  v_mfma_f32_32x32x16_bf16 v[48:63], v[76:79], a[84:87], v[48:63]
  ds_read_b64_tr_b16 v[92:93], v219 offset:0
  ds_read_b64_tr_b16 v[94:95], v219 offset:512
  v_mfma_f32_4x4x4_16b_bf16 v[4:7], v[192:193], a[86:87], v[4:7]
  v_mfma_f32_4x4x4_16b_bf16 v[8:11], a[86:87], a[86:87], v[8:11]
  s_waitcnt lgkmcnt(5)
  v_mfma_f32_32x32x16_bf16 v[32:47], v[80:83], a[88:91], v[32:47]
  ds_read_b128 a[96:99], v208 offset:4096
  ds_read_b64_tr_b16 v[64:65], v212 offset:8192
  ds_read_b64_tr_b16 v[66:67], v212 offset:8704
  v_mfma_f32_4x4x4_16b_bf16 v[4:7], v[192:193], a[88:89], v[4:7]
  v_mfma_f32_4x4x4_16b_bf16 v[8:11], a[88:89], a[88:89], v[8:11]
  v_mfma_f32_32x32x16_bf16 v[48:63], v[84:87], a[88:91], v[48:63]
  ds_read_b64_tr_b16 v[68:69], v216 offset:8192
  ds_read_b64_tr_b16 v[70:71], v216 offset:8704
  v_mfma_f32_4x4x4_16b_bf16 v[4:7], v[192:193], a[90:91], v[4:7]
  v_mfma_f32_4x4x4_16b_bf16 v[8:11], a[90:91], a[90:91], v[8:11]
  s_waitcnt lgkmcnt(5)
  v_mfma_f32_32x32x16_bf16 v[32:47], v[88:91], a[92:95], v[32:47]
  ds_read_b128 a[100:103], v209 offset:4096
  ds_read_b64_tr_b16 v[72:73], v213 offset:8192
  ds_read_b64_tr_b16 v[74:75], v213 offset:8704
  v_mfma_f32_4x4x4_16b_bf16 v[4:7], v[192:193], a[92:93], v[4:7]
  v_mfma_f32_4x4x4_16b_bf16 v[8:11], a[92:93], a[92:93], v[8:11]
  v_mfma_f32_32x32x16_bf16 v[48:63], v[92:95], a[92:95], v[48:63]
  ds_read_b64_tr_b16 v[76:77], v217 offset:8192
  ds_read_b64_tr_b16 v[78:79], v217 offset:8704
  v_mfma_f32_4x4x4_16b_bf16 v[4:7], v[192:193], a[94:95], v[4:7]
  v_mfma_f32_4x4x4_16b_bf16 v[8:11], a[94:95], a[94:95], v[8:11]
  s_waitcnt lgkmcnt(5)
  v_mfma_f32_32x32x16_bf16 v[32:47], v[64:67], a[96:99], v[32:47]
  ds_read_b128 a[104:107], v210 offset:4096
  ds_read_b64_tr_b16 v[80:81], v214 offset:8192
  ds_read_b64_tr_b16 v[82:83], v214 offset:8704
  v_mfma_f32_4x4x4_16b_bf16 v[4:7], v[192:193], a[96:97], v[4:7]
  v_mfma_f32_4x4x4_16b_bf16 v[8:11], a[96:97], a[96:97], v[8:11]
  v_mfma_f32_4x4x4_16b_bf16 v[136:139], v[192:193], v[64:65], v[136:139]
  s_nop 1
  v_mfma_f32_4x4x4_16b_bf16 v[136:139], v[192:193], v[66:67], v[136:139]
  v_mfma_f32_32x32x16_bf16 v[48:63], v[68:71], a[96:99], v[48:63]
  ds_read_b64_tr_b16 v[84:85], v218 offset:8192
  ds_read_b64_tr_b16 v[86:87], v218 offset:8704
  v_mfma_f32_4x4x4_16b_bf16 v[4:7], v[192:193], a[98:99], v[4:7]
  v_mfma_f32_4x4x4_16b_bf16 v[8:11], a[98:99], a[98:99], v[8:11]
  v_mfma_f32_4x4x4_16b_bf16 v[140:143], v[192:193], v[68:69], v[140:143]
  s_nop 1
  v_mfma_f32_4x4x4_16b_bf16 v[140:143], v[192:193], v[70:71], v[140:143]
  s_waitcnt lgkmcnt(5)
  v_mfma_f32_32x32x16_bf16 v[32:47], v[72:75], a[100:103], v[32:47]
  ds_read_b128 a[108:111], v211 offset:4096
  ds_read_b64_tr_b16 v[88:89], v215 offset:8192
  ds_read_b64_tr_b16 v[90:91], v215 offset:8704
  v_mfma_f32_4x4x4_16b_bf16 v[4:7], v[192:193], a[100:101], v[4:7]
  v_mfma_f32_4x4x4_16b_bf16 v[8:11], a[100:101], a[100:101], v[8:11]
  v_mfma_f32_32x32x16_bf16 v[48:63], v[76:79], a[100:103], v[48:63]
  ds_read_b64_tr_b16 v[92:93], v219 offset:8192
  ds_read_b64_tr_b16 v[94:95], v219 offset:8704
  v_mfma_f32_4x4x4_16b_bf16 v[4:7], v[192:193], a[102:103], v[4:7]
  v_mfma_f32_4x4x4_16b_bf16 v[8:11], a[102:103], a[102:103], v[8:11]
  s_lshl_b32 s10, s4, 2
  v_add_u32 v15, s10, v133
  v_min_u32 v136, -2, v136
  v_min_u32 v140, -2, v140
  ds_write_b32 v15, v136 offset:0
  ds_write_b32 v15, v140 offset:1024
  s_waitcnt lgkmcnt(7)
  v_mfma_f32_32x32x16_bf16 v[32:47], v[80:83], a[104:107], v[32:47]
  v_mfma_f32_4x4x4_16b_bf16 v[4:7], v[192:193], a[104:105], v[4:7]
  v_mfma_f32_4x4x4_16b_bf16 v[8:11], a[104:105], a[104:105], v[8:11]
  v_mfma_f32_32x32x16_bf16 v[48:63], v[84:87], a[104:107], v[48:63]
  v_mfma_f32_4x4x4_16b_bf16 v[4:7], v[192:193], a[106:107], v[4:7]
  v_mfma_f32_4x4x4_16b_bf16 v[8:11], a[106:107], a[106:107], v[8:11]
  ds_read_b128 v[148:151], v133 offset:0
  ds_read_b128 v[152:155], v133 offset:1024
  s_waitcnt lgkmcnt(4)
  v_mfma_f32_32x32x16_bf16 v[32:47], v[88:91], a[108:111], v[32:47]
  v_mfma_f32_4x4x4_16b_bf16 v[4:7], v[192:193], a[108:109], v[4:7]
  v_mfma_f32_4x4x4_16b_bf16 v[8:11], a[108:109], a[108:109], v[8:11]
  v_mfma_f32_32x32x16_bf16 v[48:63], v[92:95], a[108:111], v[48:63]
  v_mfma_f32_4x4x4_16b_bf16 v[4:7], v[192:193], a[110:111], v[4:7]
  v_mfma_f32_4x4x4_16b_bf16 v[8:11], a[110:111], a[110:111], v[8:11]
  v_bfe_u32 v0, v1, 2, 2
  v_xor_b32 v0, s3, v0
  v_lshl_add_u32 v0, v0, 10, v225
  buffer_load_dword v226, v0, s[36:39], 0 offen sc1
  s_nop 0
  v_cndmask_b32 v8, v8, v9, s[74:75]
  v_cndmask_b32 v10, v10, v11, s[74:75]
  s_mov_b32 s10, 0xcccccccc
  s_mov_b32 s11, 0xcccccccc
  v_cndmask_b32 v8, v8, v10, s[10:11]
  v_mov_b32 v13, v4
  s_nop 1
  v_permlane32_swap_b32 v4, v13
  v_add_f32 v4, v4, v13
  v_mov_b32 v14, v8
  s_nop 1
  v_permlane32_swap_b32 v8, v14
  v_add_f32 v8, v8, v14
  s_mov_b32 s10, 991054117
  v_mul_f32 v4, s10, v4
  v_mul_f32 v8, s10, v8
  v_fma_f32 v8, -v4, v4, v8
  v_max_f32 v8, 0, v8
  v_add_f32 v8, 925353388, v8
  v_rsq_f32 v8, v8
  v_sub_f32 v4, 0, v4
  v_and_b32 v68, 0xffff0000, v4
  v_sub_f32 v70, v4, v68
  v_and_b32 v69, 0xffff0000, v70
  v_sub_f32 v70, v70, v69
  v_perm_b32 v64, v69, v68, s100
  v_perm_b32 v65, v69, v68, s100
  v_perm_b32 v66, v68, v70, s100
  v_mov_b32 v67, 0
F_CXTL:
  s_waitcnt lgkmcnt(0)
  v_max3_u32 v0, v148, v149, v150
  v_max3_u32 v0, v0, v151, v152
  v_max3_u32 v0, v0, v153, v154
  v_max_u32 v0, v0, v155
  v_cmp_eq_u32 vcc, -1, v0
  s_nop 1
  s_cbranch_vccz F_CXTO
  ds_read_b128 v[148:151], v133 offset:0
  ds_read_b128 v[152:155], v133 offset:1024
  s_branch F_CXTL
F_CXTO:
  v_add_f32 v148, v148, v149
  v_add_f32 v150, v150, v151
  v_add_f32 v148, v148, v150
  v_and_b32 v76, 0xffff0000, v148
  v_sub_f32 v78, v148, v76
  v_and_b32 v77, 0xffff0000, v78
  v_sub_f32 v78, v78, v77
  v_perm_b32 v72, v76, v76, s100
  v_perm_b32 v73, v77, v77, s100
  v_perm_b32 v74, v78, v76, s100
  v_mov_b32 v75, 0
  s_nop 1
  v_mfma_f32_32x32x16_bf16 v[32:47], v[72:75], v[64:67], v[32:47]
  v_add_f32 v152, v152, v153
  v_add_f32 v154, v154, v155
W8:
  s_cbranch_execz W14
  v_add_f32 v152, v152, v154
  v_and_b32 v84, 0xffff0000, v152
  v_sub_f32 v86, v152, v84
  v_and_b32 v85, 0xffff0000, v86
  v_sub_f32 v86, v86, v85
  v_perm_b32 v80, v84, v84, s100
  v_perm_b32 v81, v85, v85, s100
  v_perm_b32 v82, v86, v84, s100
  v_mov_b32 v83, 0
  s_nop 1
  v_mfma_f32_32x32x16_bf16 v[48:63], v[80:83], v[64:67], v[48:63]
  v_mov_b32 v9, v8
  s_mov_b32 s10, 1049335798
  v_mul_f32 v4, s10, v8
  v_mul_f32 v5, s10, v8
  s_waitcnt lgkmcnt(0)
  v_pk_mul_f32 v[32:33], v[32:33], v[8:9]
  v_pk_mul_f32 v[34:35], v[34:35], v[8:9]
  v_pk_mul_f32 v[36:37], v[36:37], v[8:9]
  v_pk_mul_f32 v[38:39], v[38:39], v[8:9]
  v_cvt_pk_bf16_f32 v32, v32, v33
  v_cvt_pk_bf16_f32 v33, v34, v35
  v_cvt_pk_bf16_f32 v34, v36, v37
  v_cvt_pk_bf16_f32 v35, v38, v39
  v_min_u32 v32, -2, v32
  v_min_u32 v33, -2, v33
  v_min_u32 v34, -2, v34
  v_min_u32 v35, -2, v35
  buffer_store_dwordx4 v[32:35], v134, s[36:39], s14 offen offset:0 sc1
  v_pk_mul_f32 v[40:41], v[40:41], v[8:9]
  v_pk_mul_f32 v[42:43], v[42:43], v[8:9]
  v_pk_mul_f32 v[44:45], v[44:45], v[8:9]
  v_pk_mul_f32 v[46:47], v[46:47], v[8:9]
  v_cvt_pk_bf16_f32 v40, v40, v41
  v_cvt_pk_bf16_f32 v41, v42, v43
  v_cvt_pk_bf16_f32 v42, v44, v45
  v_cvt_pk_bf16_f32 v43, v46, v47
  v_min_u32 v40, -2, v40
  v_min_u32 v41, -2, v41
  v_min_u32 v42, -2, v42
  v_min_u32 v43, -2, v43
  buffer_store_dwordx4 v[40:43], v134, s[36:39], s14 offen offset:1024 sc1
  v_pk_mul_f32 v[48:49], v[48:49], v[8:9]
  v_pk_mul_f32 v[50:51], v[50:51], v[8:9]
  v_pk_mul_f32 v[52:53], v[52:53], v[8:9]
  v_pk_mul_f32 v[54:55], v[54:55], v[8:9]
  v_cvt_pk_bf16_f32 v48, v48, v49
  v_cvt_pk_bf16_f32 v49, v50, v51
  v_cvt_pk_bf16_f32 v50, v52, v53
  v_cvt_pk_bf16_f32 v51, v54, v55
  v_min_u32 v48, -2, v48
  v_min_u32 v49, -2, v49
  v_min_u32 v50, -2, v50
  v_min_u32 v51, -2, v51
  buffer_store_dwordx4 v[48:51], v135, s[36:39], s14 offen offset:0 sc1
  v_pk_mul_f32 v[56:57], v[56:57], v[8:9]
  v_pk_mul_f32 v[58:59], v[58:59], v[8:9]
  v_pk_mul_f32 v[60:61], v[60:61], v[8:9]
  v_pk_mul_f32 v[62:63], v[62:63], v[8:9]
  v_cvt_pk_bf16_f32 v56, v56, v57
  v_cvt_pk_bf16_f32 v57, v58, v59
  v_cvt_pk_bf16_f32 v58, v60, v61
  v_cvt_pk_bf16_f32 v59, v62, v63
  v_min_u32 v56, -2, v56
  v_min_u32 v57, -2, v57
  v_min_u32 v58, -2, v58
  v_min_u32 v59, -2, v59
  buffer_store_dwordx4 v[56:59], v135, s[36:39], s14 offen offset:1024 sc1
  s_branch F_Q
F_PN:
  s_lshl_b32 s10, s66, 6
  v_and_b32 v12, 31, v1
  v_lshrrev_b32 v13, 5, v1
  v_lshlrev_b32 v13, 9, v13
  s_add_u32 s13, s67, 28672
  v_add_u32 v13, s13, v13
  s_movk_i32 s13, 1600
  v_add_u32 v3, s10, v12
  v_mul_u32_u24 v14, 2341, v3
  v_lshrrev_b32 v14, 16, v14
  v_lshl_add_u32 v3, v3, 4, v13
  v_mad_u32_u24 v134, v14, s13, v3
  s_add_u32 s10, s10, 32
  v_add_u32 v3, s10, v12
  v_mul_u32_u24 v14, 2341, v3
  v_lshrrev_b32 v14, 16, v14
  v_lshl_add_u32 v3, v3, 4, v13
  v_mad_u32_u24 v135, v14, s13, v3
  s_add_u32 s10, s10, 32
  s_lshl_b32 s10, s66, 1
  s_cmp_ge_u32 s66, 4
  s_addc_u32 s10, s10, 0
  s_lshl_b32 s10, s10, 11
  s_add_u32 s10, s10, s67
  s_add_u32 s10, s10, 29120
  v_lshrrev_b32 v12, 4, v1
  v_min_u32 v12, 2, v12
  v_lshlrev_b32 v12, 11, v12
  v_bfe_u32 v3, v1, 2, 2
  v_lshl_add_u32 v12, v3, 9, v12
  v_and_b32 v3, 3, v1
  v_lshl_add_u32 v12, v3, 4, v12
  v_add_u32 v228, s10, v12
  v_cmp_eq_u32 vcc, 0, v3
  s_nop 1
  v_cndmask_b32 v196, 0, v192, vcc
  v_cndmask_b32 v197, 0, v192, vcc
  v_cndmask_b32 v198, 0, v192, vcc
  v_cndmask_b32 v199, 0, v192, vcc
  s_waitcnt vmcnt(24) lgkmcnt(0)
  s_barrier
F_BODYN:
  ds_read_b128 a[0:3], v208 offset:0
  ds_read_b64_tr_b16 v[64:65], v212 offset:0
  ds_read_b64_tr_b16 v[66:67], v212 offset:512
  ds_read_b64_tr_b16 v[68:69], v216 offset:0
  ds_read_b64_tr_b16 v[70:71], v216 offset:512
  ds_read_b128 a[4:7], v209 offset:0
  ds_read_b64_tr_b16 v[72:73], v213 offset:0
  ds_read_b64_tr_b16 v[74:75], v213 offset:512
  ds_read_b64_tr_b16 v[76:77], v217 offset:0
  ds_read_b64_tr_b16 v[78:79], v217 offset:512
  s_waitcnt lgkmcnt(5)
  v_mfma_f32_32x32x16_bf16 v[32:47], a[0:3], v[64:67], 0
  ds_read_b128 a[8:11], v210 offset:0
  ds_read_b64_tr_b16 v[80:81], v214 offset:0
  ds_read_b64_tr_b16 v[82:83], v214 offset:512
  s_add_u32 m0, s9, 12288
  s_add_u32 s10, s8, 0
  buffer_load_dwordx4 v128, s[40:43], s10 offen lds
  s_add_u32 m0, s9, 13312
  s_add_u32 s10, s8, 7168
  buffer_load_dwordx4 v128, s[40:43], s10 offen lds
  v_mfma_f32_4x4x4_16b_bf16 v[4:7], v[192:193], a[0:1], v[4:7]
  v_mfma_f32_4x4x4_16b_bf16 v[8:11], a[0:1], a[0:1], v[8:11]
  v_mfma_f32_4x4x4_16b_bf16 v[136:139], v[192:193], v[64:65], v[136:139]
  s_nop 1
  v_mfma_f32_4x4x4_16b_bf16 v[136:139], v[192:193], v[66:67], v[136:139]
  v_mfma_f32_32x32x16_bf16 v[48:63], a[0:3], v[68:71], 0
  ds_read_b64_tr_b16 v[84:85], v218 offset:0
  ds_read_b64_tr_b16 v[86:87], v218 offset:512
  s_add_u32 m0, s9, 14336
  s_add_u32 s10, s8, 14336
  buffer_load_dwordx4 v129, s[40:43], s10 offen lds
  s_add_u32 m0, s9, 15360
  s_add_u32 s10, s8, 21504
  buffer_load_dwordx4 v129, s[40:43], s10 offen lds
  s_add_u32 s8, s8, 128
  s_cmp_eq_u32 s8, s72
  s_cselect_b32 s10, 896, 0
  s_sub_u32 s8, s8, s10
  v_mfma_f32_4x4x4_16b_bf16 v[4:7], v[192:193], a[2:3], v[4:7]
  v_mfma_f32_4x4x4_16b_bf16 v[8:11], a[2:3], a[2:3], v[8:11]
  v_mfma_f32_4x4x4_16b_bf16 v[140:143], v[192:193], v[68:69], v[140:143]
  s_nop 1
  v_mfma_f32_4x4x4_16b_bf16 v[140:143], v[192:193], v[70:71], v[140:143]
  s_waitcnt lgkmcnt(5)
  v_mfma_f32_32x32x16_bf16 v[32:47], a[4:7], v[72:75], v[32:47]
  ds_read_b128 a[12:15], v211 offset:0
  ds_read_b64_tr_b16 v[88:89], v215 offset:0
  ds_read_b64_tr_b16 v[90:91], v215 offset:512
W9:
  s_cbranch_execz W11
  s_add_u32 m0, s12, 24576
  s_nop 0
  buffer_load_dwordx4 v130, s[44:47], s11 offen lds
  s_add_u32 m0, s12, 25600
  s_nop 0
  buffer_load_dwordx4 v131, s[44:47], s11 offen lds
  s_add_u32 s11, s11, 172032
  s_cmp_eq_u32 s11, s73
  s_cselect_b32 s10, 1204224, 0
  s_sub_u32 s11, s11, s10
  v_mfma_f32_4x4x4_16b_bf16 v[4:7], v[192:193], a[4:5], v[4:7]
  v_mfma_f32_4x4x4_16b_bf16 v[8:11], a[4:5], a[4:5], v[8:11]
  v_mfma_f32_32x32x16_bf16 v[48:63], a[4:7], v[76:79], v[48:63]
  ds_read_b64_tr_b16 v[92:93], v219 offset:0
  ds_read_b64_tr_b16 v[94:95], v219 offset:512
  buffer_store_dwordx4 v[196:199], v228, s[36:39], s14 offen sc1
  buffer_store_dwordx4 v[236:239], v134, s[36:39], s14 offen offset:0 sc1
  v_mfma_f32_4x4x4_16b_bf16 v[4:7], v[192:193], a[6:7], v[4:7]
  v_mfma_f32_4x4x4_16b_bf16 v[8:11], a[6:7], a[6:7], v[8:11]
  s_waitcnt vmcnt(20) lgkmcnt(0)
  s_barrier
  v_mfma_f32_32x32x16_bf16 v[32:47], a[8:11], v[80:83], v[32:47]
  ds_read_b128 a[16:19], v208 offset:4096
  ds_read_b64_tr_b16 v[64:65], v212 offset:8192
  ds_read_b64_tr_b16 v[66:67], v212 offset:8704
  buffer_store_dwordx4 v[236:239], v134, s[36:39], s14 offen offset:1024 sc1
  buffer_store_dwordx4 v[236:239], v135, s[36:39], s14 offen offset:0 sc1
  v_mfma_f32_4x4x4_16b_bf16 v[4:7], v[192:193], a[8:9], v[4:7]
  v_mfma_f32_4x4x4_16b_bf16 v[8:11], a[8:9], a[8:9], v[8:11]
  v_mfma_f32_32x32x16_bf16 v[48:63], a[8:11], v[84:87], v[48:63]
  ds_read_b64_tr_b16 v[68:69], v216 offset:8192
  ds_read_b64_tr_b16 v[70:71], v216 offset:8704
  buffer_store_dwordx4 v[236:239], v135, s[36:39], s14 offen offset:1024 sc1
  s_add_u32 m0, s9, 16384
  s_add_u32 s10, s8, 0
  buffer_load_dwordx4 v128, s[40:43], s10 offen lds
  v_mfma_f32_4x4x4_16b_bf16 v[4:7], v[192:193], a[10:11], v[4:7]
  v_mfma_f32_4x4x4_16b_bf16 v[8:11], a[10:11], a[10:11], v[8:11]
  s_waitcnt lgkmcnt(5)
  v_mfma_f32_32x32x16_bf16 v[32:47], a[12:15], v[88:91], v[32:47]
  ds_read_b128 a[20:23], v209 offset:4096
  ds_read_b64_tr_b16 v[72:73], v213 offset:8192
  ds_read_b64_tr_b16 v[74:75], v213 offset:8704
  s_add_u32 m0, s9, 17408
  s_add_u32 s10, s8, 7168
  buffer_load_dwordx4 v128, s[40:43], s10 offen lds
  s_add_u32 m0, s9, 18432
  s_add_u32 s10, s8, 14336
  buffer_load_dwordx4 v129, s[40:43], s10 offen lds
  v_mfma_f32_4x4x4_16b_bf16 v[4:7], v[192:193], a[12:13], v[4:7]
  v_mfma_f32_4x4x4_16b_bf16 v[8:11], a[12:13], a[12:13], v[8:11]
  v_mfma_f32_32x32x16_bf16 v[48:63], a[12:15], v[92:95], v[48:63]
  ds_read_b64_tr_b16 v[76:77], v217 offset:8192
  ds_read_b64_tr_b16 v[78:79], v217 offset:8704
  s_add_u32 m0, s9, 19456
  s_add_u32 s10, s8, 21504
  buffer_load_dwordx4 v129, s[40:43], s10 offen lds
  s_add_u32 s8, s8, 128
  s_cmp_eq_u32 s8, s72
  s_cselect_b32 s10, 896, 0
  s_sub_u32 s8, s8, s10
  s_add_u32 m0, s12, 32768
  s_nop 0
  buffer_load_dwordx4 v130, s[44:47], s11 offen lds
  v_mfma_f32_4x4x4_16b_bf16 v[4:7], v[192:193], a[14:15], v[4:7]
  v_mfma_f32_4x4x4_16b_bf16 v[8:11], a[14:15], a[14:15], v[8:11]
  s_waitcnt lgkmcnt(5)
  v_mfma_f32_32x32x16_bf16 v[32:47], a[16:19], v[64:67], v[32:47]
  ds_read_b128 a[24:27], v210 offset:4096
  ds_read_b64_tr_b16 v[80:81], v214 offset:8192
  ds_read_b64_tr_b16 v[82:83], v214 offset:8704
  s_add_u32 m0, s12, 33792
  s_nop 0
  buffer_load_dwordx4 v131, s[44:47], s11 offen lds
  s_add_u32 s11, s11, 172032
  s_cmp_eq_u32 s11, s73
  s_cselect_b32 s10, 1204224, 0
  s_sub_u32 s11, s11, s10
  s_add_u32 m0, s9, 0
  s_add_u32 s10, s8, 0
  buffer_load_dwordx4 v128, s[40:43], s10 offen lds
  v_mfma_f32_4x4x4_16b_bf16 v[4:7], v[192:193], a[16:17], v[4:7]
  v_mfma_f32_4x4x4_16b_bf16 v[8:11], a[16:17], a[16:17], v[8:11]
  v_mfma_f32_4x4x4_16b_bf16 v[136:139], v[192:193], v[64:65], v[136:139]
  s_nop 1
  v_mfma_f32_4x4x4_16b_bf16 v[136:139], v[192:193], v[66:67], v[136:139]
  v_mfma_f32_32x32x16_bf16 v[48:63], a[16:19], v[68:71], v[48:63]
  ds_read_b64_tr_b16 v[84:85], v218 offset:8192
  ds_read_b64_tr_b16 v[86:87], v218 offset:8704
  s_add_u32 m0, s9, 1024
  s_add_u32 s10, s8, 7168
  buffer_load_dwordx4 v128, s[40:43], s10 offen lds
  s_add_u32 m0, s9, 2048
  s_add_u32 s10, s8, 14336
  buffer_load_dwordx4 v129, s[40:43], s10 offen lds
  v_mfma_f32_4x4x4_16b_bf16 v[4:7], v[192:193], a[18:19], v[4:7]
  v_mfma_f32_4x4x4_16b_bf16 v[8:11], a[18:19], a[18:19], v[8:11]
  v_mfma_f32_4x4x4_16b_bf16 v[140:143], v[192:193], v[68:69], v[140:143]
  s_nop 1
  v_mfma_f32_4x4x4_16b_bf16 v[140:143], v[192:193], v[70:71], v[140:143]
  s_waitcnt lgkmcnt(5)
  v_mfma_f32_32x32x16_bf16 v[32:47], a[20:23], v[72:75], v[32:47]
  ds_read_b128 a[28:31], v211 offset:4096
  ds_read_b64_tr_b16 v[88:89], v215 offset:8192
  ds_read_b64_tr_b16 v[90:91], v215 offset:8704
  s_add_u32 m0, s9, 3072
  s_add_u32 s10, s8, 21504
  buffer_load_dwordx4 v129, s[40:43], s10 offen lds
  s_add_u32 s8, s8, 128
  s_cmp_eq_u32 s8, s72
  s_cselect_b32 s10, 896, 0
  s_sub_u32 s8, s8, s10
  s_add_u32 m0, s12, 0
  s_nop 0
  buffer_load_dwordx4 v130, s[44:47], s11 offen lds
  v_mfma_f32_4x4x4_16b_bf16 v[4:7], v[192:193], a[20:21], v[4:7]
  v_mfma_f32_4x4x4_16b_bf16 v[8:11], a[20:21], a[20:21], v[8:11]
  v_mfma_f32_32x32x16_bf16 v[48:63], a[20:23], v[76:79], v[48:63]
  ds_read_b64_tr_b16 v[92:93], v219 offset:8192
  ds_read_b64_tr_b16 v[94:95], v219 offset:8704
  s_add_u32 m0, s12, 1024
  s_nop 0
  buffer_load_dwordx4 v131, s[44:47], s11 offen lds
  s_add_u32 s11, s11, 172032
  s_cmp_eq_u32 s11, s73
  s_cselect_b32 s10, 1204224, 0
  s_sub_u32 s11, s11, s10
  v_mfma_f32_4x4x4_16b_bf16 v[4:7], v[192:193], a[22:23], v[4:7]
  v_mfma_f32_4x4x4_16b_bf16 v[8:11], a[22:23], a[22:23], v[8:11]
  s_waitcnt vmcnt(23) lgkmcnt(0)
  s_barrier
  s_mov_b64 exec, s[60:61]
  global_load_dword v227, v2, s[30:31] sc1
  s_mov_b64 exec, -1
  v_mfma_f32_32x32x16_bf16 v[32:47], a[24:27], v[80:83], v[32:47]
  ds_read_b128 a[32:35], v208 offset:8192
  ds_read_b64_tr_b16 v[64:65], v212 offset:16384
  ds_read_b64_tr_b16 v[66:67], v212 offset:16896
  s_add_u32 m0, s9, 4096
  s_add_u32 s10, s8, 0
  buffer_load_dwordx4 v128, s[40:43], s10 offen lds
  s_add_u32 m0, s9, 5120
  s_add_u32 s10, s8, 7168
  buffer_load_dwordx4 v128, s[40:43], s10 offen lds
W10:
  s_cbranch_execz W12
  v_mfma_f32_4x4x4_16b_bf16 v[4:7], v[192:193], a[24:25], v[4:7]
  v_mfma_f32_4x4x4_16b_bf16 v[8:11], a[24:25], a[24:25], v[8:11]
  v_mfma_f32_32x32x16_bf16 v[48:63], a[24:27], v[84:87], v[48:63]
  ds_read_b64_tr_b16 v[68:69], v216 offset:16384
  ds_read_b64_tr_b16 v[70:71], v216 offset:16896
  s_add_u32 m0, s9, 6144
  s_add_u32 s10, s8, 14336
  buffer_load_dwordx4 v129, s[40:43], s10 offen lds
  s_add_u32 m0, s9, 7168
  s_add_u32 s10, s8, 21504
  buffer_load_dwordx4 v129, s[40:43], s10 offen lds
  s_add_u32 s8, s8, 128
  s_cmp_eq_u32 s8, s72
  s_cselect_b32 s10, 896, 0
  s_sub_u32 s8, s8, s10
  v_mfma_f32_4x4x4_16b_bf16 v[4:7], v[192:193], a[26:27], v[4:7]
  v_mfma_f32_4x4x4_16b_bf16 v[8:11], a[26:27], a[26:27], v[8:11]
  s_waitcnt lgkmcnt(5)
  v_mfma_f32_32x32x16_bf16 v[32:47], a[28:31], v[88:91], v[32:47]
  ds_read_b128 a[36:39], v209 offset:8192
  ds_read_b64_tr_b16 v[72:73], v213 offset:16384
  ds_read_b64_tr_b16 v[74:75], v213 offset:16896
  s_add_u32 m0, s12, 8192
  s_nop 0
  buffer_load_dwordx4 v130, s[44:47], s11 offen lds
  s_add_u32 m0, s12, 9216
  s_nop 0
  buffer_load_dwordx4 v131, s[44:47], s11 offen lds
  s_add_u32 s11, s11, 172032
  s_cmp_eq_u32 s11, s73
  s_cselect_b32 s10, 1204224, 0
  s_sub_u32 s11, s11, s10
  v_mfma_f32_4x4x4_16b_bf16 v[4:7], v[192:193], a[28:29], v[4:7]
  v_mfma_f32_4x4x4_16b_bf16 v[8:11], a[28:29], a[28:29], v[8:11]
  v_mfma_f32_32x32x16_bf16 v[48:63], a[28:31], v[92:95], v[48:63]
  ds_read_b64_tr_b16 v[76:77], v217 offset:16384
  ds_read_b64_tr_b16 v[78:79], v217 offset:16896
  s_add_u32 m0, s65, 0
  s_nop 0
  buffer_load_dwordx4 v132, s[44:47], s71 offen lds
  s_add_u32 s71, s71, 172032
  s_cmp_eq_u32 s71, s73
  s_cselect_b32 s10, 1204224, 0
  s_sub_u32 s71, s71, s10
  s_add_u32 m0, s65, 4096
  s_nop 0
  buffer_load_dwordx4 v132, s[44:47], s71 offen lds
  s_add_u32 s71, s71, 172032
  s_cmp_eq_u32 s71, s73
  s_cselect_b32 s10, 1204224, 0
  s_sub_u32 s71, s71, s10
  v_mfma_f32_4x4x4_16b_bf16 v[4:7], v[192:193], a[30:31], v[4:7]
  v_mfma_f32_4x4x4_16b_bf16 v[8:11], a[30:31], a[30:31], v[8:11]
  s_waitcnt lgkmcnt(5)
  v_mfma_f32_32x32x16_bf16 v[32:47], a[32:35], v[64:67], v[32:47]
  ds_read_b128 a[40:43], v210 offset:8192
  ds_read_b64_tr_b16 v[80:81], v214 offset:16384
  ds_read_b64_tr_b16 v[82:83], v214 offset:16896
  s_add_u32 m0, s65, 8192
  s_nop 0
  buffer_load_dwordx4 v132, s[44:47], s71 offen lds
  s_add_u32 s71, s71, 172032
  s_cmp_eq_u32 s71, s73
  s_cselect_b32 s10, 1204224, 0
  s_sub_u32 s71, s71, s10
  s_add_u32 m0, s65, 12288
  s_nop 0
  buffer_load_dwordx4 v132, s[44:47], s71 offen lds
  s_add_u32 s71, s71, 172032
  s_cmp_eq_u32 s71, s73
  s_cselect_b32 s10, 1204224, 0
  s_sub_u32 s71, s71, s10
  v_mfma_f32_4x4x4_16b_bf16 v[4:7], v[192:193], a[32:33], v[4:7]
  v_mfma_f32_4x4x4_16b_bf16 v[8:11], a[32:33], a[32:33], v[8:11]
  v_mfma_f32_4x4x4_16b_bf16 v[136:139], v[192:193], v[64:65], v[136:139]
  s_nop 1
  v_mfma_f32_4x4x4_16b_bf16 v[136:139], v[192:193], v[66:67], v[136:139]
  v_mfma_f32_32x32x16_bf16 v[48:63], a[32:35], v[68:71], v[48:63]
  ds_read_b64_tr_b16 v[84:85], v218 offset:16384
  ds_read_b64_tr_b16 v[86:87], v218 offset:16896
  s_add_u32 m0, s65, 16384
  s_nop 0
  buffer_load_dwordx4 v132, s[44:47], s71 offen lds
  s_add_u32 s71, s71, 172032
  s_cmp_eq_u32 s71, s73
  s_cselect_b32 s10, 1204224, 0
  s_sub_u32 s71, s71, s10
  s_add_u32 m0, s65, 20480
  s_nop 0
  buffer_load_dwordx4 v132, s[44:47], s71 offen lds
  s_add_u32 s71, s71, 172032
  s_cmp_eq_u32 s71, s73
  s_cselect_b32 s10, 1204224, 0
  s_sub_u32 s71, s71, s10
  v_mfma_f32_4x4x4_16b_bf16 v[4:7], v[192:193], a[34:35], v[4:7]
  v_mfma_f32_4x4x4_16b_bf16 v[8:11], a[34:35], a[34:35], v[8:11]
  v_mfma_f32_4x4x4_16b_bf16 v[140:143], v[192:193], v[68:69], v[140:143]
  s_nop 1
  v_mfma_f32_4x4x4_16b_bf16 v[140:143], v[192:193], v[70:71], v[140:143]
  s_waitcnt lgkmcnt(5)
  v_mfma_f32_32x32x16_bf16 v[32:47], a[36:39], v[72:75], v[32:47]
  ds_read_b128 a[44:47], v211 offset:8192
  ds_read_b64_tr_b16 v[88:89], v215 offset:16384
  ds_read_b64_tr_b16 v[90:91], v215 offset:16896
  s_add_u32 m0, s65, 24576
  s_nop 0
  buffer_load_dwordx4 v132, s[44:47], s71 offen lds
  s_add_u32 s71, s71, 172032
  s_cmp_eq_u32 s71, s73
  s_cselect_b32 s10, 1204224, 0
  s_sub_u32 s71, s71, s10
  v_mfma_f32_4x4x4_16b_bf16 v[4:7], v[192:193], a[36:37], v[4:7]
  v_mfma_f32_4x4x4_16b_bf16 v[8:11], a[36:37], a[36:37], v[8:11]
  v_mfma_f32_32x32x16_bf16 v[48:63], a[36:39], v[76:79], v[48:63]
  ds_read_b64_tr_b16 v[92:93], v219 offset:16384
  ds_read_b64_tr_b16 v[94:95], v219 offset:16896
  v_mfma_f32_4x4x4_16b_bf16 v[4:7], v[192:193], a[38:39], v[4:7]
  v_mfma_f32_4x4x4_16b_bf16 v[8:11], a[38:39], a[38:39], v[8:11]
  s_waitcnt vmcnt(13) lgkmcnt(0)
  s_barrier
  s_cmp_lg_u32 s4, 0
  s_cbranch_scc1 F_NQN
  s_mov_b64 exec, s[60:61]
  v_cmp_eq_u32 vcc, 0, v227
  s_nop 1
  s_cbranch_vccnz F_NQN
  s_mov_b64 exec, 1
  buffer_store_dword v2, v2, s[36:39], s69 offen sc1
  s_mov_b32 s60, 0
F_NQN:
  s_mov_b64 exec, s[60:61]
  global_load_dword v227, v2, s[30:31] sc1
  s_mov_b64 exec, -1
  v_mfma_f32_32x32x16_bf16 v[32:47], a[40:43], v[80:83], v[32:47]
  ds_read_b128 a[48:51], v208 offset:12288
  ds_read_b64_tr_b16 v[64:65], v212 offset:24576
  ds_read_b64_tr_b16 v[66:67], v212 offset:25088
  v_mfma_f32_4x4x4_16b_bf16 v[4:7], v[192:193], a[40:41], v[4:7]
  v_mfma_f32_4x4x4_16b_bf16 v[8:11], a[40:41], a[40:41], v[8:11]
  v_mfma_f32_32x32x16_bf16 v[48:63], a[40:43], v[84:87], v[48:63]
  ds_read_b64_tr_b16 v[68:69], v216 offset:24576
  ds_read_b64_tr_b16 v[70:71], v216 offset:25088
  v_mfma_f32_4x4x4_16b_bf16 v[4:7], v[192:193], a[42:43], v[4:7]
  v_mfma_f32_4x4x4_16b_bf16 v[8:11], a[42:43], a[42:43], v[8:11]
  s_waitcnt lgkmcnt(5)
  v_mfma_f32_32x32x16_bf16 v[32:47], a[44:47], v[88:91], v[32:47]
  ds_read_b128 a[52:55], v209 offset:12288
  ds_read_b64_tr_b16 v[72:73], v213 offset:24576
  ds_read_b64_tr_b16 v[74:75], v213 offset:25088
  v_mfma_f32_4x4x4_16b_bf16 v[4:7], v[192:193], a[44:45], v[4:7]
  v_mfma_f32_4x4x4_16b_bf16 v[8:11], a[44:45], a[44:45], v[8:11]
W11:
  s_cbranch_execz W13
  v_mfma_f32_32x32x16_bf16 v[48:63], a[44:47], v[92:95], v[48:63]
  ds_read_b64_tr_b16 v[76:77], v217 offset:24576
  ds_read_b64_tr_b16 v[78:79], v217 offset:25088
  v_mfma_f32_4x4x4_16b_bf16 v[4:7], v[192:193], a[46:47], v[4:7]
  v_mfma_f32_4x4x4_16b_bf16 v[8:11], a[46:47], a[46:47], v[8:11]
  s_waitcnt lgkmcnt(5)
  v_mfma_f32_32x32x16_bf16 v[32:47], a[48:51], v[64:67], v[32:47]
  ds_read_b128 a[56:59], v210 offset:12288
  ds_read_b64_tr_b16 v[80:81], v214 offset:24576
  ds_read_b64_tr_b16 v[82:83], v214 offset:25088
  s_add_u32 m0, s101, 0
  s_nop 0
  buffer_load_dwordx4 v200, s[48:51], 0 offen lds
  s_add_u32 m0, s101, 1024
  s_nop 0
  buffer_load_dwordx4 v201, s[48:51], 0 offen lds
  v_mfma_f32_4x4x4_16b_bf16 v[4:7], v[192:193], a[48:49], v[4:7]
  v_mfma_f32_4x4x4_16b_bf16 v[8:11], a[48:49], a[48:49], v[8:11]
  v_mfma_f32_4x4x4_16b_bf16 v[136:139], v[192:193], v[64:65], v[136:139]
  s_nop 1
  v_mfma_f32_4x4x4_16b_bf16 v[136:139], v[192:193], v[66:67], v[136:139]
  v_mfma_f32_32x32x16_bf16 v[48:63], a[48:51], v[68:71], v[48:63]
  ds_read_b64_tr_b16 v[84:85], v218 offset:24576
  ds_read_b64_tr_b16 v[86:87], v218 offset:25088
  s_add_u32 m0, s101, 2048
  s_nop 0
  buffer_load_dwordx4 v202, s[48:51], 0 offen lds
  s_add_u32 m0, s101, 3072
  s_nop 0
  buffer_load_dwordx4 v203, s[48:51], 0 offen lds
  v_mfma_f32_4x4x4_16b_bf16 v[4:7], v[192:193], a[50:51], v[4:7]
  v_mfma_f32_4x4x4_16b_bf16 v[8:11], a[50:51], a[50:51], v[8:11]
  v_mfma_f32_4x4x4_16b_bf16 v[140:143], v[192:193], v[68:69], v[140:143]
  s_nop 1
  v_mfma_f32_4x4x4_16b_bf16 v[140:143], v[192:193], v[70:71], v[140:143]
  s_waitcnt lgkmcnt(5)
  v_mfma_f32_32x32x16_bf16 v[32:47], a[52:55], v[72:75], v[32:47]
  ds_read_b128 a[60:63], v211 offset:12288
  ds_read_b64_tr_b16 v[88:89], v215 offset:24576
  ds_read_b64_tr_b16 v[90:91], v215 offset:25088
  v_mfma_f32_4x4x4_16b_bf16 v[4:7], v[192:193], a[52:53], v[4:7]
  v_mfma_f32_4x4x4_16b_bf16 v[8:11], a[52:53], a[52:53], v[8:11]
  v_mfma_f32_32x32x16_bf16 v[48:63], a[52:55], v[76:79], v[48:63]
  ds_read_b64_tr_b16 v[92:93], v219 offset:24576
  ds_read_b64_tr_b16 v[94:95], v219 offset:25088
  v_mfma_f32_4x4x4_16b_bf16 v[4:7], v[192:193], a[54:55], v[4:7]
  v_mfma_f32_4x4x4_16b_bf16 v[8:11], a[54:55], a[54:55], v[8:11]
  s_waitcnt vmcnt(25) lgkmcnt(0)
  s_barrier
  s_cmp_eq_u32 s60, 0
  s_cbranch_scc1 F_NPN
  s_mov_b64 exec, s[60:61]
  s_movk_i32 s13, 2000
  s_waitcnt vmcnt(4)
F_L0N:
  v_cmp_eq_u32 vcc, 0, v227
  s_nop 1
  s_cbranch_vccz F_L0KN
  s_sleep 8
  global_load_dword v227, v2, s[30:31] sc1
  s_sub_u32 s13, s13, 1
  s_cmp_eq_u32 s13, 0
  s_cbranch_scc1 P_END
  s_waitcnt vmcnt(0)
  s_branch F_L0N
F_L0KN:
  s_mov_b64 exec, 1
  buffer_store_dword v2, v2, s[36:39], s69 offen sc1
  s_mov_b64 exec, -1
F_NPN:
  v_mfma_f32_32x32x16_bf16 v[32:47], a[56:59], v[80:83], v[32:47]
  ds_read_b128 a[64:67], v208 offset:16384
  ds_read_b64_tr_b16 v[64:65], v212 offset:32768
  ds_read_b64_tr_b16 v[66:67], v212 offset:33280
  v_mfma_f32_4x4x4_16b_bf16 v[4:7], v[192:193], a[56:57], v[4:7]
  v_mfma_f32_4x4x4_16b_bf16 v[8:11], a[56:57], a[56:57], v[8:11]
  v_mfma_f32_32x32x16_bf16 v[48:63], a[56:59], v[84:87], v[48:63]
  ds_read_b64_tr_b16 v[68:69], v216 offset:32768
  ds_read_b64_tr_b16 v[70:71], v216 offset:33280
  v_mfma_f32_4x4x4_16b_bf16 v[4:7], v[192:193], a[58:59], v[4:7]
  v_mfma_f32_4x4x4_16b_bf16 v[8:11], a[58:59], a[58:59], v[8:11]
  s_waitcnt lgkmcnt(5)
  v_mfma_f32_32x32x16_bf16 v[32:47], a[60:63], v[88:91], v[32:47]
  ds_read_b128 a[68:71], v209 offset:16384
  ds_read_b64_tr_b16 v[72:73], v213 offset:32768
  ds_read_b64_tr_b16 v[74:75], v213 offset:33280
  v_mfma_f32_4x4x4_16b_bf16 v[4:7], v[192:193], a[60:61], v[4:7]
  v_mfma_f32_4x4x4_16b_bf16 v[8:11], a[60:61], a[60:61], v[8:11]
  v_mfma_f32_32x32x16_bf16 v[48:63], a[60:63], v[92:95], v[48:63]
  ds_read_b64_tr_b16 v[76:77], v217 offset:32768
  ds_read_b64_tr_b16 v[78:79], v217 offset:33280
  v_mfma_f32_4x4x4_16b_bf16 v[4:7], v[192:193], a[62:63], v[4:7]
  v_mfma_f32_4x4x4_16b_bf16 v[8:11], a[62:63], a[62:63], v[8:11]
  s_waitcnt lgkmcnt(5)
  v_mfma_f32_32x32x16_bf16 v[32:47], a[64:67], v[64:67], v[32:47]
  ds_read_b128 a[72:75], v210 offset:16384
  ds_read_b64_tr_b16 v[80:81], v214 offset:32768
  ds_read_b64_tr_b16 v[82:83], v214 offset:33280
  v_mfma_f32_4x4x4_16b_bf16 v[4:7], v[192:193], a[64:65], v[4:7]
  v_mfma_f32_4x4x4_16b_bf16 v[8:11], a[64:65], a[64:65], v[8:11]
  v_mfma_f32_4x4x4_16b_bf16 v[136:139], v[192:193], v[64:65], v[136:139]
  s_nop 1
  v_mfma_f32_4x4x4_16b_bf16 v[136:139], v[192:193], v[66:67], v[136:139]
  v_mfma_f32_32x32x16_bf16 v[48:63], a[64:67], v[68:71], v[48:63]
  ds_read_b64_tr_b16 v[84:85], v218 offset:32768
  ds_read_b64_tr_b16 v[86:87], v218 offset:33280
  v_mfma_f32_4x4x4_16b_bf16 v[4:7], v[192:193], a[66:67], v[4:7]
  v_mfma_f32_4x4x4_16b_bf16 v[8:11], a[66:67], a[66:67], v[8:11]
  v_mfma_f32_4x4x4_16b_bf16 v[140:143], v[192:193], v[68:69], v[140:143]
  s_nop 1
  v_mfma_f32_4x4x4_16b_bf16 v[140:143], v[192:193], v[70:71], v[140:143]
  s_waitcnt lgkmcnt(5)
  v_mfma_f32_32x32x16_bf16 v[32:47], a[68:71], v[72:75], v[32:47]
  ds_read_b128 a[76:79], v211 offset:16384
  ds_read_b64_tr_b16 v[88:89], v215 offset:32768
  ds_read_b64_tr_b16 v[90:91], v215 offset:33280
  v_mfma_f32_4x4x4_16b_bf16 v[4:7], v[192:193], a[68:69], v[4:7]
  v_mfma_f32_4x4x4_16b_bf16 v[8:11], a[68:69], a[68:69], v[8:11]
  v_mfma_f32_32x32x16_bf16 v[48:63], a[68:71], v[76:79], v[48:63]
  ds_read_b64_tr_b16 v[92:93], v219 offset:32768
  ds_read_b64_tr_b16 v[94:95], v219 offset:33280
  v_mfma_f32_4x4x4_16b_bf16 v[4:7], v[192:193], a[70:71], v[4:7]
  v_mfma_f32_4x4x4_16b_bf16 v[8:11], a[70:71], a[70:71], v[8:11]
  s_waitcnt vmcnt(5) lgkmcnt(0)
  s_barrier
  v_mfma_f32_32x32x16_bf16 v[32:47], a[72:75], v[80:83], v[32:47]
  ds_read_b128 a[80:83], v208 offset:0
  ds_read_b64_tr_b16 v[64:65], v212 offset:0
  ds_read_b64_tr_b16 v[66:67], v212 offset:512
  v_mfma_f32_4x4x4_16b_bf16 v[4:7], v[192:193], a[72:73], v[4:7]
  v_mfma_f32_4x4x4_16b_bf16 v[8:11], a[72:73], a[72:73], v[8:11]
  v_mfma_f32_32x32x16_bf16 v[48:63], a[72:75], v[84:87], v[48:63]
  ds_read_b64_tr_b16 v[68:69], v216 offset:0
  ds_read_b64_tr_b16 v[70:71], v216 offset:512
  v_mfma_f32_4x4x4_16b_bf16 v[4:7], v[192:193], a[74:75], v[4:7]
  v_mfma_f32_4x4x4_16b_bf16 v[8:11], a[74:75], a[74:75], v[8:11]
  s_waitcnt lgkmcnt(5)
  v_mfma_f32_32x32x16_bf16 v[32:47], a[76:79], v[88:91], v[32:47]
  ds_read_b128 a[84:87], v209 offset:0
  ds_read_b64_tr_b16 v[72:73], v213 offset:0
  ds_read_b64_tr_b16 v[74:75], v213 offset:512
  v_mfma_f32_4x4x4_16b_bf16 v[4:7], v[192:193], a[76:77], v[4:7]
  v_mfma_f32_4x4x4_16b_bf16 v[8:11], a[76:77], a[76:77], v[8:11]
  v_mfma_f32_32x32x16_bf16 v[48:63], a[76:79], v[92:95], v[48:63]
  ds_read_b64_tr_b16 v[76:77], v217 offset:0
  ds_read_b64_tr_b16 v[78:79], v217 offset:512
  v_mfma_f32_4x4x4_16b_bf16 v[4:7], v[192:193], a[78:79], v[4:7]
  v_mfma_f32_4x4x4_16b_bf16 v[8:11], a[78:79], a[78:79], v[8:11]
W12:
  s_cbranch_execz W15
  s_waitcnt lgkmcnt(5)
  v_mfma_f32_32x32x16_bf16 v[32:47], a[80:83], v[64:67], v[32:47]
  ds_read_b128 a[88:91], v210 offset:0
  ds_read_b64_tr_b16 v[80:81], v214 offset:0
  ds_read_b64_tr_b16 v[82:83], v214 offset:512
  v_mfma_f32_4x4x4_16b_bf16 v[4:7], v[192:193], a[80:81], v[4:7]
  v_mfma_f32_4x4x4_16b_bf16 v[8:11], a[80:81], a[80:81], v[8:11]
  v_mfma_f32_4x4x4_16b_bf16 v[136:139], v[192:193], v[64:65], v[136:139]
  s_nop 1
  v_mfma_f32_4x4x4_16b_bf16 v[136:139], v[192:193], v[66:67], v[136:139]
  v_mfma_f32_32x32x16_bf16 v[48:63], a[80:83], v[68:71], v[48:63]
  ds_read_b64_tr_b16 v[84:85], v218 offset:0
  ds_read_b64_tr_b16 v[86:87], v218 offset:512
  v_mfma_f32_4x4x4_16b_bf16 v[4:7], v[192:193], a[82:83], v[4:7]
  v_mfma_f32_4x4x4_16b_bf16 v[8:11], a[82:83], a[82:83], v[8:11]
  v_mfma_f32_4x4x4_16b_bf16 v[140:143], v[192:193], v[68:69], v[140:143]
  s_nop 1
  v_mfma_f32_4x4x4_16b_bf16 v[140:143], v[192:193], v[70:71], v[140:143]
  s_waitcnt lgkmcnt(5)
  v_mfma_f32_32x32x16_bf16 v[32:47], a[84:87], v[72:75], v[32:47]
  ds_read_b128 a[92:95], v211 offset:0
  ds_read_b64_tr_b16 v[88:89], v215 offset:0
  ds_read_b64_tr_b16 v[90:91], v215 offset:512
  v_mfma_f32_4x4x4_16b_bf16 v[4:7], v[192:193], a[84:85], v[4:7]
  v_mfma_f32_4x4x4_16b_bf16 v[8:11], a[84:85], a[84:85], v[8:11]
  v_mfma_f32_32x32x16_bf16 v[48:63], a[84:87], v[76:79], v[48:63]
  ds_read_b64_tr_b16 v[92:93], v219 offset:0
  ds_read_b64_tr_b16 v[94:95], v219 offset:512
  v_mfma_f32_4x4x4_16b_bf16 v[4:7], v[192:193], a[86:87], v[4:7]
  v_mfma_f32_4x4x4_16b_bf16 v[8:11], a[86:87], a[86:87], v[8:11]
  s_waitcnt lgkmcnt(5)
  v_mfma_f32_32x32x16_bf16 v[32:47], a[88:91], v[80:83], v[32:47]
  ds_read_b128 a[96:99], v208 offset:4096
  ds_read_b64_tr_b16 v[64:65], v212 offset:8192
  ds_read_b64_tr_b16 v[66:67], v212 offset:8704
  v_mfma_f32_4x4x4_16b_bf16 v[4:7], v[192:193], a[88:89], v[4:7]
  v_mfma_f32_4x4x4_16b_bf16 v[8:11], a[88:89], a[88:89], v[8:11]
  v_mfma_f32_32x32x16_bf16 v[48:63], a[88:91], v[84:87], v[48:63]
  ds_read_b64_tr_b16 v[68:69], v216 offset:8192
  ds_read_b64_tr_b16 v[70:71], v216 offset:8704
  v_mfma_f32_4x4x4_16b_bf16 v[4:7], v[192:193], a[90:91], v[4:7]
  v_mfma_f32_4x4x4_16b_bf16 v[8:11], a[90:91], a[90:91], v[8:11]
  s_waitcnt lgkmcnt(5)
  v_mfma_f32_32x32x16_bf16 v[32:47], a[92:95], v[88:91], v[32:47]
  ds_read_b128 a[100:103], v209 offset:4096
  ds_read_b64_tr_b16 v[72:73], v213 offset:8192
  ds_read_b64_tr_b16 v[74:75], v213 offset:8704
  v_mfma_f32_4x4x4_16b_bf16 v[4:7], v[192:193], a[92:93], v[4:7]
  v_mfma_f32_4x4x4_16b_bf16 v[8:11], a[92:93], a[92:93], v[8:11]
  v_mfma_f32_32x32x16_bf16 v[48:63], a[92:95], v[92:95], v[48:63]
  ds_read_b64_tr_b16 v[76:77], v217 offset:8192
  ds_read_b64_tr_b16 v[78:79], v217 offset:8704
  v_mfma_f32_4x4x4_16b_bf16 v[4:7], v[192:193], a[94:95], v[4:7]
  v_mfma_f32_4x4x4_16b_bf16 v[8:11], a[94:95], a[94:95], v[8:11]
  s_waitcnt lgkmcnt(5)
  v_mfma_f32_32x32x16_bf16 v[32:47], a[96:99], v[64:67], v[32:47]
  ds_read_b128 a[104:107], v210 offset:4096
  ds_read_b64_tr_b16 v[80:81], v214 offset:8192
  ds_read_b64_tr_b16 v[82:83], v214 offset:8704
  v_mfma_f32_4x4x4_16b_bf16 v[4:7], v[192:193], a[96:97], v[4:7]
  v_mfma_f32_4x4x4_16b_bf16 v[8:11], a[96:97], a[96:97], v[8:11]
  v_mfma_f32_4x4x4_16b_bf16 v[136:139], v[192:193], v[64:65], v[136:139]
  s_nop 1
  v_mfma_f32_4x4x4_16b_bf16 v[136:139], v[192:193], v[66:67], v[136:139]
  v_mfma_f32_32x32x16_bf16 v[48:63], a[96:99], v[68:71], v[48:63]
  ds_read_b64_tr_b16 v[84:85], v218 offset:8192
  ds_read_b64_tr_b16 v[86:87], v218 offset:8704
  v_mfma_f32_4x4x4_16b_bf16 v[4:7], v[192:193], a[98:99], v[4:7]
  v_mfma_f32_4x4x4_16b_bf16 v[8:11], a[98:99], a[98:99], v[8:11]
  v_mfma_f32_4x4x4_16b_bf16 v[140:143], v[192:193], v[68:69], v[140:143]
  s_nop 1
  v_mfma_f32_4x4x4_16b_bf16 v[140:143], v[192:193], v[70:71], v[140:143]
  s_waitcnt lgkmcnt(5)
  v_mfma_f32_32x32x16_bf16 v[32:47], a[100:103], v[72:75], v[32:47]
  ds_read_b128 a[108:111], v211 offset:4096
  ds_read_b64_tr_b16 v[88:89], v215 offset:8192
  ds_read_b64_tr_b16 v[90:91], v215 offset:8704
  v_mfma_f32_4x4x4_16b_bf16 v[4:7], v[192:193], a[100:101], v[4:7]
  v_mfma_f32_4x4x4_16b_bf16 v[8:11], a[100:101], a[100:101], v[8:11]
  v_mfma_f32_32x32x16_bf16 v[48:63], a[100:103], v[76:79], v[48:63]
  ds_read_b64_tr_b16 v[92:93], v219 offset:8192
  ds_read_b64_tr_b16 v[94:95], v219 offset:8704
  v_mfma_f32_4x4x4_16b_bf16 v[4:7], v[192:193], a[102:103], v[4:7]
  v_mfma_f32_4x4x4_16b_bf16 v[8:11], a[102:103], a[102:103], v[8:11]
  s_lshl_b32 s10, s4, 2
  v_add_u32 v15, s10, v133
  v_min_u32 v136, -2, v136
  v_min_u32 v140, -2, v140
  ds_write_b32 v15, v136 offset:0
  ds_write_b32 v15, v140 offset:1024
  s_waitcnt lgkmcnt(7)
  v_mfma_f32_32x32x16_bf16 v[32:47], a[104:107], v[80:83], v[32:47]
  v_mfma_f32_4x4x4_16b_bf16 v[4:7], v[192:193], a[104:105], v[4:7]
  v_mfma_f32_4x4x4_16b_bf16 v[8:11], a[104:105], a[104:105], v[8:11]
  v_mfma_f32_32x32x16_bf16 v[48:63], a[104:107], v[84:87], v[48:63]
  v_mfma_f32_4x4x4_16b_bf16 v[4:7], v[192:193], a[106:107], v[4:7]
  v_mfma_f32_4x4x4_16b_bf16 v[8:11], a[106:107], a[106:107], v[8:11]
  ds_read_b128 v[148:151], v133 offset:0
  ds_read_b128 v[152:155], v133 offset:1024
  s_waitcnt lgkmcnt(4)
  v_mfma_f32_32x32x16_bf16 v[32:47], a[108:111], v[88:91], v[32:47]
  v_mfma_f32_4x4x4_16b_bf16 v[4:7], v[192:193], a[108:109], v[4:7]
  v_mfma_f32_4x4x4_16b_bf16 v[8:11], a[108:109], a[108:109], v[8:11]
  v_mfma_f32_32x32x16_bf16 v[48:63], a[108:111], v[92:95], v[48:63]
  v_mfma_f32_4x4x4_16b_bf16 v[4:7], v[192:193], a[110:111], v[4:7]
  v_mfma_f32_4x4x4_16b_bf16 v[8:11], a[110:111], a[110:111], v[8:11]
  v_bfe_u32 v0, v1, 2, 2
  v_xor_b32 v0, s3, v0
  v_lshl_add_u32 v0, v0, 10, v225
  buffer_load_dword v226, v0, s[36:39], 0 offen sc1
  s_nop 0
  v_cndmask_b32 v8, v8, v9, s[74:75]
  v_cndmask_b32 v10, v10, v11, s[74:75]
  s_mov_b32 s10, 0xcccccccc
  s_mov_b32 s11, 0xcccccccc
  v_cndmask_b32 v8, v8, v10, s[10:11]
  v_mov_b32 v13, v4
  s_nop 1
  v_permlane32_swap_b32 v4, v13
  v_add_f32 v4, v4, v13
  v_mov_b32 v14, v8
  s_nop 1
  v_permlane32_swap_b32 v8, v14
  v_add_f32 v8, v8, v14
  s_mov_b32 s10, 991054117
  v_mul_f32 v4, s10, v4
  v_mul_f32 v8, s10, v8
  v_fma_f32 v8, -v4, v4, v8
  v_max_f32 v8, 0, v8
  v_add_f32 v8, 925353388, v8
  v_rsq_f32 v8, v8
  v_sub_f32 v4, 0, v4
  v_and_b32 v13, 31, v1
  v_lshlrev_b32 v13, 2, v13
  s_lshl_b32 s10, s4, 7
  s_add_u32 s10, s10, 154624
  v_add_u32 v13, s10, v13
  ds_write_b32 v13, v8
  v_lshrrev_b32 v14, 5, v1
  v_lshlrev_b32 v14, 4, v14
  v_add_u32 v14, s10, v14
  v_and_b32 v68, 0xffff0000, v4
  v_sub_f32 v70, v4, v68
  v_and_b32 v69, 0xffff0000, v70
  v_sub_f32 v70, v70, v69
  v_perm_b32 v64, v69, v68, s100
  v_perm_b32 v65, v69, v68, s100
  v_perm_b32 v66, v68, v70, s100
W13:
  s_cbranch_execz W14
  v_mov_b32 v67, 0
F_CXNL:
  s_waitcnt lgkmcnt(0)
  v_max3_u32 v0, v148, v149, v150
  v_max3_u32 v0, v0, v151, v152
  v_max3_u32 v0, v0, v153, v154
  v_max_u32 v0, v0, v155
  v_cmp_eq_u32 vcc, -1, v0
  s_nop 1
  s_cbranch_vccz F_CXNO
  ds_read_b128 v[148:151], v133 offset:0
  ds_read_b128 v[152:155], v133 offset:1024
  s_branch F_CXNL
F_CXNO:
  ds_read_b128 v[112:115], v14 offset:0
  ds_read_b128 v[116:119], v14 offset:32
  ds_read_b128 v[120:123], v14 offset:64
  ds_read_b128 v[124:127], v14 offset:96
  v_add_f32 v148, v148, v149
  v_add_f32 v150, v150, v151
  v_add_f32 v148, v148, v150
  v_and_b32 v76, 0xffff0000, v148
  v_sub_f32 v78, v148, v76
  v_and_b32 v77, 0xffff0000, v78
  v_sub_f32 v78, v78, v77
  v_perm_b32 v72, v76, v76, s100
  v_perm_b32 v73, v77, v77, s100
  v_perm_b32 v74, v78, v76, s100
  v_mov_b32 v75, 0
  s_nop 1
  v_mfma_f32_32x32x16_bf16 v[32:47], v[64:67], v[72:75], v[32:47]
  v_add_f32 v152, v152, v153
  v_add_f32 v154, v154, v155
  v_add_f32 v152, v152, v154
  v_and_b32 v84, 0xffff0000, v152
  v_sub_f32 v86, v152, v84
  v_and_b32 v85, 0xffff0000, v86
  v_sub_f32 v86, v86, v85
  v_perm_b32 v80, v84, v84, s100
  v_perm_b32 v81, v85, v85, s100
  v_perm_b32 v82, v86, v84, s100
  v_mov_b32 v83, 0
  s_nop 1
  v_mfma_f32_32x32x16_bf16 v[48:63], v[64:67], v[80:83], v[48:63]
  v_mov_b32 v9, v8
  s_mov_b32 s10, 1049335798
  v_mul_f32 v4, s10, v8
  v_mul_f32 v5, s10, v8
  s_waitcnt lgkmcnt(0)
  v_pk_mul_f32 v[32:33], v[32:33], v[112:113]
  v_pk_mul_f32 v[34:35], v[34:35], v[114:115]
  v_pk_mul_f32 v[36:37], v[36:37], v[116:117]
  v_pk_mul_f32 v[38:39], v[38:39], v[118:119]
  v_cvt_pk_bf16_f32 v32, v32, v33
  v_cvt_pk_bf16_f32 v33, v34, v35
  v_cvt_pk_bf16_f32 v34, v36, v37
  v_cvt_pk_bf16_f32 v35, v38, v39
  v_min_u32 v32, -2, v32
  v_min_u32 v33, -2, v33
  v_min_u32 v34, -2, v34
  v_min_u32 v35, -2, v35
  buffer_store_dwordx4 v[32:35], v134, s[36:39], s14 offen offset:0 sc1
  v_pk_mul_f32 v[40:41], v[40:41], v[120:121]
  v_pk_mul_f32 v[42:43], v[42:43], v[122:123]
  v_pk_mul_f32 v[44:45], v[44:45], v[124:125]
  v_pk_mul_f32 v[46:47], v[46:47], v[126:127]
  v_cvt_pk_bf16_f32 v40, v40, v41
  v_cvt_pk_bf16_f32 v41, v42, v43
  v_cvt_pk_bf16_f32 v42, v44, v45
  v_cvt_pk_bf16_f32 v43, v46, v47
  v_min_u32 v40, -2, v40
  v_min_u32 v41, -2, v41
  v_min_u32 v42, -2, v42
  v_min_u32 v43, -2, v43
  buffer_store_dwordx4 v[40:43], v134, s[36:39], s14 offen offset:1024 sc1
  v_pk_mul_f32 v[48:49], v[48:49], v[112:113]
  v_pk_mul_f32 v[50:51], v[50:51], v[114:115]
  v_pk_mul_f32 v[52:53], v[52:53], v[116:117]
  v_pk_mul_f32 v[54:55], v[54:55], v[118:119]
  v_cvt_pk_bf16_f32 v48, v48, v49
  v_cvt_pk_bf16_f32 v49, v50, v51
  v_cvt_pk_bf16_f32 v50, v52, v53
  v_cvt_pk_bf16_f32 v51, v54, v55
  v_min_u32 v48, -2, v48
  v_min_u32 v49, -2, v49
  v_min_u32 v50, -2, v50
  v_min_u32 v51, -2, v51
  buffer_store_dwordx4 v[48:51], v135, s[36:39], s14 offen offset:0 sc1
  v_pk_mul_f32 v[56:57], v[56:57], v[120:121]
  v_pk_mul_f32 v[58:59], v[58:59], v[122:123]
  v_pk_mul_f32 v[60:61], v[60:61], v[124:125]
  v_pk_mul_f32 v[62:63], v[62:63], v[126:127]
  v_cvt_pk_bf16_f32 v56, v56, v57
  v_cvt_pk_bf16_f32 v57, v58, v59
  v_cvt_pk_bf16_f32 v58, v60, v61
  v_cvt_pk_bf16_f32 v59, v62, v63
  v_min_u32 v56, -2, v56
  v_min_u32 v57, -2, v57
  v_min_u32 v58, -2, v58
  v_min_u32 v59, -2, v59
  buffer_store_dwordx4 v[56:59], v135, s[36:39], s14 offen offset:1024 sc1
F_Q:
  ds_read_b64_tr_b16 v[96:97], v220 offset:0
  ds_read_b64_tr_b16 v[98:99], v220 offset:256
  ds_read_b64_tr_b16 v[100:101], v221 offset:0
  ds_read_b64_tr_b16 v[102:103], v221 offset:256
  ds_read_b64_tr_b16 v[104:105], v222 offset:0
  ds_read_b64_tr_b16 v[106:107], v222 offset:256
  s_waitcnt lgkmcnt(4)
  v_mfma_f32_32x32x16_bf16 v[16:31], v[96:99], a[0:3], 0
  v_mfma_f32_4x4x4_16b_bf16 v[144:147], v[192:193], v[96:97], v[144:147]
  s_nop 1
  v_mfma_f32_4x4x4_16b_bf16 v[144:147], v[192:193], v[98:99], v[144:147]
  ds_read_b64_tr_b16 v[108:109], v223 offset:0
  ds_read_b64_tr_b16 v[110:111], v223 offset:256
  s_mov_b32 s63, 30000
  s_lshl_b32 s11, s68, 9
  s_add_u32 s11, s11, 2097152
  s_lshl_b32 s47, s7, 11
  s_add_u32 s47, s47, 2125824
  s_and_b32 s46, s3, 12
  s_waitcnt lgkmcnt(4)
  v_mfma_f32_32x32x16_bf16 v[16:31], v[100:103], a[4:7], v[16:31]
  ds_read_b64_tr_b16 v[96:97], v220 offset:4096
  ds_read_b64_tr_b16 v[98:99], v220 offset:4352
  s_xor_b32 s10, s46, 0
  s_mul_i32 s10, s10, 245760
  s_add_u32 s13, s10, s47
  s_add_u32 s10, s10, s11
  s_add_u32 s18, s32, s10
  s_addc_u32 s19, s33, 0
  s_waitcnt lgkmcnt(4)
  v_mfma_f32_32x32x16_bf16 v[16:31], v[104:107], a[8:11], v[16:31]
  ds_read_b64_tr_b16 v[100:101], v221 offset:4096
  ds_read_b64_tr_b16 v[102:103], v221 offset:4352
  s_add_u32 s20, s32, s13
  s_addc_u32 s21, s33, 0
  s_and_b32 s13, s3, 3
  s_mul_i32 s12, s4, 61440
  s_xor_b32 s10, s13, 0
  s_mul_i32 s10, s10, 245760
  s_waitcnt lgkmcnt(4)
  v_mfma_f32_32x32x16_bf16 v[16:31], v[108:111], a[12:15], v[16:31]
  ds_read_b64_tr_b16 v[104:105], v222 offset:4096
  ds_read_b64_tr_b16 v[106:107], v222 offset:4352
  s_add_u32 s10, s10, s12
  v_add_u32 v8, s10, v2
  s_xor_b32 s10, s13, 1
  s_mul_i32 s10, s10, 245760
  s_add_u32 s10, s10, s12
  v_add_u32 v9, s10, v2
  s_waitcnt lgkmcnt(4)
  v_mfma_f32_32x32x16_bf16 v[16:31], v[96:99], a[16:19], v[16:31]
  v_mfma_f32_4x4x4_16b_bf16 v[144:147], v[192:193], v[96:97], v[144:147]
  s_nop 1
  v_mfma_f32_4x4x4_16b_bf16 v[144:147], v[192:193], v[98:99], v[144:147]
  ds_read_b64_tr_b16 v[108:109], v223 offset:4096
  ds_read_b64_tr_b16 v[110:111], v223 offset:4352
  s_xor_b32 s10, s13, 2
  s_mul_i32 s10, s10, 245760
  s_add_u32 s10, s10, s12
  v_add_u32 v10, s10, v2
  s_xor_b32 s10, s13, 3
  s_mul_i32 s10, s10, 245760
  s_waitcnt lgkmcnt(4)
W14:
  s_cbranch_execz W40
  v_mfma_f32_32x32x16_bf16 v[16:31], v[100:103], a[20:23], v[16:31]
  ds_read_b64_tr_b16 v[96:97], v220 offset:8192
  ds_read_b64_tr_b16 v[98:99], v220 offset:8448
  s_add_u32 s10, s10, s12
  v_add_u32 v11, s10, v2
  s_mov_b32 s12, 0
  s_waitcnt vmcnt(4)
  v_cmp_eq_u32 vcc, -1, v226
  s_nop 1
  s_cbranch_vccnz CT_H
CT_B:
  s_waitcnt lgkmcnt(4)
  v_mfma_f32_32x32x16_bf16 v[16:31], v[104:107], a[24:27], v[16:31]
  ds_read_b64_tr_b16 v[100:101], v221 offset:8192
  ds_read_b64_tr_b16 v[102:103], v221 offset:8448
  s_add_u32 s10, s4, 1
  s_and_b32 s10, s10, 3
  s_mul_i32 s10, s10, 20480
  v_add_u32 v113, s10, v2
  s_add_u32 s10, s4, 2
  s_and_b32 s10, s10, 3
  s_waitcnt lgkmcnt(4)
  v_mfma_f32_32x32x16_bf16 v[16:31], v[108:111], a[28:31], v[16:31]
  ds_read_b64_tr_b16 v[104:105], v222 offset:8192
  ds_read_b64_tr_b16 v[106:107], v222 offset:8448
  s_mul_i32 s10, s10, 20480
  v_add_u32 v114, s10, v2
  s_add_u32 s10, s4, 3
  s_and_b32 s10, s10, 3
  s_mul_i32 s10, s10, 20480
  v_add_u32 v115, s10, v2
  s_waitcnt lgkmcnt(4)
  v_mfma_f32_32x32x16_bf16 v[16:31], v[96:99], a[32:35], v[16:31]
  v_mfma_f32_4x4x4_16b_bf16 v[144:147], v[192:193], v[96:97], v[144:147]
  s_nop 1
  v_mfma_f32_4x4x4_16b_bf16 v[144:147], v[192:193], v[98:99], v[144:147]
  ds_read_b64_tr_b16 v[108:109], v223 offset:8192
  ds_read_b64_tr_b16 v[110:111], v223 offset:8448
  s_and_b32 s5, s2, 7
  s_lshr_b32 s6, s2, 3
  v_add_u32 v3, 12288, v2
  s_lshl_b32 s56, s5, 2
  s_lshr_b32 s10, s6, 3
  s_add_u32 s56, s56, s10
  s_waitcnt lgkmcnt(4)
  v_mfma_f32_32x32x16_bf16 v[16:31], v[100:103], a[36:39], v[16:31]
  ds_read_b64_tr_b16 v[96:97], v220 offset:12288
  ds_read_b64_tr_b16 v[98:99], v220 offset:12544
  s_and_b32 s57, s6, 7
  s_and_b32 s58, s4, 1
  s_lshr_b32 s59, s4, 1
  s_mov_b32 s52, s32
  s_mov_b32 s53, s33
  s_cmp_lt_u32 s57, 7
  s_cselect_b32 s54, 0x10000000, 0
  s_waitcnt lgkmcnt(4)
  v_mfma_f32_32x32x16_bf16 v[16:31], v[104:107], a[40:43], v[16:31]
  ds_read_b64_tr_b16 v[100:101], v221 offset:12288
  ds_read_b64_tr_b16 v[102:103], v221 offset:12544
  s_mov_b32 s55, 0x20000
  s_mov_b32 s48, s28
  s_mov_b32 s49, s29
  s_mov_b32 s50, 1835008
  s_mov_b32 s51, 0x20000
  s_xor_b32 s10, s46, 4
  s_waitcnt lgkmcnt(4)
  v_mfma_f32_32x32x16_bf16 v[16:31], v[108:111], a[44:47], v[16:31]
  ds_read_b64_tr_b16 v[104:105], v222 offset:12288
  ds_read_b64_tr_b16 v[106:107], v222 offset:12544
  s_mul_i32 s10, s10, 245760
  s_add_u32 s13, s10, s47
  s_add_u32 s10, s10, s11
  s_add_u32 s22, s32, s10
  s_addc_u32 s23, s33, 0
  s_add_u32 s24, s32, s13
  s_addc_u32 s25, s33, 0
  s_waitcnt lgkmcnt(4)
  v_mfma_f32_32x32x16_bf16 v[16:31], v[96:99], a[48:51], v[16:31]
  v_mfma_f32_4x4x4_16b_bf16 v[144:147], v[192:193], v[96:97], v[144:147]
  s_nop 1
  v_mfma_f32_4x4x4_16b_bf16 v[144:147], v[192:193], v[98:99], v[144:147]
  ds_read_b64_tr_b16 v[108:109], v223 offset:12288
  ds_read_b64_tr_b16 v[110:111], v223 offset:12544
  s_waitcnt vmcnt(5)
  ds_read_b64_tr_b16 v[240:241], v229 offset:0
  ds_read_b64_tr_b16 v[242:243], v230 offset:0
  s_xor_b32 s10, s46, 8
  s_mul_i32 s10, s10, 245760
  s_add_u32 s13, s10, s47
  s_add_u32 s10, s10, s11
  s_add_u32 s26, s32, s10
  s_addc_u32 s27, s33, 0
  s_waitcnt lgkmcnt(6)
  v_mfma_f32_32x32x16_bf16 v[16:31], v[100:103], a[52:55], v[16:31]
  ds_read_b64_tr_b16 v[96:97], v220 offset:16384
  ds_read_b64_tr_b16 v[98:99], v220 offset:16640
  ds_read_b64_tr_b16 v[244:245], v229 offset:1024
  ds_read_b64_tr_b16 v[246:247], v230 offset:1024
  s_add_u32 s34, s32, s13
  s_addc_u32 s35, s33, 0
  s_xor_b32 s10, s46, 12
  s_mul_i32 s10, s10, 245760
  s_add_u32 s13, s10, s47
  s_add_u32 s10, s10, s11
  s_waitcnt lgkmcnt(8)
  v_mfma_f32_32x32x16_bf16 v[16:31], v[104:107], a[56:59], v[16:31]
  ds_read_b64_tr_b16 v[100:101], v221 offset:16384
  ds_read_b64_tr_b16 v[102:103], v221 offset:16640
  ds_read_b64_tr_b16 v[248:249], v229 offset:2048
  ds_read_b64_tr_b16 v[250:251], v230 offset:2048
  s_add_u32 s16, s32, s10
  s_addc_u32 s17, s33, 0
  s_add_u32 s28, s32, s13
  s_addc_u32 s29, s33, 0
  s_min_u32 s8, s57, 6
  s_xor_b32 s10, s58, 0
  s_waitcnt lgkmcnt(10)
  v_mfma_f32_32x32x16_bf16 v[16:31], v[108:111], a[60:63], v[16:31]
  ds_read_b64_tr_b16 v[104:105], v222 offset:16384
  ds_read_b64_tr_b16 v[106:107], v222 offset:16640
  ds_read_b64_tr_b16 v[252:253], v229 offset:3072
  ds_read_b64_tr_b16 v[254:255], v230 offset:3072
  s_lshl_b32 s13, s8, 1
  s_add_u32 s10, s10, s13
  s_mul_i32 s10, s10, 32
  s_mul_i32 s13, s4, 8
  s_add_u32 s10, s10, s13
  s_lshl_b32 s10, s10, 10
  s_waitcnt lgkmcnt(10)
  v_mfma_f32_32x32x16_bf16 v[16:31], v[96:99], a[64:67], v[16:31]
  v_mfma_f32_4x4x4_16b_bf16 v[144:147], v[192:193], v[96:97], v[144:147]
  s_nop 1
  v_mfma_f32_4x4x4_16b_bf16 v[144:147], v[192:193], v[98:99], v[144:147]
  ds_read_b64_tr_b16 v[108:109], v223 offset:16384
  ds_read_b64_tr_b16 v[110:111], v223 offset:16640
  s_add_u32 s64, s10, 14684160
  s_xor_b32 s10, s58, 1
  s_lshl_b32 s13, s8, 1
  s_add_u32 s10, s10, s13
  s_mul_i32 s10, s10, 32
  s_mul_i32 s13, s4, 8
  s_waitcnt lgkmcnt(8)
  v_mfma_f32_32x32x16_bf16 v[16:31], v[100:103], a[68:71], v[16:31]
  ds_read_b64_tr_b16 v[96:97], v220 offset:20480
  ds_read_b64_tr_b16 v[98:99], v220 offset:20736
  s_add_u32 s10, s10, s13
  s_lshl_b32 s10, s10, 10
  s_add_u32 s65, s10, 14684160
  s_min_u32 s10, s57, 6
  s_lshl_b32 s10, s10, 3
  s_lshl_b32 s13, s4, 1
  s_waitcnt lgkmcnt(6)
  v_mfma_f32_32x32x16_bf16 v[16:31], v[104:107], a[72:75], v[16:31]
  ds_read_b64_tr_b16 v[100:101], v221 offset:20480
  ds_read_b64_tr_b16 v[102:103], v221 offset:20736
  s_add_u32 s10, s10, s13
  s_mul_i32 s10, s10, 29696
  s_add_u32 s66, s10, 10489856
  s_mul_i32 s10, s57, 14
  s_mul_i32 s13, s4, 3
  s_add_u32 s10, s10, s13
  s_waitcnt lgkmcnt(4)
  v_mfma_f32_32x32x16_bf16 v[16:31], v[108:111], a[76:79], v[16:31]
  ds_read_b64_tr_b16 v[104:105], v222 offset:20480
  ds_read_b64_tr_b16 v[106:107], v222 offset:20736
  s_lshl_b32 s10, s10, 14
  s_add_u32 s67, s10, 12582912
  s_lshl_b32 s10, s56, 1
  s_add_u32 s10, s10, s59
  s_mul_i32 s72, s10, 28672
  s_lshl_b32 s13, s57, 1
  s_waitcnt lgkmcnt(4)
  v_mfma_f32_32x32x16_bf16 v[16:31], v[96:99], a[80:83], v[16:31]
  v_mfma_f32_4x4x4_16b_bf16 v[144:147], v[192:193], v[96:97], v[144:147]
  s_nop 1
  v_mfma_f32_4x4x4_16b_bf16 v[144:147], v[192:193], v[98:99], v[144:147]
  ds_read_b64_tr_b16 v[108:109], v223 offset:20480
W15:
  s_cbranch_execz W41
  ds_read_b64_tr_b16 v[110:111], v223 offset:20736
  s_add_u32 s13, s13, s58
  s_lshl_b32 s10, s13, 11
  s_add_u32 s68, s72, s10
  s_add_u32 s68, s68, 8388608
  s_lshl_b32 s10, s13, 6
  s_add_u32 s72, s72, s10
  global_load_dwordx4 v[160:163], v8, s[18:19] sc1
  global_load_dwordx4 v[164:167], v8, s[18:19] offset:1024 sc1
  s_waitcnt lgkmcnt(4)
  v_mfma_f32_32x32x16_bf16 v[16:31], v[100:103], a[84:87], v[16:31]
  ds_read_b64_tr_b16 v[96:97], v220 offset:24576
  ds_read_b64_tr_b16 v[98:99], v220 offset:24832
  s_getreg_b32 s73, hwreg(HW_REG_XCC_ID, 0, 4)
  s_and_b32 s10, s56, 3
  s_mul_i32 s10, s10, 49152
  s_lshl_b32 s13, s4, 13
  s_add_u32 s10, s10, s13
  s_add_u32 s10, s10, 12587008
  global_load_dwordx4 v[168:171], v8, s[20:21] sc1
  global_load_dwordx4 v[172:175], v8, s[20:21] offset:1024 sc1
  s_waitcnt lgkmcnt(4)
  v_mfma_f32_32x32x16_bf16 v[16:31], v[104:107], a[88:91], v[16:31]
  ds_read_b64_tr_b16 v[100:101], v221 offset:24576
  ds_read_b64_tr_b16 v[102:103], v221 offset:24832
  s_cmp_eq_u32 s57, 7
  s_cselect_b32 s66, s10, s66
  s_lshl_b32 s45, s56, 10
  s_add_u32 s45, s45, 15761408
  s_lshl_b32 s44, s57, 2
  s_add_u32 s44, s44, s4
  s_waitcnt lgkmcnt(4)
  v_mfma_f32_32x32x16_bf16 v[16:31], v[108:111], a[92:95], v[16:31]
  ds_read_b64_tr_b16 v[104:105], v222 offset:24576
  ds_read_b64_tr_b16 v[106:107], v222 offset:24832
  s_lshl_b32 s44, s44, 4
  s_add_u32 s44, s44, s45
  v_mov_b32 v13, s44
  s_add_u32 s13, s4, 3
  s_and_b32 s13, s13, 3
  s_lshl_b32 s10, s3, 2
  global_load_dwordx4 v[176:179], v9, s[18:19] sc1
  global_load_dwordx4 v[180:183], v9, s[18:19] offset:1024 sc1
  s_waitcnt lgkmcnt(4)
  v_mfma_f32_32x32x16_bf16 v[16:31], v[96:99], a[96:99], v[16:31]
  v_mfma_f32_4x4x4_16b_bf16 v[144:147], v[192:193], v[96:97], v[144:147]
  s_nop 1
  v_mfma_f32_4x4x4_16b_bf16 v[144:147], v[192:193], v[98:99], v[144:147]
  ds_read_b64_tr_b16 v[108:109], v223 offset:24576
  ds_read_b64_tr_b16 v[110:111], v223 offset:24832
  s_add_u32 s10, s10, s13
  s_lshl_b32 s44, s10, 4
  s_add_u32 s44, s44, s7
  s_and_b32 s13, s44, 31
  s_lshl_b32 s13, s13, 4
  s_lshr_b32 s10, s10, 1
  global_load_dwordx4 v[184:187], v9, s[20:21] sc1
  global_load_dwordx4 v[188:191], v9, s[20:21] offset:1024 sc1
  s_waitcnt lgkmcnt(4)
  v_mfma_f32_32x32x16_bf16 v[16:31], v[100:103], a[100:103], v[16:31]
  v_min_u32 v144, -2, v144
  ds_write_b32 v15, v144 offset:2048
  s_lshl_b32 s10, s10, 10
  s_add_u32 s10, s10, s13
  s_add_u32 s10, s10, 15761920
  v_writelane_b32 v13, s10, 1
  s_lshl_b32 s44, s44, 11
  s_add_u32 s44, s44, 6291456
  s_waitcnt lgkmcnt(3)
  v_mfma_f32_32x32x16_bf16 v[16:31], v[104:107], a[104:107], v[16:31]
  ds_read_b128 v[156:159], v133 offset:2048
  s_mul_i32 s14, s56, 168
  s_add_u32 s14, s14, s57
  s_mul_i32 s13, s4, 3
  s_lshl_b32 s15, s57, 1
  s_add_u32 s10, s13, 0
  s_cmp_lt_u32 s10, s15
  s_cselect_b32 s74, -1, 24
  s_waitcnt lgkmcnt(2)
  v_mfma_f32_32x32x16_bf16 v[16:31], v[108:111], a[108:111], v[16:31]
  s_mul_i32 s10, s10, 12
  s_add_u32 s10, s10, s74
  s_add_u32 s10, s10, s14
  s_lshl_b32 s10, s10, 11
  s_add_u32 s69, s10, 16777216
  s_add_u32 s10, s13, 1
  s_cmp_lt_u32 s10, s15
  s_cselect_b32 s74, -1, 24
  s_mul_i32 s10, s10, 12
  s_add_u32 s10, s10, s74
  s_add_u32 s10, s10, s14
  s_lshl_b32 s10, s10, 11
  s_add_u32 s70, s10, 16777216
  s_add_u32 s10, s13, 2
  s_cmp_lt_u32 s10, s15
  s_cselect_b32 s74, -1, 24
  s_mul_i32 s10, s10, 12
  s_add_u32 s10, s10, s74
  s_add_u32 s10, s10, s14
  s_lshl_b32 s10, s10, 11
  s_add_u32 s47, s10, 16777216
  v_mov_b32 v12, s73
  s_add_u32 s14, s32, s64
  s_addc_u32 s15, s33, 0
  s_add_u32 s74, s32, s65
  s_addc_u32 s75, s33, 0
  s_cmp_eq_u32 s57, 7
  s_cselect_b32 s65, 28, 1
  s_lshl_b32 s65, s65, 13
  s_add_u32 s64, s66, s65
  s_lshl_b32 s65, s65, 1
  s_min_u32 s10, s57, 6
  s_lshl_b32 s10, s10, 2
  s_add_u32 s10, s10, s4
  s_lshl_b32 s10, s10, 13
  s_add_u32 s101, s10, 15794176
F_CXQL:
  s_waitcnt lgkmcnt(0)
  v_max3_u32 v0, v156, v157, v158
  v_max_u32 v0, v0, v159
  v_cmp_eq_u32 vcc, -1, v0
  s_nop 1
  s_cbranch_vccz F_CXQO
  ds_read_b128 v[156:159], v133 offset:2048
  s_branch F_CXQL
F_CXQO:
  v_add_f32 v156, v156, v157
  v_add_f32 v158, v158, v159
  v_add_f32 v156, v156, v158
  v_and_b32 v92, 0xffff0000, v156
  v_sub_f32 v94, v156, v92
  v_and_b32 v93, 0xffff0000, v94
  v_sub_f32 v94, v94, v93
  v_perm_b32 v88, v92, v92, s100
  v_perm_b32 v89, v93, v93, s100
  v_perm_b32 v90, v94, v92, s100
  v_mov_b32 v91, 0
  s_nop 1
  v_mfma_f32_32x32x16_bf16 v[16:31], v[88:91], v[64:67], v[16:31]
  s_bitcmp1_b32 s7, 0
  s_cselect_b32 s60, -1, 0
  s_mov_b32 s61, 0
  s_mov_b32 vcc_lo, 0
  s_cselect_b32 vcc_hi, 0, -1
  v_add_u32 v0, s9, v2
  s_nop 5
  v_pk_mul_f32 v[16:17], v[16:17], v[4:5]
  v_pk_mul_f32 v[18:19], v[18:19], v[4:5]
  v_pk_mul_f32 v[20:21], v[20:21], v[4:5]
  v_pk_mul_f32 v[22:23], v[22:23], v[4:5]
  v_pk_mul_f32 v[24:25], v[24:25], v[4:5]
  v_pk_mul_f32 v[26:27], v[26:27], v[4:5]
  v_pk_mul_f32 v[28:29], v[28:29], v[4:5]
  v_pk_mul_f32 v[30:31], v[30:31], v[4:5]
  v_cvt_pk_bf16_f32 v16, v16, v17
  v_cvt_pk_bf16_f32 v17, v18, v19
  v_cvt_pk_bf16_f32 v18, v20, v21
  v_cvt_pk_bf16_f32 v19, v22, v23
  v_cndmask_b32 v16, v16, 0, s[60:61]
  v_cndmask_b32 v17, v17, 0, s[60:61]
  ds_write_b128 v0, v[16:19]
  v_cvt_pk_bf16_f32 v20, v24, v25
  v_cvt_pk_bf16_f32 v21, v26, v27
  v_cvt_pk_bf16_f32 v22, v28, v29
  v_cvt_pk_bf16_f32 v23, v30, v31
  v_cndmask_b32 v22, v22, 0, vcc
  v_cndmask_b32 v23, v23, 0, vcc
  ds_write_b128 v0, v[20:23] offset:1024
P_ATT:
  v_lshrrev_b32 v0, 2, v1
  v_lshl_add_u32 v0, v0, 10, v225
  buffer_load_dword v224, v0, s[36:39], 0 offen sc1
  global_load_dwordx4 v[192:195], v10, s[18:19] sc1
  global_load_dwordx4 v[196:199], v10, s[18:19] offset:1024 sc1
  global_load_dwordx4 v[200:203], v10, s[20:21] sc1
  global_load_dwordx4 v[204:207], v10, s[20:21] offset:1024 sc1
  s_waitcnt lgkmcnt(0)
  s_barrier
  ds_read_b128 v[24:27], v113
  ds_read_b128 v[28:31], v113 offset:1024
W16:
  s_cbranch_execz P_END
  ds_read_b128 v[32:35], v114
  ds_read_b128 v[36:39], v114 offset:1024
  ds_read_b128 v[40:43], v115
  ds_read_b128 v[44:47], v115 offset:1024
  v_mov_b32 v4, -1
  v_mov_b32 v5, -1
  v_mov_b32 v6, -1
  v_mov_b32 v7, -1
  buffer_store_dwordx4 v[240:243], v231, s[36:39], 0 offen offset:0 sc1
  v_and_b32 v246, v233, v246
  v_and_b32 v247, v233, v247
  buffer_store_dwordx4 v[244:247], v231, s[36:39], 0 offen offset:1024 sc1
  buffer_store_dwordx4 v[248:251], v231, s[36:39], 0 offen offset:2048 sc1
  v_and_b32 v254, v233, v254
  v_and_b32 v255, v233, v255
  buffer_store_dwordx4 v[252:255], v232, s[36:39], 0 offen offset:3072 sc1
  s_waitcnt vmcnt(15)
  v_max_u32 v0, v160, v164
  v_cmp_eq_u32 vcc, -1, v0
  s_nop 1
  s_cbranch_vccnz CK0_H
CK0_B:
  v_mfma_f32_32x32x16_bf16 v[112:127], v[160:163], v[16:19], 0
  v_mfma_f32_32x32x16_bf16 v[112:127], v[164:167], v[20:23], v[112:127]
  s_waitcnt lgkmcnt(0)
  v_mfma_f32_32x32x16_bf16 v[128:143], v[160:163], v[24:27], 0
  global_load_dwordx4 v[208:211], v11, s[18:19] sc1
  s_nop 8
  v_exp_f32 v112, v112
  v_exp_f32 v113, v113
  v_exp_f32 v114, v114
  v_exp_f32 v115, v115
  v_cvt_pk_bf16_f32 v144, v112, v113
  v_cvt_pk_bf16_f32 v145, v114, v115
  v_mfma_f32_32x32x16_bf16 v[128:143], v[164:167], v[28:31], v[128:143]
  v_exp_f32 v116, v116
  v_exp_f32 v117, v117
  v_exp_f32 v118, v118
  v_exp_f32 v119, v119
  v_cvt_pk_bf16_f32 v146, v116, v117
  v_cvt_pk_bf16_f32 v147, v118, v119
  global_load_dwordx4 v[212:215], v11, s[18:19] offset:1024 sc1
  v_exp_f32 v120, v120
  v_exp_f32 v121, v121
  v_exp_f32 v122, v122
  v_exp_f32 v123, v123
  v_cvt_pk_bf16_f32 v148, v120, v121
  v_cvt_pk_bf16_f32 v149, v122, v123
  v_exp_f32 v124, v124
  v_exp_f32 v125, v125
  v_exp_f32 v126, v126
  v_exp_f32 v127, v127
  v_cvt_pk_bf16_f32 v150, v124, v125
  v_cvt_pk_bf16_f32 v151, v126, v127
  v_mfma_f32_32x32x16_bf16 v[112:127], v[160:163], v[32:35], 0
  global_load_dwordx4 v[216:219], v11, s[20:21] sc1
  v_exp_f32 v128, v128
  v_exp_f32 v129, v129
  v_exp_f32 v130, v130
  v_exp_f32 v131, v131
  v_cvt_pk_bf16_f32 v152, v128, v129
  v_cvt_pk_bf16_f32 v153, v130, v131
  v_mfma_f32_32x32x16_bf16 v[112:127], v[164:167], v[36:39], v[112:127]
  s_waitcnt vmcnt(16)
  v_max_u32 v0, v168, v172
  v_cmp_eq_u32 vcc, -1, v0
  v_exp_f32 v132, v132
  v_exp_f32 v133, v133
  v_exp_f32 v134, v134
  v_exp_f32 v135, v135
  v_cvt_pk_bf16_f32 v154, v132, v133
  v_cvt_pk_bf16_f32 v155, v134, v135
  s_cbranch_vccnz CV0_H
CV0_B:
  v_mfma_f32_32x32x16_bf16 v[48:63], v[168:171], v[144:147], 0
  global_load_dwordx4 v[220:223], v11, s[20:21] offset:1024 sc1
  v_exp_f32 v136, v136
  v_exp_f32 v137, v137
  v_exp_f32 v138, v138
  v_exp_f32 v139, v139
  v_cvt_pk_bf16_f32 v156, v136, v137
  v_cvt_pk_bf16_f32 v157, v138, v139
  v_mfma_f32_32x32x16_bf16 v[48:63], v[172:175], v[148:151], v[48:63]
  v_exp_f32 v140, v140
  v_exp_f32 v141, v141
  v_exp_f32 v142, v142
  v_exp_f32 v143, v143
  v_cvt_pk_bf16_f32 v158, v140, v141
  v_cvt_pk_bf16_f32 v159, v142, v143
  v_mfma_f32_32x32x16_bf16 v[128:143], v[160:163], v[40:43], 0
  v_exp_f32 v112, v112
  v_exp_f32 v113, v113
  v_exp_f32 v114, v114
  v_exp_f32 v115, v115
  v_cvt_pk_bf16_f32 v144, v112, v113
  v_cvt_pk_bf16_f32 v145, v114, v115
  v_mfma_f32_32x32x16_bf16 v[128:143], v[164:167], v[44:47], v[128:143]
  v_exp_f32 v116, v116
  v_exp_f32 v117, v117
  v_exp_f32 v118, v118
  v_exp_f32 v119, v119
  v_cvt_pk_bf16_f32 v146, v116, v117
  v_cvt_pk_bf16_f32 v147, v118, v119
  v_mfma_f32_32x32x16_bf16 v[64:79], v[168:171], v[152:155], 0
  v_exp_f32 v120, v120
  v_exp_f32 v121, v121
  v_exp_f32 v122, v122
  v_exp_f32 v123, v123
  v_cvt_pk_bf16_f32 v148, v120, v121
  v_cvt_pk_bf16_f32 v149, v122, v123
  v_mfma_f32_32x32x16_bf16 v[64:79], v[172:175], v[156:159], v[64:79]
  s_waitcnt vmcnt(15)
  v_max_u32 v0, v176, v180
  v_cmp_eq_u32 vcc, -1, v0
  v_exp_f32 v124, v124
  v_exp_f32 v125, v125
  v_exp_f32 v126, v126
  v_exp_f32 v127, v127
  v_cvt_pk_bf16_f32 v150, v124, v125
  v_cvt_pk_bf16_f32 v151, v126, v127
  s_cbranch_vccnz CK1_H
CK1_B:
  v_mfma_f32_32x32x16_bf16 v[112:127], v[176:179], v[16:19], 0
  v_exp_f32 v128, v128
  v_exp_f32 v129, v129
  v_exp_f32 v130, v130
  v_exp_f32 v131, v131
  v_cvt_pk_bf16_f32 v152, v128, v129
  v_cvt_pk_bf16_f32 v153, v130, v131
  v_mfma_f32_32x32x16_bf16 v[112:127], v[180:183], v[20:23], v[112:127]
  v_exp_f32 v132, v132
  v_exp_f32 v133, v133
  v_exp_f32 v134, v134
  v_exp_f32 v135, v135
  v_cvt_pk_bf16_f32 v154, v132, v133
  v_cvt_pk_bf16_f32 v155, v134, v135
  v_mfma_f32_32x32x16_bf16 v[80:95], v[168:171], v[144:147], 0
  v_exp_f32 v136, v136
  v_exp_f32 v137, v137
  v_exp_f32 v138, v138
  v_exp_f32 v139, v139
  v_cvt_pk_bf16_f32 v156, v136, v137
  v_cvt_pk_bf16_f32 v157, v138, v139
  v_mfma_f32_32x32x16_bf16 v[80:95], v[172:175], v[148:151], v[80:95]
  s_waitcnt vmcnt(12)
  v_cmp_eq_u32 vcc, -1, v224
  v_exp_f32 v140, v140
  v_exp_f32 v141, v141
  v_exp_f32 v142, v142
  v_exp_f32 v143, v143
  v_cvt_pk_bf16_f32 v158, v140, v141
  v_cvt_pk_bf16_f32 v159, v142, v143
  s_cbranch_vccnz CU_H
CU_B:
  v_mfma_f32_32x32x16_bf16 v[128:143], v[176:179], v[24:27], 0
  global_load_dwordx4 v[160:163], v8, s[22:23] sc1
  v_exp_f32 v112, v112
  v_exp_f32 v113, v113
  v_exp_f32 v114, v114
  v_exp_f32 v115, v115
  v_cvt_pk_bf16_f32 v144, v112, v113
  v_cvt_pk_bf16_f32 v145, v114, v115
  v_mfma_f32_32x32x16_bf16 v[128:143], v[180:183], v[28:31], v[128:143]
  v_exp_f32 v116, v116
  v_exp_f32 v117, v117
  v_exp_f32 v118, v118
  v_exp_f32 v119, v119
  v_cvt_pk_bf16_f32 v146, v116, v117
  v_cvt_pk_bf16_f32 v147, v118, v119
  v_mfma_f32_32x32x16_bf16 v[96:111], v[168:171], v[152:155], 0
  global_load_dwordx4 v[164:167], v8, s[22:23] offset:1024 sc1
  v_exp_f32 v120, v120
  v_exp_f32 v121, v121
  v_exp_f32 v122, v122
  v_exp_f32 v123, v123
  v_cvt_pk_bf16_f32 v148, v120, v121
  v_cvt_pk_bf16_f32 v149, v122, v123
  v_mfma_f32_32x32x16_bf16 v[96:111], v[172:175], v[156:159], v[96:111]
  v_exp_f32 v124, v124
  v_exp_f32 v125, v125
  v_exp_f32 v126, v126
  v_exp_f32 v127, v127
  v_cvt_pk_bf16_f32 v150, v124, v125
  v_cvt_pk_bf16_f32 v151, v126, v127
W17:
  s_cbranch_execz P_END
  v_mfma_f32_32x32x16_bf16 v[112:127], v[176:179], v[32:35], 0
  global_load_dwordx4 v[168:171], v8, s[24:25] sc1
  v_exp_f32 v128, v128
  v_exp_f32 v129, v129
  v_exp_f32 v130, v130
  v_exp_f32 v131, v131
  v_cvt_pk_bf16_f32 v152, v128, v129
  v_cvt_pk_bf16_f32 v153, v130, v131
  v_mfma_f32_32x32x16_bf16 v[112:127], v[180:183], v[36:39], v[112:127]
  s_waitcnt vmcnt(16)
  v_max_u32 v0, v184, v188
  v_cmp_eq_u32 vcc, -1, v0
  v_exp_f32 v132, v132
  v_exp_f32 v133, v133
  v_exp_f32 v134, v134
  v_exp_f32 v135, v135
  v_cvt_pk_bf16_f32 v154, v132, v133
  v_cvt_pk_bf16_f32 v155, v134, v135
  s_cbranch_vccnz CV1_H
CV1_B:
  v_mfma_f32_32x32x16_bf16 v[48:63], v[184:187], v[144:147], v[48:63]
  global_load_dwordx4 v[172:175], v8, s[24:25] offset:1024 sc1
  v_exp_f32 v136, v136
  v_exp_f32 v137, v137
  v_exp_f32 v138, v138
  v_exp_f32 v139, v139
  v_cvt_pk_bf16_f32 v156, v136, v137
  v_cvt_pk_bf16_f32 v157, v138, v139
  v_mfma_f32_32x32x16_bf16 v[48:63], v[188:191], v[148:151], v[48:63]
  v_exp_f32 v140, v140
  v_exp_f32 v141, v141
  v_exp_f32 v142, v142
  v_exp_f32 v143, v143
  v_cvt_pk_bf16_f32 v158, v140, v141
  v_cvt_pk_bf16_f32 v159, v142, v143
  v_mfma_f32_32x32x16_bf16 v[128:143], v[176:179], v[40:43], 0
  buffer_store_dwordx4 v[4:7], v2, s[36:39], s44 offen offset:0 sc1
  v_exp_f32 v112, v112
  v_exp_f32 v113, v113
  v_exp_f32 v114, v114
  v_exp_f32 v115, v115
  v_cvt_pk_bf16_f32 v144, v112, v113
  v_cvt_pk_bf16_f32 v145, v114, v115
  v_mfma_f32_32x32x16_bf16 v[128:143], v[180:183], v[44:47], v[128:143]
  v_exp_f32 v116, v116
  v_exp_f32 v117, v117
  v_exp_f32 v118, v118
  v_exp_f32 v119, v119
  v_cvt_pk_bf16_f32 v146, v116, v117
  v_cvt_pk_bf16_f32 v147, v118, v119
  v_mfma_f32_32x32x16_bf16 v[64:79], v[184:187], v[152:155], v[64:79]
  v_exp_f32 v120, v120
  v_exp_f32 v121, v121
  v_exp_f32 v122, v122
  v_exp_f32 v123, v123
  v_cvt_pk_bf16_f32 v148, v120, v121
  v_cvt_pk_bf16_f32 v149, v122, v123
  v_mfma_f32_32x32x16_bf16 v[64:79], v[188:191], v[156:159], v[64:79]
  s_waitcnt vmcnt(15)
  v_max_u32 v0, v192, v196
  v_cmp_eq_u32 vcc, -1, v0
  v_exp_f32 v124, v124
  v_exp_f32 v125, v125
  v_exp_f32 v126, v126
  v_exp_f32 v127, v127
  v_cvt_pk_bf16_f32 v150, v124, v125
  v_cvt_pk_bf16_f32 v151, v126, v127
  s_cbranch_vccnz CK2_H
CK2_B:
  v_mfma_f32_32x32x16_bf16 v[112:127], v[192:195], v[16:19], 0
  buffer_store_dwordx4 v[4:7], v2, s[36:39], s44 offen offset:1024 sc1
  v_exp_f32 v128, v128
  v_exp_f32 v129, v129
  v_exp_f32 v130, v130
  v_exp_f32 v131, v131
  v_cvt_pk_bf16_f32 v152, v128, v129
  v_cvt_pk_bf16_f32 v153, v130, v131
  v_mfma_f32_32x32x16_bf16 v[112:127], v[196:199], v[20:23], v[112:127]
  v_exp_f32 v132, v132
  v_exp_f32 v133, v133
  v_exp_f32 v134, v134
  v_exp_f32 v135, v135
  v_cvt_pk_bf16_f32 v154, v132, v133
  v_cvt_pk_bf16_f32 v155, v134, v135
  v_mfma_f32_32x32x16_bf16 v[80:95], v[184:187], v[144:147], v[80:95]
  v_exp_f32 v136, v136
  v_exp_f32 v137, v137
  v_exp_f32 v138, v138
  v_exp_f32 v139, v139
  v_cvt_pk_bf16_f32 v156, v136, v137
  v_cvt_pk_bf16_f32 v157, v138, v139
  v_mfma_f32_32x32x16_bf16 v[80:95], v[188:191], v[148:151], v[80:95]
  v_exp_f32 v140, v140
  v_exp_f32 v141, v141
  v_exp_f32 v142, v142
  v_exp_f32 v143, v143
  v_cvt_pk_bf16_f32 v158, v140, v141
  v_cvt_pk_bf16_f32 v159, v142, v143
  v_mfma_f32_32x32x16_bf16 v[128:143], v[192:195], v[24:27], 0
  global_load_dwordx4 v[176:179], v9, s[22:23] sc1
  v_exp_f32 v112, v112
  v_exp_f32 v113, v113
  v_exp_f32 v114, v114
  v_exp_f32 v115, v115
  v_cvt_pk_bf16_f32 v144, v112, v113
  v_cvt_pk_bf16_f32 v145, v114, v115
  v_mfma_f32_32x32x16_bf16 v[128:143], v[196:199], v[28:31], v[128:143]
  v_exp_f32 v116, v116
  v_exp_f32 v117, v117
  v_exp_f32 v118, v118
  v_exp_f32 v119, v119
  v_cvt_pk_bf16_f32 v146, v116, v117
  v_cvt_pk_bf16_f32 v147, v118, v119
  v_mfma_f32_32x32x16_bf16 v[96:111], v[184:187], v[152:155], v[96:111]
  global_load_dwordx4 v[180:183], v9, s[22:23] offset:1024 sc1
  v_exp_f32 v120, v120
  v_exp_f32 v121, v121
  v_exp_f32 v122, v122
  v_exp_f32 v123, v123
  v_cvt_pk_bf16_f32 v148, v120, v121
  v_cvt_pk_bf16_f32 v149, v122, v123
  v_mfma_f32_32x32x16_bf16 v[96:111], v[188:191], v[156:159], v[96:111]
  v_exp_f32 v124, v124
  v_exp_f32 v125, v125
  v_exp_f32 v126, v126
  v_exp_f32 v127, v127
  v_cvt_pk_bf16_f32 v150, v124, v125
  v_cvt_pk_bf16_f32 v151, v126, v127
  v_mfma_f32_32x32x16_bf16 v[112:127], v[192:195], v[32:35], 0
  global_load_dwordx4 v[184:187], v9, s[24:25] sc1
  v_exp_f32 v128, v128
  v_exp_f32 v129, v129
  v_exp_f32 v130, v130
  v_exp_f32 v131, v131
  v_cvt_pk_bf16_f32 v152, v128, v129
  v_cvt_pk_bf16_f32 v153, v130, v131
  v_mfma_f32_32x32x16_bf16 v[112:127], v[196:199], v[36:39], v[112:127]
  s_waitcnt vmcnt(17)
  v_max_u32 v0, v200, v204
  v_cmp_eq_u32 vcc, -1, v0
  v_exp_f32 v132, v132
  v_exp_f32 v133, v133
  v_exp_f32 v134, v134
  v_exp_f32 v135, v135
  v_cvt_pk_bf16_f32 v154, v132, v133
  v_cvt_pk_bf16_f32 v155, v134, v135
  s_cbranch_vccnz CV2_H
CV2_B:
  v_mfma_f32_32x32x16_bf16 v[48:63], v[200:203], v[144:147], v[48:63]
  global_load_dwordx4 v[188:191], v9, s[24:25] offset:1024 sc1
  v_exp_f32 v136, v136
  v_exp_f32 v137, v137
  v_exp_f32 v138, v138
  v_exp_f32 v139, v139
  v_cvt_pk_bf16_f32 v156, v136, v137
  v_cvt_pk_bf16_f32 v157, v138, v139
  v_mfma_f32_32x32x16_bf16 v[48:63], v[204:207], v[148:151], v[48:63]
  v_exp_f32 v140, v140
  v_exp_f32 v141, v141
  v_exp_f32 v142, v142
  v_exp_f32 v143, v143
  v_cvt_pk_bf16_f32 v158, v140, v141
  v_cvt_pk_bf16_f32 v159, v142, v143
  v_mfma_f32_32x32x16_bf16 v[128:143], v[192:195], v[40:43], 0
  s_waitcnt vmcnt(14)
  s_mov_b64 exec, 1
  buffer_store_dword v1, v235, s[36:39], 0 offen sc1
  s_mov_b64 exec, -1
  v_exp_f32 v112, v112
  v_exp_f32 v113, v113
  v_exp_f32 v114, v114
  v_exp_f32 v115, v115
  v_cvt_pk_bf16_f32 v144, v112, v113
  v_cvt_pk_bf16_f32 v145, v114, v115
  v_mfma_f32_32x32x16_bf16 v[128:143], v[196:199], v[44:47], v[128:143]
  buffer_store_dwordx4 v[4:7], v2, s[52:55], s68 offen offset:0 sc1
  v_exp_f32 v116, v116
  v_exp_f32 v117, v117
  v_exp_f32 v118, v118
  v_exp_f32 v119, v119
  v_cvt_pk_bf16_f32 v146, v116, v117
  v_cvt_pk_bf16_f32 v147, v118, v119
W18:
  s_cbranch_execz P_END
  v_mfma_f32_32x32x16_bf16 v[64:79], v[200:203], v[152:155], v[64:79]
  buffer_store_dwordx4 v[4:7], v2, s[52:55], s68 offen offset:1024 sc1
  v_exp_f32 v120, v120
  v_exp_f32 v121, v121
  v_exp_f32 v122, v122
  v_exp_f32 v123, v123
  v_cvt_pk_bf16_f32 v148, v120, v121
  v_cvt_pk_bf16_f32 v149, v122, v123
  v_mfma_f32_32x32x16_bf16 v[64:79], v[204:207], v[156:159], v[64:79]
  s_waitcnt vmcnt(15)
  v_max_u32 v0, v208, v212
  v_cmp_eq_u32 vcc, -1, v0
  v_exp_f32 v124, v124
  v_exp_f32 v125, v125
  v_exp_f32 v126, v126
  v_exp_f32 v127, v127
  v_cvt_pk_bf16_f32 v150, v124, v125
  v_cvt_pk_bf16_f32 v151, v126, v127
  s_cbranch_vccnz CK3_H
CK3_B:
  v_mfma_f32_32x32x16_bf16 v[112:127], v[208:211], v[16:19], 0
  s_waitcnt vmcnt(7)
  s_mov_b64 exec, 2
  buffer_store_dword v12, v13, s[36:39], 0 offen sc1
  s_mov_b64 exec, -1
  v_exp_f32 v128, v128
  v_exp_f32 v129, v129
  v_exp_f32 v130, v130
  v_exp_f32 v131, v131
  v_cvt_pk_bf16_f32 v152, v128, v129
  v_cvt_pk_bf16_f32 v153, v130, v131
  v_mfma_f32_32x32x16_bf16 v[112:127], v[212:215], v[20:23], v[112:127]
  buffer_store_dwordx4 v[4:7], v2, s[52:55], s69 offen offset:0 sc1
  v_exp_f32 v132, v132
  v_exp_f32 v133, v133
  v_exp_f32 v134, v134
  v_exp_f32 v135, v135
  v_cvt_pk_bf16_f32 v154, v132, v133
  v_cvt_pk_bf16_f32 v155, v134, v135
  v_mfma_f32_32x32x16_bf16 v[80:95], v[200:203], v[144:147], v[80:95]
  buffer_store_dwordx4 v[4:7], v2, s[52:55], s69 offen offset:1024 sc1
  v_exp_f32 v136, v136
  v_exp_f32 v137, v137
  v_exp_f32 v138, v138
  v_exp_f32 v139, v139
  v_cvt_pk_bf16_f32 v156, v136, v137
  v_cvt_pk_bf16_f32 v157, v138, v139
  v_mfma_f32_32x32x16_bf16 v[80:95], v[204:207], v[148:151], v[80:95]
  v_exp_f32 v140, v140
  v_exp_f32 v141, v141
  v_exp_f32 v142, v142
  v_exp_f32 v143, v143
  v_cvt_pk_bf16_f32 v158, v140, v141
  v_cvt_pk_bf16_f32 v159, v142, v143
  v_mfma_f32_32x32x16_bf16 v[128:143], v[208:211], v[24:27], 0
  global_load_dwordx4 v[192:195], v10, s[22:23] sc1
  v_exp_f32 v112, v112
  v_exp_f32 v113, v113
  v_exp_f32 v114, v114
  v_exp_f32 v115, v115
  v_cvt_pk_bf16_f32 v144, v112, v113
  v_cvt_pk_bf16_f32 v145, v114, v115
  v_mfma_f32_32x32x16_bf16 v[128:143], v[212:215], v[28:31], v[128:143]
  buffer_store_dwordx4 v[4:7], v3, s[52:55], s69 offen offset:0 sc1
  v_exp_f32 v116, v116
  v_exp_f32 v117, v117
  v_exp_f32 v118, v118
  v_exp_f32 v119, v119
  v_cvt_pk_bf16_f32 v146, v116, v117
  v_cvt_pk_bf16_f32 v147, v118, v119
  v_mfma_f32_32x32x16_bf16 v[96:111], v[200:203], v[152:155], v[96:111]
  global_load_dwordx4 v[196:199], v10, s[22:23] offset:1024 sc1
  v_exp_f32 v120, v120
  v_exp_f32 v121, v121
  v_exp_f32 v122, v122
  v_exp_f32 v123, v123
  v_cvt_pk_bf16_f32 v148, v120, v121
  v_cvt_pk_bf16_f32 v149, v122, v123
  v_mfma_f32_32x32x16_bf16 v[96:111], v[204:207], v[156:159], v[96:111]
  v_exp_f32 v124, v124
  v_exp_f32 v125, v125
  v_exp_f32 v126, v126
  v_exp_f32 v127, v127
  v_cvt_pk_bf16_f32 v150, v124, v125
  v_cvt_pk_bf16_f32 v151, v126, v127
  v_mfma_f32_32x32x16_bf16 v[112:127], v[208:211], v[32:35], 0
  global_load_dwordx4 v[200:203], v10, s[24:25] sc1
  v_exp_f32 v128, v128
  v_exp_f32 v129, v129
  v_exp_f32 v130, v130
  v_exp_f32 v131, v131
  v_cvt_pk_bf16_f32 v152, v128, v129
  v_cvt_pk_bf16_f32 v153, v130, v131
  v_mfma_f32_32x32x16_bf16 v[112:127], v[212:215], v[36:39], v[112:127]
  s_waitcnt vmcnt(20)
  v_max_u32 v0, v216, v220
  v_cmp_eq_u32 vcc, -1, v0
  v_exp_f32 v132, v132
  v_exp_f32 v133, v133
  v_exp_f32 v134, v134
  v_exp_f32 v135, v135
  v_cvt_pk_bf16_f32 v154, v132, v133
  v_cvt_pk_bf16_f32 v155, v134, v135
  s_cbranch_vccnz CV3_H
CV3_B:
  v_mfma_f32_32x32x16_bf16 v[48:63], v[216:219], v[144:147], v[48:63]
  global_load_dwordx4 v[204:207], v10, s[24:25] offset:1024 sc1
  v_exp_f32 v136, v136
  v_exp_f32 v137, v137
  v_exp_f32 v138, v138
  v_exp_f32 v139, v139
  v_cvt_pk_bf16_f32 v156, v136, v137
  v_cvt_pk_bf16_f32 v157, v138, v139
  v_mfma_f32_32x32x16_bf16 v[48:63], v[220:223], v[148:151], v[48:63]
  buffer_store_dwordx4 v[4:7], v3, s[52:55], s69 offen offset:1024 sc1
  v_exp_f32 v140, v140
  v_exp_f32 v141, v141
  v_exp_f32 v142, v142
  v_exp_f32 v143, v143
  v_cvt_pk_bf16_f32 v158, v140, v141
  v_cvt_pk_bf16_f32 v159, v142, v143
  v_mfma_f32_32x32x16_bf16 v[128:143], v[208:211], v[40:43], 0
  buffer_store_dwordx4 v[4:7], v2, s[52:55], s70 offen offset:0 sc1
  v_exp_f32 v112, v112
  v_exp_f32 v113, v113
  v_exp_f32 v114, v114
  v_exp_f32 v115, v115
  v_cvt_pk_bf16_f32 v144, v112, v113
  v_cvt_pk_bf16_f32 v145, v114, v115
  v_mfma_f32_32x32x16_bf16 v[128:143], v[212:215], v[44:47], v[128:143]
  v_exp_f32 v116, v116
  v_exp_f32 v117, v117
  v_exp_f32 v118, v118
  v_exp_f32 v119, v119
  v_cvt_pk_bf16_f32 v146, v116, v117
  v_cvt_pk_bf16_f32 v147, v118, v119
  v_mfma_f32_32x32x16_bf16 v[64:79], v[216:219], v[152:155], v[64:79]
  v_exp_f32 v120, v120
  v_exp_f32 v121, v121
  v_exp_f32 v122, v122
  v_exp_f32 v123, v123
  v_cvt_pk_bf16_f32 v148, v120, v121
  v_cvt_pk_bf16_f32 v149, v122, v123
  v_mfma_f32_32x32x16_bf16 v[64:79], v[220:223], v[156:159], v[64:79]
  s_waitcnt vmcnt(21)
  v_max_u32 v0, v160, v164
  v_cmp_eq_u32 vcc, -1, v0
  v_exp_f32 v124, v124
  v_exp_f32 v125, v125
  v_exp_f32 v126, v126
  v_exp_f32 v127, v127
  v_cvt_pk_bf16_f32 v150, v124, v125
  v_cvt_pk_bf16_f32 v151, v126, v127
  s_cbranch_vccnz CK4_H
CK4_B:
  v_mfma_f32_32x32x16_bf16 v[112:127], v[160:163], v[16:19], 0
  v_exp_f32 v128, v128
  v_exp_f32 v129, v129
  v_exp_f32 v130, v130
  v_exp_f32 v131, v131
  v_cvt_pk_bf16_f32 v152, v128, v129
  v_cvt_pk_bf16_f32 v153, v130, v131
  v_mfma_f32_32x32x16_bf16 v[112:127], v[164:167], v[20:23], v[112:127]
  v_exp_f32 v132, v132
  v_exp_f32 v133, v133
  v_exp_f32 v134, v134
  v_exp_f32 v135, v135
  v_cvt_pk_bf16_f32 v154, v132, v133
  v_cvt_pk_bf16_f32 v155, v134, v135
  v_mfma_f32_32x32x16_bf16 v[80:95], v[216:219], v[144:147], v[80:95]
  v_exp_f32 v136, v136
  v_exp_f32 v137, v137
  v_exp_f32 v138, v138
  v_exp_f32 v139, v139
  v_cvt_pk_bf16_f32 v156, v136, v137
  v_cvt_pk_bf16_f32 v157, v138, v139
  v_mfma_f32_32x32x16_bf16 v[80:95], v[220:223], v[148:151], v[80:95]
  v_exp_f32 v140, v140
  v_exp_f32 v141, v141
  v_exp_f32 v142, v142
  v_exp_f32 v143, v143
  v_cvt_pk_bf16_f32 v158, v140, v141
W19:
  s_cbranch_execz P_END
  v_cvt_pk_bf16_f32 v159, v142, v143
  v_mfma_f32_32x32x16_bf16 v[128:143], v[160:163], v[24:27], 0
  global_load_dwordx4 v[208:211], v11, s[22:23] sc1
  v_exp_f32 v112, v112
  v_exp_f32 v113, v113
  v_exp_f32 v114, v114
  v_exp_f32 v115, v115
  v_cvt_pk_bf16_f32 v144, v112, v113
  v_cvt_pk_bf16_f32 v145, v114, v115
  v_mfma_f32_32x32x16_bf16 v[128:143], v[164:167], v[28:31], v[128:143]
  v_exp_f32 v116, v116
  v_exp_f32 v117, v117
  v_exp_f32 v118, v118
  v_exp_f32 v119, v119
  v_cvt_pk_bf16_f32 v146, v116, v117
  v_cvt_pk_bf16_f32 v147, v118, v119
  v_mfma_f32_32x32x16_bf16 v[96:111], v[216:219], v[152:155], v[96:111]
  global_load_dwordx4 v[212:215], v11, s[22:23] offset:1024 sc1
  v_exp_f32 v120, v120
  v_exp_f32 v121, v121
  v_exp_f32 v122, v122
  v_exp_f32 v123, v123
  v_cvt_pk_bf16_f32 v148, v120, v121
  v_cvt_pk_bf16_f32 v149, v122, v123
  v_mfma_f32_32x32x16_bf16 v[96:111], v[220:223], v[156:159], v[96:111]
  v_exp_f32 v124, v124
  v_exp_f32 v125, v125
  v_exp_f32 v126, v126
  v_exp_f32 v127, v127
  v_cvt_pk_bf16_f32 v150, v124, v125
  v_cvt_pk_bf16_f32 v151, v126, v127
  v_mfma_f32_32x32x16_bf16 v[112:127], v[160:163], v[32:35], 0
  global_load_dwordx4 v[216:219], v11, s[24:25] sc1
  v_exp_f32 v128, v128
  v_exp_f32 v129, v129
  v_exp_f32 v130, v130
  v_exp_f32 v131, v131
  v_cvt_pk_bf16_f32 v152, v128, v129
  v_cvt_pk_bf16_f32 v153, v130, v131
  v_mfma_f32_32x32x16_bf16 v[112:127], v[164:167], v[36:39], v[112:127]
  s_waitcnt vmcnt(22)
  v_max_u32 v0, v168, v172
  v_cmp_eq_u32 vcc, -1, v0
  v_exp_f32 v132, v132
  v_exp_f32 v133, v133
  v_exp_f32 v134, v134
  v_exp_f32 v135, v135
  v_cvt_pk_bf16_f32 v154, v132, v133
  v_cvt_pk_bf16_f32 v155, v134, v135
  s_cbranch_vccnz CV4_H
CV4_B:
  v_mfma_f32_32x32x16_bf16 v[48:63], v[168:171], v[144:147], v[48:63]
  global_load_dwordx4 v[220:223], v11, s[24:25] offset:1024 sc1
  v_exp_f32 v136, v136
  v_exp_f32 v137, v137
  v_exp_f32 v138, v138
  v_exp_f32 v139, v139
  v_cvt_pk_bf16_f32 v156, v136, v137
  v_cvt_pk_bf16_f32 v157, v138, v139
  v_mfma_f32_32x32x16_bf16 v[48:63], v[172:175], v[148:151], v[48:63]
  v_exp_f32 v140, v140
  v_exp_f32 v141, v141
  v_exp_f32 v142, v142
  v_exp_f32 v143, v143
  v_cvt_pk_bf16_f32 v158, v140, v141
  v_cvt_pk_bf16_f32 v159, v142, v143
  v_mfma_f32_32x32x16_bf16 v[128:143], v[160:163], v[40:43], 0
  v_exp_f32 v112, v112
  v_exp_f32 v113, v113
  v_exp_f32 v114, v114
  v_exp_f32 v115, v115
  v_cvt_pk_bf16_f32 v144, v112, v113
  v_cvt_pk_bf16_f32 v145, v114, v115
  v_mfma_f32_32x32x16_bf16 v[128:143], v[164:167], v[44:47], v[128:143]
  v_exp_f32 v116, v116
  v_exp_f32 v117, v117
  v_exp_f32 v118, v118
  v_exp_f32 v119, v119
  v_cvt_pk_bf16_f32 v146, v116, v117
  v_cvt_pk_bf16_f32 v147, v118, v119
  v_mfma_f32_32x32x16_bf16 v[64:79], v[168:171], v[152:155], v[64:79]
  v_exp_f32 v120, v120
  v_exp_f32 v121, v121
  v_exp_f32 v122, v122
  v_exp_f32 v123, v123
  v_cvt_pk_bf16_f32 v148, v120, v121
  v_cvt_pk_bf16_f32 v149, v122, v123
  v_mfma_f32_32x32x16_bf16 v[64:79], v[172:175], v[156:159], v[64:79]
  s_waitcnt vmcnt(19)
  v_max_u32 v0, v176, v180
  v_cmp_eq_u32 vcc, -1, v0
  v_exp_f32 v124, v124
  v_exp_f32 v125, v125
  v_exp_f32 v126, v126
  v_exp_f32 v127, v127
  v_cvt_pk_bf16_f32 v150, v124, v125
  v_cvt_pk_bf16_f32 v151, v126, v127
  s_cbranch_vccnz CK5_H
CK5_B:
  v_mfma_f32_32x32x16_bf16 v[112:127], v[176:179], v[16:19], 0
  v_exp_f32 v128, v128
  v_exp_f32 v129, v129
  v_exp_f32 v130, v130
  v_exp_f32 v131, v131
  v_cvt_pk_bf16_f32 v152, v128, v129
  v_cvt_pk_bf16_f32 v153, v130, v131
  v_mfma_f32_32x32x16_bf16 v[112:127], v[180:183], v[20:23], v[112:127]
  v_exp_f32 v132, v132
  v_exp_f32 v133, v133
  v_exp_f32 v134, v134
  v_exp_f32 v135, v135
  v_cvt_pk_bf16_f32 v154, v132, v133
  v_cvt_pk_bf16_f32 v155, v134, v135
  v_mfma_f32_32x32x16_bf16 v[80:95], v[168:171], v[144:147], v[80:95]
  v_exp_f32 v136, v136
  v_exp_f32 v137, v137
  v_exp_f32 v138, v138
  v_exp_f32 v139, v139
  v_cvt_pk_bf16_f32 v156, v136, v137
  v_cvt_pk_bf16_f32 v157, v138, v139
  v_mfma_f32_32x32x16_bf16 v[80:95], v[172:175], v[148:151], v[80:95]
  v_exp_f32 v140, v140
  v_exp_f32 v141, v141
  v_exp_f32 v142, v142
  v_exp_f32 v143, v143
  v_cvt_pk_bf16_f32 v158, v140, v141
  v_cvt_pk_bf16_f32 v159, v142, v143
  v_mfma_f32_32x32x16_bf16 v[128:143], v[176:179], v[24:27], 0
  global_load_dwordx4 v[160:163], v8, s[26:27] sc1
  v_exp_f32 v112, v112
  v_exp_f32 v113, v113
  v_exp_f32 v114, v114
  v_exp_f32 v115, v115
  v_cvt_pk_bf16_f32 v144, v112, v113
  v_cvt_pk_bf16_f32 v145, v114, v115
  v_mfma_f32_32x32x16_bf16 v[128:143], v[180:183], v[28:31], v[128:143]
  v_exp_f32 v116, v116
  v_exp_f32 v117, v117
  v_exp_f32 v118, v118
  v_exp_f32 v119, v119
  v_cvt_pk_bf16_f32 v146, v116, v117
  v_cvt_pk_bf16_f32 v147, v118, v119
  v_mfma_f32_32x32x16_bf16 v[96:111], v[168:171], v[152:155], v[96:111]
  global_load_dwordx4 v[164:167], v8, s[26:27] offset:1024 sc1
  v_exp_f32 v120, v120
  v_exp_f32 v121, v121
  v_exp_f32 v122, v122
  v_exp_f32 v123, v123
  v_cvt_pk_bf16_f32 v148, v120, v121
  v_cvt_pk_bf16_f32 v149, v122, v123
  v_mfma_f32_32x32x16_bf16 v[96:111], v[172:175], v[156:159], v[96:111]
  v_exp_f32 v124, v124
  v_exp_f32 v125, v125
  v_exp_f32 v126, v126
  v_exp_f32 v127, v127
  v_cvt_pk_bf16_f32 v150, v124, v125
  v_cvt_pk_bf16_f32 v151, v126, v127
  v_mfma_f32_32x32x16_bf16 v[112:127], v[176:179], v[32:35], 0
  global_load_dwordx4 v[168:171], v8, s[34:35] sc1
  v_exp_f32 v128, v128
  v_exp_f32 v129, v129
  v_exp_f32 v130, v130
  v_exp_f32 v131, v131
  v_cvt_pk_bf16_f32 v152, v128, v129
  v_cvt_pk_bf16_f32 v153, v130, v131
  v_mfma_f32_32x32x16_bf16 v[112:127], v[180:183], v[36:39], v[112:127]
  s_waitcnt vmcnt(20)
  v_max_u32 v0, v184, v188
  v_cmp_eq_u32 vcc, -1, v0
  v_exp_f32 v132, v132
  v_exp_f32 v133, v133
  v_exp_f32 v134, v134
  v_exp_f32 v135, v135
  v_cvt_pk_bf16_f32 v154, v132, v133
  v_cvt_pk_bf16_f32 v155, v134, v135
  s_cbranch_vccnz CV5_H
CV5_B:
  v_mfma_f32_32x32x16_bf16 v[48:63], v[184:187], v[144:147], v[48:63]
  global_load_dwordx4 v[172:175], v8, s[34:35] offset:1024 sc1
  v_exp_f32 v136, v136
  v_exp_f32 v137, v137
  v_exp_f32 v138, v138
W20:
  s_cbranch_execz P_END
  v_exp_f32 v139, v139
  v_cvt_pk_bf16_f32 v156, v136, v137
  v_cvt_pk_bf16_f32 v157, v138, v139
  v_mfma_f32_32x32x16_bf16 v[48:63], v[188:191], v[148:151], v[48:63]
  v_min_u32 v0, 19, v1
  v_lshlrev_b32 v0, 7, v0
  buffer_load_dword v15, v0, s[36:39], s101 offen sc1
  v_exp_f32 v140, v140
  v_exp_f32 v141, v141
  v_exp_f32 v142, v142
  v_exp_f32 v143, v143
  v_cvt_pk_bf16_f32 v158, v140, v141
  v_cvt_pk_bf16_f32 v159, v142, v143
  v_mfma_f32_32x32x16_bf16 v[128:143], v[176:179], v[40:43], 0
  buffer_store_dwordx4 v[4:7], v2, s[52:55], s70 offen offset:1024 sc1
  v_exp_f32 v112, v112
  v_exp_f32 v113, v113
  v_exp_f32 v114, v114
  v_exp_f32 v115, v115
  v_cvt_pk_bf16_f32 v144, v112, v113
  v_cvt_pk_bf16_f32 v145, v114, v115
  v_mfma_f32_32x32x16_bf16 v[128:143], v[180:183], v[44:47], v[128:143]
  v_exp_f32 v116, v116
  v_exp_f32 v117, v117
  v_exp_f32 v118, v118
  v_exp_f32 v119, v119
  v_cvt_pk_bf16_f32 v146, v116, v117
  v_cvt_pk_bf16_f32 v147, v118, v119
  v_mfma_f32_32x32x16_bf16 v[64:79], v[184:187], v[152:155], v[64:79]
  v_exp_f32 v120, v120
  v_exp_f32 v121, v121
  v_exp_f32 v122, v122
  v_exp_f32 v123, v123
  v_cvt_pk_bf16_f32 v148, v120, v121
  v_cvt_pk_bf16_f32 v149, v122, v123
  v_mfma_f32_32x32x16_bf16 v[64:79], v[188:191], v[156:159], v[64:79]
  s_waitcnt vmcnt(14)
  v_max_u32 v0, v192, v196
  v_cmp_eq_u32 vcc, -1, v0
  v_exp_f32 v124, v124
  v_exp_f32 v125, v125
  v_exp_f32 v126, v126
  v_exp_f32 v127, v127
  v_cvt_pk_bf16_f32 v150, v124, v125
  v_cvt_pk_bf16_f32 v151, v126, v127
  s_cbranch_vccnz CK6_H
CK6_B:
  v_mfma_f32_32x32x16_bf16 v[112:127], v[192:195], v[16:19], 0
  buffer_store_dwordx4 v[4:7], v3, s[52:55], s70 offen offset:0 sc1
  v_exp_f32 v128, v128
  v_exp_f32 v129, v129
  v_exp_f32 v130, v130
  v_exp_f32 v131, v131
  v_cvt_pk_bf16_f32 v152, v128, v129
  v_cvt_pk_bf16_f32 v153, v130, v131
  v_mfma_f32_32x32x16_bf16 v[112:127], v[196:199], v[20:23], v[112:127]
  v_exp_f32 v132, v132
  v_exp_f32 v133, v133
  v_exp_f32 v134, v134
  v_exp_f32 v135, v135
  v_cvt_pk_bf16_f32 v154, v132, v133
  v_cvt_pk_bf16_f32 v155, v134, v135
  v_mfma_f32_32x32x16_bf16 v[80:95], v[184:187], v[144:147], v[80:95]
  v_exp_f32 v136, v136
  v_exp_f32 v137, v137
  v_exp_f32 v138, v138
  v_exp_f32 v139, v139
  v_cvt_pk_bf16_f32 v156, v136, v137
  v_cvt_pk_bf16_f32 v157, v138, v139
  v_mfma_f32_32x32x16_bf16 v[80:95], v[188:191], v[148:151], v[80:95]
  v_exp_f32 v140, v140
  v_exp_f32 v141, v141
  v_exp_f32 v142, v142
  v_exp_f32 v143, v143
  v_cvt_pk_bf16_f32 v158, v140, v141
  v_cvt_pk_bf16_f32 v159, v142, v143
  v_mfma_f32_32x32x16_bf16 v[128:143], v[192:195], v[24:27], 0
  global_load_dwordx4 v[176:179], v9, s[26:27] sc1
  v_exp_f32 v112, v112
  v_exp_f32 v113, v113
  v_exp_f32 v114, v114
  v_exp_f32 v115, v115
  v_cvt_pk_bf16_f32 v144, v112, v113
  v_cvt_pk_bf16_f32 v145, v114, v115
  v_mfma_f32_32x32x16_bf16 v[128:143], v[196:199], v[28:31], v[128:143]
  buffer_store_dwordx4 v[4:7], v3, s[52:55], s70 offen offset:1024 sc1
  v_exp_f32 v116, v116
  v_exp_f32 v117, v117
  v_exp_f32 v118, v118
  v_exp_f32 v119, v119
  v_cvt_pk_bf16_f32 v146, v116, v117
  v_cvt_pk_bf16_f32 v147, v118, v119
  v_mfma_f32_32x32x16_bf16 v[96:111], v[184:187], v[152:155], v[96:111]
  global_load_dwordx4 v[180:183], v9, s[26:27] offset:1024 sc1
  v_exp_f32 v120, v120
  v_exp_f32 v121, v121
  v_exp_f32 v122, v122
  v_exp_f32 v123, v123
  v_cvt_pk_bf16_f32 v148, v120, v121
  v_cvt_pk_bf16_f32 v149, v122, v123
  v_mfma_f32_32x32x16_bf16 v[96:111], v[188:191], v[156:159], v[96:111]
  v_exp_f32 v124, v124
  v_exp_f32 v125, v125
  v_exp_f32 v126, v126
  v_exp_f32 v127, v127
  v_cvt_pk_bf16_f32 v150, v124, v125
  v_cvt_pk_bf16_f32 v151, v126, v127
  v_mfma_f32_32x32x16_bf16 v[112:127], v[192:195], v[32:35], 0
  global_load_dwordx4 v[184:187], v9, s[34:35] sc1
  v_exp_f32 v128, v128
  v_exp_f32 v129, v129
  v_exp_f32 v130, v130
  v_exp_f32 v131, v131
  v_cvt_pk_bf16_f32 v152, v128, v129
  v_cvt_pk_bf16_f32 v153, v130, v131
  v_mfma_f32_32x32x16_bf16 v[112:127], v[196:199], v[36:39], v[112:127]
  s_waitcnt vmcnt(17)
  v_max_u32 v0, v200, v204
  v_cmp_eq_u32 vcc, -1, v0
  v_exp_f32 v132, v132
  v_exp_f32 v133, v133
  v_exp_f32 v134, v134
  v_exp_f32 v135, v135
  v_cvt_pk_bf16_f32 v154, v132, v133
  v_cvt_pk_bf16_f32 v155, v134, v135
  s_cbranch_vccnz CV6_H
CV6_B:
  v_mfma_f32_32x32x16_bf16 v[48:63], v[200:203], v[144:147], v[48:63]
  global_load_dwordx4 v[188:191], v9, s[34:35] offset:1024 sc1
  v_exp_f32 v136, v136
  v_exp_f32 v137, v137
  v_exp_f32 v138, v138
  v_exp_f32 v139, v139
  v_cvt_pk_bf16_f32 v156, v136, v137
  v_cvt_pk_bf16_f32 v157, v138, v139
  v_mfma_f32_32x32x16_bf16 v[48:63], v[204:207], v[148:151], v[48:63]
  buffer_store_dwordx4 v[4:7], v2, s[52:55], s47 offen offset:0 sc1
  v_exp_f32 v140, v140
  v_exp_f32 v141, v141
  v_exp_f32 v142, v142
  v_exp_f32 v143, v143
  v_cvt_pk_bf16_f32 v158, v140, v141
  v_cvt_pk_bf16_f32 v159, v142, v143
  v_mfma_f32_32x32x16_bf16 v[128:143], v[192:195], v[40:43], 0
  buffer_store_dwordx4 v[4:7], v2, s[52:55], s47 offen offset:1024 sc1
  v_exp_f32 v112, v112
  v_exp_f32 v113, v113
  v_exp_f32 v114, v114
  v_exp_f32 v115, v115
  v_cvt_pk_bf16_f32 v144, v112, v113
  v_cvt_pk_bf16_f32 v145, v114, v115
  v_mfma_f32_32x32x16_bf16 v[128:143], v[196:199], v[44:47], v[128:143]
  v_exp_f32 v116, v116
  v_exp_f32 v117, v117
  v_exp_f32 v118, v118
  v_exp_f32 v119, v119
  v_cvt_pk_bf16_f32 v146, v116, v117
  v_cvt_pk_bf16_f32 v147, v118, v119
  v_mfma_f32_32x32x16_bf16 v[64:79], v[200:203], v[152:155], v[64:79]
  v_exp_f32 v120, v120
  v_exp_f32 v121, v121
  v_exp_f32 v122, v122
  v_exp_f32 v123, v123
  v_cvt_pk_bf16_f32 v148, v120, v121
  v_cvt_pk_bf16_f32 v149, v122, v123
  v_mfma_f32_32x32x16_bf16 v[64:79], v[204:207], v[156:159], v[64:79]
  s_waitcnt vmcnt(16)
  v_max_u32 v0, v208, v212
  v_cmp_eq_u32 vcc, -1, v0
  v_exp_f32 v124, v124
  v_exp_f32 v125, v125
  v_exp_f32 v126, v126
  v_exp_f32 v127, v127
  v_cvt_pk_bf16_f32 v150, v124, v125
  v_cvt_pk_bf16_f32 v151, v126, v127
  s_cbranch_vccnz CK7_H
CK7_B:
  v_mfma_f32_32x32x16_bf16 v[112:127], v[208:211], v[16:19], 0
  buffer_store_dwordx4 v[4:7], v3, s[52:55], s47 offen offset:0 sc1
  v_exp_f32 v128, v128
  v_exp_f32 v129, v129
W21:
  s_cbranch_execz P_END
  v_exp_f32 v130, v130
  v_exp_f32 v131, v131
  v_cvt_pk_bf16_f32 v152, v128, v129
  v_cvt_pk_bf16_f32 v153, v130, v131
  v_mfma_f32_32x32x16_bf16 v[112:127], v[212:215], v[20:23], v[112:127]
  v_exp_f32 v132, v132
  v_exp_f32 v133, v133
  v_exp_f32 v134, v134
  v_exp_f32 v135, v135
  v_cvt_pk_bf16_f32 v154, v132, v133
  v_cvt_pk_bf16_f32 v155, v134, v135
  v_mfma_f32_32x32x16_bf16 v[80:95], v[200:203], v[144:147], v[80:95]
  v_exp_f32 v136, v136
  v_exp_f32 v137, v137
  v_exp_f32 v138, v138
  v_exp_f32 v139, v139
  v_cvt_pk_bf16_f32 v156, v136, v137
  v_cvt_pk_bf16_f32 v157, v138, v139
  v_mfma_f32_32x32x16_bf16 v[80:95], v[204:207], v[148:151], v[80:95]
  v_exp_f32 v140, v140
  v_exp_f32 v141, v141
  v_exp_f32 v142, v142
  v_exp_f32 v143, v143
  v_cvt_pk_bf16_f32 v158, v140, v141
  v_cvt_pk_bf16_f32 v159, v142, v143
  v_mfma_f32_32x32x16_bf16 v[128:143], v[208:211], v[24:27], 0
  global_load_dwordx4 v[192:195], v10, s[26:27] sc1
  v_exp_f32 v112, v112
  v_exp_f32 v113, v113
  v_exp_f32 v114, v114
  v_exp_f32 v115, v115
  v_cvt_pk_bf16_f32 v144, v112, v113
  v_cvt_pk_bf16_f32 v145, v114, v115
  v_mfma_f32_32x32x16_bf16 v[128:143], v[212:215], v[28:31], v[128:143]
  v_exp_f32 v116, v116
  v_exp_f32 v117, v117
  v_exp_f32 v118, v118
  v_exp_f32 v119, v119
  v_cvt_pk_bf16_f32 v146, v116, v117
  v_cvt_pk_bf16_f32 v147, v118, v119
  v_mfma_f32_32x32x16_bf16 v[96:111], v[200:203], v[152:155], v[96:111]
  global_load_dwordx4 v[196:199], v10, s[26:27] offset:1024 sc1
  v_exp_f32 v120, v120
  v_exp_f32 v121, v121
  v_exp_f32 v122, v122
  v_exp_f32 v123, v123
  v_cvt_pk_bf16_f32 v148, v120, v121
  v_cvt_pk_bf16_f32 v149, v122, v123
  v_mfma_f32_32x32x16_bf16 v[96:111], v[204:207], v[156:159], v[96:111]
  v_exp_f32 v124, v124
  v_exp_f32 v125, v125
  v_exp_f32 v126, v126
  v_exp_f32 v127, v127
  v_cvt_pk_bf16_f32 v150, v124, v125
  v_cvt_pk_bf16_f32 v151, v126, v127
  v_mfma_f32_32x32x16_bf16 v[112:127], v[208:211], v[32:35], 0
  global_load_dwordx4 v[200:203], v10, s[34:35] sc1
  v_exp_f32 v128, v128
  v_exp_f32 v129, v129
  v_exp_f32 v130, v130
  v_exp_f32 v131, v131
  v_cvt_pk_bf16_f32 v152, v128, v129
  v_cvt_pk_bf16_f32 v153, v130, v131
  v_mfma_f32_32x32x16_bf16 v[112:127], v[212:215], v[36:39], v[112:127]
  s_waitcnt vmcnt(18)
  v_max_u32 v0, v216, v220
  v_cmp_eq_u32 vcc, -1, v0
  v_exp_f32 v132, v132
  v_exp_f32 v133, v133
  v_exp_f32 v134, v134
  v_exp_f32 v135, v135
  v_cvt_pk_bf16_f32 v154, v132, v133
  v_cvt_pk_bf16_f32 v155, v134, v135
  s_cbranch_vccnz CV7_H
CV7_B:
  v_mfma_f32_32x32x16_bf16 v[48:63], v[216:219], v[144:147], v[48:63]
  global_load_dwordx4 v[204:207], v10, s[34:35] offset:1024 sc1
  v_exp_f32 v136, v136
  v_exp_f32 v137, v137
  v_exp_f32 v138, v138
  v_exp_f32 v139, v139
  v_cvt_pk_bf16_f32 v156, v136, v137
  v_cvt_pk_bf16_f32 v157, v138, v139
  v_mfma_f32_32x32x16_bf16 v[48:63], v[220:223], v[148:151], v[48:63]
  v_exp_f32 v140, v140
  v_exp_f32 v141, v141
  v_exp_f32 v142, v142
  v_exp_f32 v143, v143
  v_cvt_pk_bf16_f32 v158, v140, v141
  v_cvt_pk_bf16_f32 v159, v142, v143
  v_mfma_f32_32x32x16_bf16 v[128:143], v[208:211], v[40:43], 0
  s_waitcnt vmcnt(14)
  v_cmp_eq_u32 vcc, -1, v15
  s_nop 1
  s_cbranch_vccnz CFCK_H
CFCK_B:
  v_exp_f32 v112, v112
  v_exp_f32 v113, v113
  v_exp_f32 v114, v114
  v_exp_f32 v115, v115
  v_cvt_pk_bf16_f32 v144, v112, v113
  v_cvt_pk_bf16_f32 v145, v114, v115
  v_mfma_f32_32x32x16_bf16 v[128:143], v[212:215], v[44:47], v[128:143]
  global_load_dwordx4 v[224:227], v2, s[14:15] offset:-4096 sc1
  v_exp_f32 v116, v116
  v_exp_f32 v117, v117
  v_exp_f32 v118, v118
  v_exp_f32 v119, v119
  v_cvt_pk_bf16_f32 v146, v116, v117
  v_cvt_pk_bf16_f32 v147, v118, v119
  v_mfma_f32_32x32x16_bf16 v[64:79], v[216:219], v[152:155], v[64:79]
  global_load_dwordx4 v[228:231], v2, s[14:15] offset:-3072 sc1
  v_exp_f32 v120, v120
  v_exp_f32 v121, v121
  v_exp_f32 v122, v122
  v_exp_f32 v123, v123
  v_cvt_pk_bf16_f32 v148, v120, v121
  v_cvt_pk_bf16_f32 v149, v122, v123
  v_mfma_f32_32x32x16_bf16 v[64:79], v[220:223], v[156:159], v[64:79]
  s_waitcnt vmcnt(19)
  v_max_u32 v0, v160, v164
  v_cmp_eq_u32 vcc, -1, v0
  v_exp_f32 v124, v124
  v_exp_f32 v125, v125
  v_exp_f32 v126, v126
  v_exp_f32 v127, v127
  v_cvt_pk_bf16_f32 v150, v124, v125
  v_cvt_pk_bf16_f32 v151, v126, v127
  s_cbranch_vccnz CK8_H
CK8_B:
  v_mfma_f32_32x32x16_bf16 v[112:127], v[160:163], v[16:19], 0
  global_load_dwordx4 v[232:235], v2, s[14:15] offset:-2048 sc1
  v_exp_f32 v128, v128
  v_exp_f32 v129, v129
  v_exp_f32 v130, v130
  v_exp_f32 v131, v131
  v_cvt_pk_bf16_f32 v152, v128, v129
  v_cvt_pk_bf16_f32 v153, v130, v131
  v_mfma_f32_32x32x16_bf16 v[112:127], v[164:167], v[20:23], v[112:127]
  global_load_dwordx4 v[236:239], v2, s[14:15] offset:-1024 sc1
  v_exp_f32 v132, v132
  v_exp_f32 v133, v133
  v_exp_f32 v134, v134
  v_exp_f32 v135, v135
  v_cvt_pk_bf16_f32 v154, v132, v133
  v_cvt_pk_bf16_f32 v155, v134, v135
  v_mfma_f32_32x32x16_bf16 v[80:95], v[216:219], v[144:147], v[80:95]
  buffer_store_dwordx4 v[4:7], v3, s[52:55], s47 offen offset:1024 sc1
  v_exp_f32 v136, v136
  v_exp_f32 v137, v137
  v_exp_f32 v138, v138
  v_exp_f32 v139, v139
  v_cvt_pk_bf16_f32 v156, v136, v137
  v_cvt_pk_bf16_f32 v157, v138, v139
  v_mfma_f32_32x32x16_bf16 v[80:95], v[220:223], v[148:151], v[80:95]
  global_load_dwordx4 v[240:243], v2, s[14:15] offset:0 sc1
  v_exp_f32 v140, v140
  v_exp_f32 v141, v141
  v_exp_f32 v142, v142
  v_exp_f32 v143, v143
  v_cvt_pk_bf16_f32 v158, v140, v141
  v_cvt_pk_bf16_f32 v159, v142, v143
  v_mfma_f32_32x32x16_bf16 v[128:143], v[160:163], v[24:27], 0
  global_load_dwordx4 v[208:211], v11, s[26:27] sc1
  v_exp_f32 v112, v112
  v_exp_f32 v113, v113
  v_exp_f32 v114, v114
  v_exp_f32 v115, v115
  v_cvt_pk_bf16_f32 v144, v112, v113
  v_cvt_pk_bf16_f32 v145, v114, v115
  v_mfma_f32_32x32x16_bf16 v[128:143], v[164:167], v[28:31], v[128:143]
  global_load_dwordx4 v[244:247], v2, s[14:15] offset:1024 sc1
  v_exp_f32 v116, v116
  v_exp_f32 v117, v117
  v_exp_f32 v118, v118
  v_exp_f32 v119, v119
  v_cvt_pk_bf16_f32 v146, v116, v117
  v_cvt_pk_bf16_f32 v147, v118, v119
  v_mfma_f32_32x32x16_bf16 v[96:111], v[216:219], v[152:155], v[96:111]
  global_load_dwordx4 v[212:215], v11, s[26:27] offset:1024 sc1
W22:
  s_cbranch_execz P_END
  v_exp_f32 v120, v120
  v_exp_f32 v121, v121
  v_exp_f32 v122, v122
  v_exp_f32 v123, v123
  v_cvt_pk_bf16_f32 v148, v120, v121
  v_cvt_pk_bf16_f32 v149, v122, v123
  v_mfma_f32_32x32x16_bf16 v[96:111], v[220:223], v[156:159], v[96:111]
  global_load_dwordx4 v[248:251], v2, s[14:15] offset:2048 sc1
  v_exp_f32 v124, v124
  v_exp_f32 v125, v125
  v_exp_f32 v126, v126
  v_exp_f32 v127, v127
  v_cvt_pk_bf16_f32 v150, v124, v125
  v_cvt_pk_bf16_f32 v151, v126, v127
  v_mfma_f32_32x32x16_bf16 v[112:127], v[160:163], v[32:35], 0
  global_load_dwordx4 v[216:219], v11, s[34:35] sc1
  v_exp_f32 v128, v128
  v_exp_f32 v129, v129
  v_exp_f32 v130, v130
  v_exp_f32 v131, v131
  v_cvt_pk_bf16_f32 v152, v128, v129
  v_cvt_pk_bf16_f32 v153, v130, v131
  v_mfma_f32_32x32x16_bf16 v[112:127], v[164:167], v[36:39], v[112:127]
  s_waitcnt vmcnt(26)
  v_max_u32 v0, v168, v172
  v_cmp_eq_u32 vcc, -1, v0
  v_exp_f32 v132, v132
  v_exp_f32 v133, v133
  v_exp_f32 v134, v134
  v_exp_f32 v135, v135
  v_cvt_pk_bf16_f32 v154, v132, v133
  v_cvt_pk_bf16_f32 v155, v134, v135
  s_cbranch_vccnz CV8_H
CV8_B:
  v_mfma_f32_32x32x16_bf16 v[48:63], v[168:171], v[144:147], v[48:63]
  global_load_dwordx4 v[220:223], v11, s[34:35] offset:1024 sc1
  v_exp_f32 v136, v136
  v_exp_f32 v137, v137
  v_exp_f32 v138, v138
  v_exp_f32 v139, v139
  v_cvt_pk_bf16_f32 v156, v136, v137
  v_cvt_pk_bf16_f32 v157, v138, v139
  v_mfma_f32_32x32x16_bf16 v[48:63], v[172:175], v[148:151], v[48:63]
  global_load_dwordx4 v[252:255], v2, s[14:15] offset:3072 sc1
  v_exp_f32 v140, v140
  v_exp_f32 v141, v141
  v_exp_f32 v142, v142
  v_exp_f32 v143, v143
  v_cvt_pk_bf16_f32 v158, v140, v141
  v_cvt_pk_bf16_f32 v159, v142, v143
  v_mfma_f32_32x32x16_bf16 v[128:143], v[160:163], v[40:43], 0
  global_load_dwordx4 a[232:235], v2, s[74:75] offset:-4096 sc1
  v_exp_f32 v112, v112
  v_exp_f32 v113, v113
  v_exp_f32 v114, v114
  v_exp_f32 v115, v115
  v_cvt_pk_bf16_f32 v144, v112, v113
  v_cvt_pk_bf16_f32 v145, v114, v115
  v_mfma_f32_32x32x16_bf16 v[128:143], v[164:167], v[44:47], v[128:143]
  global_load_dwordx4 a[236:239], v2, s[74:75] offset:-3072 sc1
  v_exp_f32 v116, v116
  v_exp_f32 v117, v117
  v_exp_f32 v118, v118
  v_exp_f32 v119, v119
  v_cvt_pk_bf16_f32 v146, v116, v117
  v_cvt_pk_bf16_f32 v147, v118, v119
  v_mfma_f32_32x32x16_bf16 v[64:79], v[168:171], v[152:155], v[64:79]
  global_load_dwordx4 a[240:243], v2, s[74:75] offset:-2048 sc1
  v_exp_f32 v120, v120
  v_exp_f32 v121, v121
  v_exp_f32 v122, v122
  v_exp_f32 v123, v123
  v_cvt_pk_bf16_f32 v148, v120, v121
  v_cvt_pk_bf16_f32 v149, v122, v123
  v_mfma_f32_32x32x16_bf16 v[64:79], v[172:175], v[156:159], v[64:79]
  s_waitcnt vmcnt(25)
  v_max_u32 v0, v176, v180
  v_cmp_eq_u32 vcc, -1, v0
  v_exp_f32 v124, v124
  v_exp_f32 v125, v125
  v_exp_f32 v126, v126
  v_exp_f32 v127, v127
  v_cvt_pk_bf16_f32 v150, v124, v125
  v_cvt_pk_bf16_f32 v151, v126, v127
  s_cbranch_vccnz CK9_H
CK9_B:
  v_mfma_f32_32x32x16_bf16 v[112:127], v[176:179], v[16:19], 0
  global_load_dwordx4 a[244:247], v2, s[74:75] offset:-1024 sc1
  v_exp_f32 v128, v128
  v_exp_f32 v129, v129
  v_exp_f32 v130, v130
  v_exp_f32 v131, v131
  v_cvt_pk_bf16_f32 v152, v128, v129
  v_cvt_pk_bf16_f32 v153, v130, v131
  v_mfma_f32_32x32x16_bf16 v[112:127], v[180:183], v[20:23], v[112:127]
  global_load_dwordx4 a[248:251], v2, s[74:75] offset:0 sc1
  v_exp_f32 v132, v132
  v_exp_f32 v133, v133
  v_exp_f32 v134, v134
  v_exp_f32 v135, v135
  v_cvt_pk_bf16_f32 v154, v132, v133
  v_cvt_pk_bf16_f32 v155, v134, v135
  v_mfma_f32_32x32x16_bf16 v[80:95], v[168:171], v[144:147], v[80:95]
  global_load_dwordx4 a[252:255], v2, s[74:75] offset:1024 sc1
  v_exp_f32 v136, v136
  v_exp_f32 v137, v137
  v_exp_f32 v138, v138
  v_exp_f32 v139, v139
  v_cvt_pk_bf16_f32 v156, v136, v137
  v_cvt_pk_bf16_f32 v157, v138, v139
  v_mfma_f32_32x32x16_bf16 v[80:95], v[172:175], v[148:151], v[80:95]
  s_waitcnt vmcnt(14)
  s_mov_b64 exec, 1
  buffer_store_dword v12, v13, s[36:39], 0 offen sc1
  s_mov_b64 exec, -1
  v_exp_f32 v140, v140
  v_exp_f32 v141, v141
  v_exp_f32 v142, v142
  v_exp_f32 v143, v143
  v_cvt_pk_bf16_f32 v158, v140, v141
  v_cvt_pk_bf16_f32 v159, v142, v143
  v_mfma_f32_32x32x16_bf16 v[128:143], v[176:179], v[24:27], 0
  global_load_dwordx4 v[160:163], v8, s[16:17] sc1
  v_exp_f32 v112, v112
  v_exp_f32 v113, v113
  v_exp_f32 v114, v114
  v_exp_f32 v115, v115
  v_cvt_pk_bf16_f32 v144, v112, v113
  v_cvt_pk_bf16_f32 v145, v114, v115
  v_mfma_f32_32x32x16_bf16 v[128:143], v[180:183], v[28:31], v[128:143]
  global_load_dwordx4 a[112:115], v2, s[74:75] offset:2048 sc1
  v_exp_f32 v116, v116
  v_exp_f32 v117, v117
  v_exp_f32 v118, v118
  v_exp_f32 v119, v119
  v_cvt_pk_bf16_f32 v146, v116, v117
  v_cvt_pk_bf16_f32 v147, v118, v119
  v_mfma_f32_32x32x16_bf16 v[96:111], v[168:171], v[152:155], v[96:111]
  global_load_dwordx4 v[164:167], v8, s[16:17] offset:1024 sc1
  v_exp_f32 v120, v120
  v_exp_f32 v121, v121
  v_exp_f32 v122, v122
  v_exp_f32 v123, v123
  v_cvt_pk_bf16_f32 v148, v120, v121
  v_cvt_pk_bf16_f32 v149, v122, v123
  v_mfma_f32_32x32x16_bf16 v[96:111], v[172:175], v[156:159], v[96:111]
  global_load_dwordx4 a[228:231], v2, s[74:75] offset:3072 sc1
  v_exp_f32 v124, v124
  v_exp_f32 v125, v125
  v_exp_f32 v126, v126
  v_exp_f32 v127, v127
  v_cvt_pk_bf16_f32 v150, v124, v125
  v_cvt_pk_bf16_f32 v151, v126, v127
  v_mfma_f32_32x32x16_bf16 v[112:127], v[176:179], v[32:35], 0
  global_load_dwordx4 v[168:171], v8, s[28:29] sc1
  v_exp_f32 v128, v128
  v_exp_f32 v129, v129
  v_exp_f32 v130, v130
  v_exp_f32 v131, v131
  v_cvt_pk_bf16_f32 v152, v128, v129
  v_cvt_pk_bf16_f32 v153, v130, v131
  v_mfma_f32_32x32x16_bf16 v[112:127], v[180:183], v[36:39], v[112:127]
  s_waitcnt vmcnt(32)
  v_max_u32 v0, v184, v188
  v_cmp_eq_u32 vcc, -1, v0
  v_exp_f32 v132, v132
  v_exp_f32 v133, v133
  v_exp_f32 v134, v134
  v_exp_f32 v135, v135
  v_cvt_pk_bf16_f32 v154, v132, v133
  v_cvt_pk_bf16_f32 v155, v134, v135
  s_cbranch_vccnz CV9_H
CV9_B:
  v_mfma_f32_32x32x16_bf16 v[48:63], v[184:187], v[144:147], v[48:63]
  global_load_dwordx4 v[172:175], v8, s[28:29] offset:1024 sc1
  v_exp_f32 v136, v136
  v_exp_f32 v137, v137
  v_exp_f32 v138, v138
  v_exp_f32 v139, v139
  v_cvt_pk_bf16_f32 v156, v136, v137
W23:
  s_cbranch_execz P_END
  v_cvt_pk_bf16_f32 v157, v138, v139
  v_mfma_f32_32x32x16_bf16 v[48:63], v[188:191], v[148:151], v[48:63]
  s_add_u32 s14, s32, s66
  s_addc_u32 s15, s33, 0
  v_exp_f32 v140, v140
  v_exp_f32 v141, v141
  v_exp_f32 v142, v142
  v_exp_f32 v143, v143
  v_cvt_pk_bf16_f32 v158, v140, v141
  v_cvt_pk_bf16_f32 v159, v142, v143
  v_mfma_f32_32x32x16_bf16 v[128:143], v[176:179], v[40:43], 0
  global_load_dwordx4 a[0:3], v2, s[14:15] offset:-4096 sc1
  v_exp_f32 v112, v112
  v_exp_f32 v113, v113
  v_exp_f32 v114, v114
  v_exp_f32 v115, v115
  v_cvt_pk_bf16_f32 v144, v112, v113
  v_cvt_pk_bf16_f32 v145, v114, v115
  v_mfma_f32_32x32x16_bf16 v[128:143], v[180:183], v[44:47], v[128:143]
  global_load_dwordx4 a[4:7], v2, s[14:15] offset:-3072 sc1
  v_exp_f32 v116, v116
  v_exp_f32 v117, v117
  v_exp_f32 v118, v118
  v_exp_f32 v119, v119
  v_cvt_pk_bf16_f32 v146, v116, v117
  v_cvt_pk_bf16_f32 v147, v118, v119
  v_mfma_f32_32x32x16_bf16 v[64:79], v[184:187], v[152:155], v[64:79]
  global_load_dwordx4 a[8:11], v2, s[14:15] offset:-2048 sc1
  v_exp_f32 v120, v120
  v_exp_f32 v121, v121
  v_exp_f32 v122, v122
  v_exp_f32 v123, v123
  v_cvt_pk_bf16_f32 v148, v120, v121
  v_cvt_pk_bf16_f32 v149, v122, v123
  v_mfma_f32_32x32x16_bf16 v[64:79], v[188:191], v[156:159], v[64:79]
  s_waitcnt vmcnt(31)
  v_max_u32 v0, v192, v196
  v_cmp_eq_u32 vcc, -1, v0
  v_exp_f32 v124, v124
  v_exp_f32 v125, v125
  v_exp_f32 v126, v126
  v_exp_f32 v127, v127
  v_cvt_pk_bf16_f32 v150, v124, v125
  v_cvt_pk_bf16_f32 v151, v126, v127
  s_cbranch_vccnz CK10_H
CK10_B:
  v_mfma_f32_32x32x16_bf16 v[112:127], v[192:195], v[16:19], 0
  global_load_dwordx4 a[12:15], v2, s[14:15] offset:-1024 sc1
  v_exp_f32 v128, v128
  v_exp_f32 v129, v129
  v_exp_f32 v130, v130
  v_exp_f32 v131, v131
  v_cvt_pk_bf16_f32 v152, v128, v129
  v_cvt_pk_bf16_f32 v153, v130, v131
  v_mfma_f32_32x32x16_bf16 v[112:127], v[196:199], v[20:23], v[112:127]
  global_load_dwordx4 a[16:19], v2, s[14:15] offset:0 sc1
  v_exp_f32 v132, v132
  v_exp_f32 v133, v133
  v_exp_f32 v134, v134
  v_exp_f32 v135, v135
  v_cvt_pk_bf16_f32 v154, v132, v133
  v_cvt_pk_bf16_f32 v155, v134, v135
  v_mfma_f32_32x32x16_bf16 v[80:95], v[184:187], v[144:147], v[80:95]
  global_load_dwordx4 a[20:23], v2, s[14:15] offset:1024 sc1
  v_exp_f32 v136, v136
  v_exp_f32 v137, v137
  v_exp_f32 v138, v138
  v_exp_f32 v139, v139
  v_cvt_pk_bf16_f32 v156, v136, v137
  v_cvt_pk_bf16_f32 v157, v138, v139
  v_mfma_f32_32x32x16_bf16 v[80:95], v[188:191], v[148:151], v[80:95]
  global_load_dwordx4 a[24:27], v2, s[14:15] offset:2048 sc1
  v_exp_f32 v140, v140
  v_exp_f32 v141, v141
  v_exp_f32 v142, v142
  v_exp_f32 v143, v143
  v_cvt_pk_bf16_f32 v158, v140, v141
  v_cvt_pk_bf16_f32 v159, v142, v143
  v_mfma_f32_32x32x16_bf16 v[128:143], v[192:195], v[24:27], 0
  global_load_dwordx4 v[176:179], v9, s[16:17] sc1
  v_exp_f32 v112, v112
  v_exp_f32 v113, v113
  v_exp_f32 v114, v114
  v_exp_f32 v115, v115
  v_cvt_pk_bf16_f32 v144, v112, v113
  v_cvt_pk_bf16_f32 v145, v114, v115
  v_mfma_f32_32x32x16_bf16 v[128:143], v[196:199], v[28:31], v[128:143]
  global_load_dwordx4 a[28:31], v2, s[14:15] offset:3072 sc1
  v_exp_f32 v116, v116
  v_exp_f32 v117, v117
  v_exp_f32 v118, v118
  v_exp_f32 v119, v119
  v_cvt_pk_bf16_f32 v146, v116, v117
  v_cvt_pk_bf16_f32 v147, v118, v119
  v_mfma_f32_32x32x16_bf16 v[96:111], v[184:187], v[152:155], v[96:111]
  global_load_dwordx4 v[180:183], v9, s[16:17] offset:1024 sc1
  v_exp_f32 v120, v120
  v_exp_f32 v121, v121
  v_exp_f32 v122, v122
  v_exp_f32 v123, v123
  v_cvt_pk_bf16_f32 v148, v120, v121
  v_cvt_pk_bf16_f32 v149, v122, v123
  v_mfma_f32_32x32x16_bf16 v[96:111], v[188:191], v[156:159], v[96:111]
  s_add_u32 s74, s32, s64
  s_addc_u32 s75, s33, 0
  v_exp_f32 v124, v124
  v_exp_f32 v125, v125
  v_exp_f32 v126, v126
  v_exp_f32 v127, v127
  v_cvt_pk_bf16_f32 v150, v124, v125
  v_cvt_pk_bf16_f32 v151, v126, v127
  v_mfma_f32_32x32x16_bf16 v[112:127], v[192:195], v[32:35], 0
  global_load_dwordx4 v[184:187], v9, s[28:29] sc1
  v_exp_f32 v128, v128
  v_exp_f32 v129, v129
  v_exp_f32 v130, v130
  v_exp_f32 v131, v131
  v_cvt_pk_bf16_f32 v152, v128, v129
  v_cvt_pk_bf16_f32 v153, v130, v131
  v_mfma_f32_32x32x16_bf16 v[112:127], v[196:199], v[36:39], v[112:127]
  s_waitcnt vmcnt(37)
  v_max_u32 v0, v200, v204
  v_cmp_eq_u32 vcc, -1, v0
  v_exp_f32 v132, v132
  v_exp_f32 v133, v133
  v_exp_f32 v134, v134
  v_exp_f32 v135, v135
  v_cvt_pk_bf16_f32 v154, v132, v133
  v_cvt_pk_bf16_f32 v155, v134, v135
  s_cbranch_vccnz CV10_H
CV10_B:
  v_mfma_f32_32x32x16_bf16 v[48:63], v[200:203], v[144:147], v[48:63]
  global_load_dwordx4 v[188:191], v9, s[28:29] offset:1024 sc1
  v_exp_f32 v136, v136
  v_exp_f32 v137, v137
  v_exp_f32 v138, v138
  v_exp_f32 v139, v139
  v_cvt_pk_bf16_f32 v156, v136, v137
  v_cvt_pk_bf16_f32 v157, v138, v139
  v_mfma_f32_32x32x16_bf16 v[48:63], v[204:207], v[148:151], v[48:63]
  global_load_dwordx4 a[32:35], v2, s[74:75] offset:-4096 sc1
  v_exp_f32 v140, v140
  v_exp_f32 v141, v141
  v_exp_f32 v142, v142
  v_exp_f32 v143, v143
  v_cvt_pk_bf16_f32 v158, v140, v141
  v_cvt_pk_bf16_f32 v159, v142, v143
  v_mfma_f32_32x32x16_bf16 v[128:143], v[192:195], v[40:43], 0
  global_load_dwordx4 a[36:39], v2, s[74:75] offset:-3072 sc1
  v_exp_f32 v112, v112
  v_exp_f32 v113, v113
  v_exp_f32 v114, v114
  v_exp_f32 v115, v115
  v_cvt_pk_bf16_f32 v144, v112, v113
  v_cvt_pk_bf16_f32 v145, v114, v115
  v_mfma_f32_32x32x16_bf16 v[128:143], v[196:199], v[44:47], v[128:143]
  global_load_dwordx4 a[40:43], v2, s[74:75] offset:-2048 sc1
  v_exp_f32 v116, v116
  v_exp_f32 v117, v117
  v_exp_f32 v118, v118
  v_exp_f32 v119, v119
  v_cvt_pk_bf16_f32 v146, v116, v117
  v_cvt_pk_bf16_f32 v147, v118, v119
  v_mfma_f32_32x32x16_bf16 v[64:79], v[200:203], v[152:155], v[64:79]
  global_load_dwordx4 a[44:47], v2, s[74:75] offset:-1024 sc1
  v_exp_f32 v120, v120
  v_exp_f32 v121, v121
  v_exp_f32 v122, v122
  v_exp_f32 v123, v123
  v_cvt_pk_bf16_f32 v148, v120, v121
  v_cvt_pk_bf16_f32 v149, v122, v123
  v_mfma_f32_32x32x16_bf16 v[64:79], v[204:207], v[156:159], v[64:79]
  s_waitcnt vmcnt(33)
  v_max_u32 v0, v208, v212
  v_cmp_eq_u32 vcc, -1, v0
  v_exp_f32 v124, v124
  v_exp_f32 v125, v125
  v_exp_f32 v126, v126
W24:
  s_cbranch_execz P_END
  v_exp_f32 v127, v127
  v_cvt_pk_bf16_f32 v150, v124, v125
  v_cvt_pk_bf16_f32 v151, v126, v127
  s_cbranch_vccnz CK11_H
CK11_B:
  v_mfma_f32_32x32x16_bf16 v[112:127], v[208:211], v[16:19], 0
  global_load_dwordx4 a[48:51], v2, s[74:75] offset:0 sc1
  v_exp_f32 v128, v128
  v_exp_f32 v129, v129
  v_exp_f32 v130, v130
  v_exp_f32 v131, v131
  v_cvt_pk_bf16_f32 v152, v128, v129
  v_cvt_pk_bf16_f32 v153, v130, v131
  v_mfma_f32_32x32x16_bf16 v[112:127], v[212:215], v[20:23], v[112:127]
  global_load_dwordx4 a[52:55], v2, s[74:75] offset:1024 sc1
  v_exp_f32 v132, v132
  v_exp_f32 v133, v133
  v_exp_f32 v134, v134
  v_exp_f32 v135, v135
  v_cvt_pk_bf16_f32 v154, v132, v133
  v_cvt_pk_bf16_f32 v155, v134, v135
  v_mfma_f32_32x32x16_bf16 v[80:95], v[200:203], v[144:147], v[80:95]
  global_load_dwordx4 a[56:59], v2, s[74:75] offset:2048 sc1
  v_exp_f32 v136, v136
  v_exp_f32 v137, v137
  v_exp_f32 v138, v138
  v_exp_f32 v139, v139
  v_cvt_pk_bf16_f32 v156, v136, v137
  v_cvt_pk_bf16_f32 v157, v138, v139
  v_mfma_f32_32x32x16_bf16 v[80:95], v[204:207], v[148:151], v[80:95]
  global_load_dwordx4 a[60:63], v2, s[74:75] offset:3072 sc1
  v_exp_f32 v140, v140
  v_exp_f32 v141, v141
  v_exp_f32 v142, v142
  v_exp_f32 v143, v143
  v_cvt_pk_bf16_f32 v158, v140, v141
  v_cvt_pk_bf16_f32 v159, v142, v143
  v_mfma_f32_32x32x16_bf16 v[128:143], v[208:211], v[24:27], 0
  global_load_dwordx4 v[192:195], v10, s[16:17] sc1
  v_exp_f32 v112, v112
  v_exp_f32 v113, v113
  v_exp_f32 v114, v114
  v_exp_f32 v115, v115
  v_cvt_pk_bf16_f32 v144, v112, v113
  v_cvt_pk_bf16_f32 v145, v114, v115
  v_mfma_f32_32x32x16_bf16 v[128:143], v[212:215], v[28:31], v[128:143]
  s_add_u32 s14, s14, s65
  s_addc_u32 s15, s15, 0
  v_exp_f32 v116, v116
  v_exp_f32 v117, v117
  v_exp_f32 v118, v118
  v_exp_f32 v119, v119
  v_cvt_pk_bf16_f32 v146, v116, v117
  v_cvt_pk_bf16_f32 v147, v118, v119
  v_mfma_f32_32x32x16_bf16 v[96:111], v[200:203], v[152:155], v[96:111]
  global_load_dwordx4 v[196:199], v10, s[16:17] offset:1024 sc1
  v_exp_f32 v120, v120
  v_exp_f32 v121, v121
  v_exp_f32 v122, v122
  v_exp_f32 v123, v123
  v_cvt_pk_bf16_f32 v148, v120, v121
  v_cvt_pk_bf16_f32 v149, v122, v123
  v_mfma_f32_32x32x16_bf16 v[96:111], v[204:207], v[156:159], v[96:111]
  global_load_dwordx4 a[64:67], v2, s[14:15] offset:-4096 sc1
  v_exp_f32 v124, v124
  v_exp_f32 v125, v125
  v_exp_f32 v126, v126
  v_exp_f32 v127, v127
  v_cvt_pk_bf16_f32 v150, v124, v125
  v_cvt_pk_bf16_f32 v151, v126, v127
  v_mfma_f32_32x32x16_bf16 v[112:127], v[208:211], v[32:35], 0
  global_load_dwordx4 v[200:203], v10, s[28:29] sc1
  v_exp_f32 v128, v128
  v_exp_f32 v129, v129
  v_exp_f32 v130, v130
  v_exp_f32 v131, v131
  v_cvt_pk_bf16_f32 v152, v128, v129
  v_cvt_pk_bf16_f32 v153, v130, v131
  v_mfma_f32_32x32x16_bf16 v[112:127], v[212:215], v[36:39], v[112:127]
  s_waitcnt vmcnt(38)
  v_max_u32 v0, v216, v220
  v_cmp_eq_u32 vcc, -1, v0
  v_exp_f32 v132, v132
  v_exp_f32 v133, v133
  v_exp_f32 v134, v134
  v_exp_f32 v135, v135
  v_cvt_pk_bf16_f32 v154, v132, v133
  v_cvt_pk_bf16_f32 v155, v134, v135
  s_cbranch_vccnz CV11_H
CV11_B:
  v_mfma_f32_32x32x16_bf16 v[48:63], v[216:219], v[144:147], v[48:63]
  global_load_dwordx4 v[204:207], v10, s[28:29] offset:1024 sc1
  v_exp_f32 v136, v136
  v_exp_f32 v137, v137
  v_exp_f32 v138, v138
  v_exp_f32 v139, v139
  v_cvt_pk_bf16_f32 v156, v136, v137
  v_cvt_pk_bf16_f32 v157, v138, v139
  v_mfma_f32_32x32x16_bf16 v[48:63], v[220:223], v[148:151], v[48:63]
  global_load_dwordx4 a[68:71], v2, s[14:15] offset:-3072 sc1
  v_exp_f32 v140, v140
  v_exp_f32 v141, v141
  v_exp_f32 v142, v142
  v_exp_f32 v143, v143
  v_cvt_pk_bf16_f32 v158, v140, v141
  v_cvt_pk_bf16_f32 v159, v142, v143
  v_mfma_f32_32x32x16_bf16 v[128:143], v[208:211], v[40:43], 0
  global_load_dwordx4 a[72:75], v2, s[14:15] offset:-2048 sc1
  v_exp_f32 v112, v112
  v_exp_f32 v113, v113
  v_exp_f32 v114, v114
  v_exp_f32 v115, v115
  v_cvt_pk_bf16_f32 v144, v112, v113
  v_cvt_pk_bf16_f32 v145, v114, v115
  v_mfma_f32_32x32x16_bf16 v[128:143], v[212:215], v[44:47], v[128:143]
  global_load_dwordx4 a[76:79], v2, s[14:15] offset:-1024 sc1
  v_exp_f32 v116, v116
  v_exp_f32 v117, v117
  v_exp_f32 v118, v118
  v_exp_f32 v119, v119
  v_cvt_pk_bf16_f32 v146, v116, v117
  v_cvt_pk_bf16_f32 v147, v118, v119
  v_mfma_f32_32x32x16_bf16 v[64:79], v[216:219], v[152:155], v[64:79]
  global_load_dwordx4 a[80:83], v2, s[14:15] offset:0 sc1
  v_exp_f32 v120, v120
  v_exp_f32 v121, v121
  v_exp_f32 v122, v122
  v_exp_f32 v123, v123
  v_cvt_pk_bf16_f32 v148, v120, v121
  v_cvt_pk_bf16_f32 v149, v122, v123
  v_mfma_f32_32x32x16_bf16 v[64:79], v[220:223], v[156:159], v[64:79]
  s_waitcnt vmcnt(32)
  v_max_u32 v0, v160, v164
  v_cmp_eq_u32 vcc, -1, v0
  v_exp_f32 v124, v124
  v_exp_f32 v125, v125
  v_exp_f32 v126, v126
  v_exp_f32 v127, v127
  v_cvt_pk_bf16_f32 v150, v124, v125
  v_cvt_pk_bf16_f32 v151, v126, v127
  s_cbranch_vccnz CK12_H
CK12_B:
  v_mfma_f32_32x32x16_bf16 v[112:127], v[160:163], v[16:19], 0
  global_load_dwordx4 a[84:87], v2, s[14:15] offset:1024 sc1
  v_exp_f32 v128, v128
  v_exp_f32 v129, v129
  v_exp_f32 v130, v130
  v_exp_f32 v131, v131
  v_cvt_pk_bf16_f32 v152, v128, v129
  v_cvt_pk_bf16_f32 v153, v130, v131
  v_mfma_f32_32x32x16_bf16 v[112:127], v[164:167], v[20:23], v[112:127]
  global_load_dwordx4 a[88:91], v2, s[14:15] offset:2048 sc1
  v_exp_f32 v132, v132
  v_exp_f32 v133, v133
  v_exp_f32 v134, v134
  v_exp_f32 v135, v135
  v_cvt_pk_bf16_f32 v154, v132, v133
  v_cvt_pk_bf16_f32 v155, v134, v135
  v_mfma_f32_32x32x16_bf16 v[80:95], v[216:219], v[144:147], v[80:95]
  global_load_dwordx4 a[92:95], v2, s[14:15] offset:3072 sc1
  v_exp_f32 v136, v136
  v_exp_f32 v137, v137
  v_exp_f32 v138, v138
  v_exp_f32 v139, v139
  v_cvt_pk_bf16_f32 v156, v136, v137
  v_cvt_pk_bf16_f32 v157, v138, v139
  v_mfma_f32_32x32x16_bf16 v[80:95], v[220:223], v[148:151], v[80:95]
  s_add_u32 s74, s74, s65
  s_addc_u32 s75, s75, 0
  v_exp_f32 v140, v140
  v_exp_f32 v141, v141
  v_exp_f32 v142, v142
  v_exp_f32 v143, v143
  v_cvt_pk_bf16_f32 v158, v140, v141
  v_cvt_pk_bf16_f32 v159, v142, v143
  v_mfma_f32_32x32x16_bf16 v[128:143], v[160:163], v[24:27], 0
  global_load_dwordx4 v[208:211], v11, s[16:17] sc1
  v_exp_f32 v112, v112
W25:
  s_cbranch_execz P_END
  v_exp_f32 v113, v113
  v_exp_f32 v114, v114
  v_exp_f32 v115, v115
  v_cvt_pk_bf16_f32 v144, v112, v113
  v_cvt_pk_bf16_f32 v145, v114, v115
  v_mfma_f32_32x32x16_bf16 v[128:143], v[164:167], v[28:31], v[128:143]
  global_load_dwordx4 a[96:99], v2, s[74:75] offset:-4096 sc1
  v_exp_f32 v116, v116
  v_exp_f32 v117, v117
  v_exp_f32 v118, v118
  v_exp_f32 v119, v119
  v_cvt_pk_bf16_f32 v146, v116, v117
  v_cvt_pk_bf16_f32 v147, v118, v119
  v_mfma_f32_32x32x16_bf16 v[96:111], v[216:219], v[152:155], v[96:111]
  global_load_dwordx4 v[212:215], v11, s[16:17] offset:1024 sc1
  v_exp_f32 v120, v120
  v_exp_f32 v121, v121
  v_exp_f32 v122, v122
  v_exp_f32 v123, v123
  v_cvt_pk_bf16_f32 v148, v120, v121
  v_cvt_pk_bf16_f32 v149, v122, v123
  v_mfma_f32_32x32x16_bf16 v[96:111], v[220:223], v[156:159], v[96:111]
  global_load_dwordx4 a[100:103], v2, s[74:75] offset:-3072 sc1
  v_exp_f32 v124, v124
  v_exp_f32 v125, v125
  v_exp_f32 v126, v126
  v_exp_f32 v127, v127
  v_cvt_pk_bf16_f32 v150, v124, v125
  v_cvt_pk_bf16_f32 v151, v126, v127
  v_mfma_f32_32x32x16_bf16 v[112:127], v[160:163], v[32:35], 0
  global_load_dwordx4 v[216:219], v11, s[28:29] sc1
  v_exp_f32 v128, v128
  v_exp_f32 v129, v129
  v_exp_f32 v130, v130
  v_exp_f32 v131, v131
  v_cvt_pk_bf16_f32 v152, v128, v129
  v_cvt_pk_bf16_f32 v153, v130, v131
  v_mfma_f32_32x32x16_bf16 v[112:127], v[164:167], v[36:39], v[112:127]
  s_waitcnt vmcnt(37)
  v_max_u32 v0, v168, v172
  v_cmp_eq_u32 vcc, -1, v0
  v_exp_f32 v132, v132
  v_exp_f32 v133, v133
  v_exp_f32 v134, v134
  v_exp_f32 v135, v135
  v_cvt_pk_bf16_f32 v154, v132, v133
  v_cvt_pk_bf16_f32 v155, v134, v135
  s_cbranch_vccnz CV12_H
CV12_B:
  v_mfma_f32_32x32x16_bf16 v[48:63], v[168:171], v[144:147], v[48:63]
  global_load_dwordx4 v[220:223], v11, s[28:29] offset:1024 sc1
  v_exp_f32 v136, v136
  v_exp_f32 v137, v137
  v_exp_f32 v138, v138
  v_exp_f32 v139, v139
  v_cvt_pk_bf16_f32 v156, v136, v137
  v_cvt_pk_bf16_f32 v157, v138, v139
  v_mfma_f32_32x32x16_bf16 v[48:63], v[172:175], v[148:151], v[48:63]
  global_load_dwordx4 a[104:107], v2, s[74:75] offset:-2048 sc1
  v_exp_f32 v140, v140
  v_exp_f32 v141, v141
  v_exp_f32 v142, v142
  v_exp_f32 v143, v143
  v_cvt_pk_bf16_f32 v158, v140, v141
  v_cvt_pk_bf16_f32 v159, v142, v143
  v_mfma_f32_32x32x16_bf16 v[128:143], v[160:163], v[40:43], 0
  global_load_dwordx4 a[108:111], v2, s[74:75] offset:-1024 sc1
  v_exp_f32 v112, v112
  v_exp_f32 v113, v113
  v_exp_f32 v114, v114
  v_exp_f32 v115, v115
  v_cvt_pk_bf16_f32 v144, v112, v113
  v_cvt_pk_bf16_f32 v145, v114, v115
  v_mfma_f32_32x32x16_bf16 v[128:143], v[164:167], v[44:47], v[128:143]
  global_load_dwordx4 a[116:119], v2, s[74:75] offset:1024 sc1
  v_exp_f32 v116, v116
  v_exp_f32 v117, v117
  v_exp_f32 v118, v118
  v_exp_f32 v119, v119
  v_cvt_pk_bf16_f32 v146, v116, v117
  v_cvt_pk_bf16_f32 v147, v118, v119
  v_mfma_f32_32x32x16_bf16 v[64:79], v[168:171], v[152:155], v[64:79]
  global_load_dwordx4 a[120:123], v2, s[74:75] offset:2048 sc1
  v_exp_f32 v120, v120
  v_exp_f32 v121, v121
  v_exp_f32 v122, v122
  v_exp_f32 v123, v123
  v_cvt_pk_bf16_f32 v148, v120, v121
  v_cvt_pk_bf16_f32 v149, v122, v123
  v_mfma_f32_32x32x16_bf16 v[64:79], v[172:175], v[156:159], v[64:79]
  s_waitcnt vmcnt(32)
  v_max_u32 v0, v176, v180
  v_cmp_eq_u32 vcc, -1, v0
  v_exp_f32 v124, v124
  v_exp_f32 v125, v125
  v_exp_f32 v126, v126
  v_exp_f32 v127, v127
  v_cvt_pk_bf16_f32 v150, v124, v125
  v_cvt_pk_bf16_f32 v151, v126, v127
  s_cbranch_vccnz CK13_H
CK13_B:
  v_mfma_f32_32x32x16_bf16 v[112:127], v[176:179], v[16:19], 0
  global_load_dwordx4 a[124:127], v2, s[74:75] offset:3072 sc1
  v_exp_f32 v128, v128
  v_exp_f32 v129, v129
  v_exp_f32 v130, v130
  v_exp_f32 v131, v131
  v_cvt_pk_bf16_f32 v152, v128, v129
  v_cvt_pk_bf16_f32 v153, v130, v131
  v_mfma_f32_32x32x16_bf16 v[112:127], v[180:183], v[20:23], v[112:127]
  s_add_u32 s14, s14, s65
  s_addc_u32 s15, s15, 0
  v_exp_f32 v132, v132
  v_exp_f32 v133, v133
  v_exp_f32 v134, v134
  v_exp_f32 v135, v135
  v_cvt_pk_bf16_f32 v154, v132, v133
  v_cvt_pk_bf16_f32 v155, v134, v135
  v_mfma_f32_32x32x16_bf16 v[80:95], v[168:171], v[144:147], v[80:95]
  global_load_dwordx4 a[128:131], v2, s[14:15] offset:-4096 sc1
  v_exp_f32 v136, v136
  v_exp_f32 v137, v137
  v_exp_f32 v138, v138
  v_exp_f32 v139, v139
  v_cvt_pk_bf16_f32 v156, v136, v137
  v_cvt_pk_bf16_f32 v157, v138, v139
  v_mfma_f32_32x32x16_bf16 v[80:95], v[172:175], v[148:151], v[80:95]
  global_load_dwordx4 a[132:135], v2, s[14:15] offset:-3072 sc1
  v_exp_f32 v140, v140
  v_exp_f32 v141, v141
  v_exp_f32 v142, v142
  v_exp_f32 v143, v143
  v_cvt_pk_bf16_f32 v158, v140, v141
  v_cvt_pk_bf16_f32 v159, v142, v143
  v_mfma_f32_32x32x16_bf16 v[128:143], v[176:179], v[24:27], 0
  global_load_dwordx4 a[136:139], v2, s[14:15] offset:-2048 sc1
  v_exp_f32 v112, v112
  v_exp_f32 v113, v113
  v_exp_f32 v114, v114
  v_exp_f32 v115, v115
  v_cvt_pk_bf16_f32 v144, v112, v113
  v_cvt_pk_bf16_f32 v145, v114, v115
  v_mfma_f32_32x32x16_bf16 v[128:143], v[180:183], v[28:31], v[128:143]
  v_min_u32 v0, 13, v1
  v_lshlrev_b32 v0, 7, v0
  buffer_load_dword v15, v0, s[36:39], s101 offen offset:2560 sc1
  v_exp_f32 v116, v116
  v_exp_f32 v117, v117
  v_exp_f32 v118, v118
  v_exp_f32 v119, v119
  v_cvt_pk_bf16_f32 v146, v116, v117
  v_cvt_pk_bf16_f32 v147, v118, v119
  v_mfma_f32_32x32x16_bf16 v[96:111], v[168:171], v[152:155], v[96:111]
  global_load_dwordx4 a[140:143], v2, s[14:15] offset:-1024 sc1
  v_exp_f32 v120, v120
  v_exp_f32 v121, v121
  v_exp_f32 v122, v122
  v_exp_f32 v123, v123
  v_cvt_pk_bf16_f32 v148, v120, v121
  v_cvt_pk_bf16_f32 v149, v122, v123
  v_mfma_f32_32x32x16_bf16 v[96:111], v[172:175], v[156:159], v[96:111]
  s_add_u32 s74, s74, s65
  s_addc_u32 s75, s75, 0
  v_exp_f32 v124, v124
  v_exp_f32 v125, v125
  v_exp_f32 v126, v126
  v_exp_f32 v127, v127
  v_cvt_pk_bf16_f32 v150, v124, v125
  v_cvt_pk_bf16_f32 v151, v126, v127
  v_mfma_f32_32x32x16_bf16 v[112:127], v[176:179], v[32:35], 0
  global_load_dwordx4 a[144:147], v2, s[14:15] offset:0 sc1
  v_exp_f32 v128, v128
  v_exp_f32 v129, v129
  v_exp_f32 v130, v130
  v_exp_f32 v131, v131
  v_cvt_pk_bf16_f32 v152, v128, v129
  v_cvt_pk_bf16_f32 v153, v130, v131
  v_mfma_f32_32x32x16_bf16 v[112:127], v[180:183], v[36:39], v[112:127]
W26:
  s_cbranch_execz P_END
  s_waitcnt vmcnt(37)
  v_max_u32 v0, v184, v188
  v_cmp_eq_u32 vcc, -1, v0
  v_exp_f32 v132, v132
  v_exp_f32 v133, v133
  v_exp_f32 v134, v134
  v_exp_f32 v135, v135
  v_cvt_pk_bf16_f32 v154, v132, v133
  v_cvt_pk_bf16_f32 v155, v134, v135
  s_cbranch_vccnz CV13_H
CV13_B:
  v_mfma_f32_32x32x16_bf16 v[48:63], v[184:187], v[144:147], v[48:63]
  global_load_dwordx4 a[148:151], v2, s[14:15] offset:1024 sc1
  v_exp_f32 v136, v136
  v_exp_f32 v137, v137
  v_exp_f32 v138, v138
  v_exp_f32 v139, v139
  v_cvt_pk_bf16_f32 v156, v136, v137
  v_cvt_pk_bf16_f32 v157, v138, v139
  v_mfma_f32_32x32x16_bf16 v[48:63], v[188:191], v[148:151], v[48:63]
  v_exp_f32 v140, v140
  v_exp_f32 v141, v141
  v_exp_f32 v142, v142
  v_exp_f32 v143, v143
  v_cvt_pk_bf16_f32 v158, v140, v141
  v_cvt_pk_bf16_f32 v159, v142, v143
  v_mfma_f32_32x32x16_bf16 v[128:143], v[176:179], v[40:43], 0
  global_load_dwordx4 a[152:155], v2, s[14:15] offset:2048 sc1
  v_exp_f32 v112, v112
  v_exp_f32 v113, v113
  v_exp_f32 v114, v114
  v_exp_f32 v115, v115
  v_cvt_pk_bf16_f32 v144, v112, v113
  v_cvt_pk_bf16_f32 v145, v114, v115
  v_mfma_f32_32x32x16_bf16 v[128:143], v[180:183], v[44:47], v[128:143]
  global_load_dwordx4 a[156:159], v2, s[14:15] offset:3072 sc1
  v_exp_f32 v116, v116
  v_exp_f32 v117, v117
  v_exp_f32 v118, v118
  v_exp_f32 v119, v119
  v_cvt_pk_bf16_f32 v146, v116, v117
  v_cvt_pk_bf16_f32 v147, v118, v119
  v_mfma_f32_32x32x16_bf16 v[64:79], v[184:187], v[152:155], v[64:79]
  global_load_dwordx4 a[160:163], v2, s[74:75] offset:-4096 sc1
  v_exp_f32 v120, v120
  v_exp_f32 v121, v121
  v_exp_f32 v122, v122
  v_exp_f32 v123, v123
  v_cvt_pk_bf16_f32 v148, v120, v121
  v_cvt_pk_bf16_f32 v149, v122, v123
  v_mfma_f32_32x32x16_bf16 v[64:79], v[188:191], v[156:159], v[64:79]
  s_waitcnt vmcnt(31)
  v_max_u32 v0, v192, v196
  v_cmp_eq_u32 vcc, -1, v0
  v_exp_f32 v124, v124
  v_exp_f32 v125, v125
  v_exp_f32 v126, v126
  v_exp_f32 v127, v127
  v_cvt_pk_bf16_f32 v150, v124, v125
  v_cvt_pk_bf16_f32 v151, v126, v127
  s_cbranch_vccnz CK14_H
CK14_B:
  v_mfma_f32_32x32x16_bf16 v[112:127], v[192:195], v[16:19], 0
  global_load_dwordx4 a[164:167], v2, s[74:75] offset:-3072 sc1
  v_exp_f32 v128, v128
  v_exp_f32 v129, v129
  v_exp_f32 v130, v130
  v_exp_f32 v131, v131
  v_cvt_pk_bf16_f32 v152, v128, v129
  v_cvt_pk_bf16_f32 v153, v130, v131
  v_mfma_f32_32x32x16_bf16 v[112:127], v[196:199], v[20:23], v[112:127]
  global_load_dwordx4 a[168:171], v2, s[74:75] offset:-2048 sc1
  v_exp_f32 v132, v132
  v_exp_f32 v133, v133
  v_exp_f32 v134, v134
  v_exp_f32 v135, v135
  v_cvt_pk_bf16_f32 v154, v132, v133
  v_cvt_pk_bf16_f32 v155, v134, v135
  v_mfma_f32_32x32x16_bf16 v[80:95], v[184:187], v[144:147], v[80:95]
  global_load_dwordx4 a[172:175], v2, s[74:75] offset:-1024 sc1
  v_exp_f32 v136, v136
  v_exp_f32 v137, v137
  v_exp_f32 v138, v138
  v_exp_f32 v139, v139
  v_cvt_pk_bf16_f32 v156, v136, v137
  v_cvt_pk_bf16_f32 v157, v138, v139
  v_mfma_f32_32x32x16_bf16 v[80:95], v[188:191], v[148:151], v[80:95]
  s_add_u32 s14, s14, s65
  s_addc_u32 s15, s15, 0
  v_exp_f32 v140, v140
  v_exp_f32 v141, v141
  v_exp_f32 v142, v142
  v_exp_f32 v143, v143
  v_cvt_pk_bf16_f32 v158, v140, v141
  v_cvt_pk_bf16_f32 v159, v142, v143
  v_mfma_f32_32x32x16_bf16 v[128:143], v[192:195], v[24:27], 0
  global_load_dwordx4 a[176:179], v2, s[74:75] offset:0 sc1
  v_exp_f32 v112, v112
  v_exp_f32 v113, v113
  v_exp_f32 v114, v114
  v_exp_f32 v115, v115
  v_cvt_pk_bf16_f32 v144, v112, v113
  v_cvt_pk_bf16_f32 v145, v114, v115
  v_mfma_f32_32x32x16_bf16 v[128:143], v[196:199], v[28:31], v[128:143]
  global_load_dwordx4 a[180:183], v2, s[74:75] offset:1024 sc1
  v_exp_f32 v116, v116
  v_exp_f32 v117, v117
  v_exp_f32 v118, v118
  v_exp_f32 v119, v119
  v_cvt_pk_bf16_f32 v146, v116, v117
  v_cvt_pk_bf16_f32 v147, v118, v119
  v_mfma_f32_32x32x16_bf16 v[96:111], v[184:187], v[152:155], v[96:111]
  s_waitcnt vmcnt(11)
  v_cmp_eq_u32 vcc, -1, v15
  s_nop 1
  s_cbranch_vccnz CFCK2_H
CFCK2_B:
  v_exp_f32 v120, v120
  v_exp_f32 v121, v121
  v_exp_f32 v122, v122
  v_exp_f32 v123, v123
  v_cvt_pk_bf16_f32 v148, v120, v121
  v_cvt_pk_bf16_f32 v149, v122, v123
  v_mfma_f32_32x32x16_bf16 v[96:111], v[188:191], v[156:159], v[96:111]
  v_exp_f32 v124, v124
  v_exp_f32 v125, v125
  v_exp_f32 v126, v126
  v_exp_f32 v127, v127
  v_cvt_pk_bf16_f32 v150, v124, v125
  v_cvt_pk_bf16_f32 v151, v126, v127
  v_mfma_f32_32x32x16_bf16 v[112:127], v[192:195], v[32:35], 0
  global_load_dwordx4 a[184:187], v2, s[74:75] offset:2048 sc1
  v_exp_f32 v128, v128
  v_exp_f32 v129, v129
  v_exp_f32 v130, v130
  v_exp_f32 v131, v131
  v_cvt_pk_bf16_f32 v152, v128, v129
  v_cvt_pk_bf16_f32 v153, v130, v131
  v_mfma_f32_32x32x16_bf16 v[112:127], v[196:199], v[36:39], v[112:127]
  s_waitcnt vmcnt(34)
  v_max_u32 v0, v200, v204
  v_cmp_eq_u32 vcc, -1, v0
  v_exp_f32 v132, v132
  v_exp_f32 v133, v133
  v_exp_f32 v134, v134
  v_exp_f32 v135, v135
  v_cvt_pk_bf16_f32 v154, v132, v133
  v_cvt_pk_bf16_f32 v155, v134, v135
  s_cbranch_vccnz CV14_H
CV14_B:
  v_mfma_f32_32x32x16_bf16 v[48:63], v[200:203], v[144:147], v[48:63]
  global_load_dwordx4 a[188:191], v2, s[74:75] offset:3072 sc1
  v_exp_f32 v136, v136
  v_exp_f32 v137, v137
  v_exp_f32 v138, v138
  v_exp_f32 v139, v139
  v_cvt_pk_bf16_f32 v156, v136, v137
  v_cvt_pk_bf16_f32 v157, v138, v139
  v_mfma_f32_32x32x16_bf16 v[48:63], v[204:207], v[148:151], v[48:63]
  s_add_u32 s74, s74, s65
  s_addc_u32 s75, s75, 0
  v_exp_f32 v140, v140
  v_exp_f32 v141, v141
  v_exp_f32 v142, v142
  v_exp_f32 v143, v143
  v_cvt_pk_bf16_f32 v158, v140, v141
  v_cvt_pk_bf16_f32 v159, v142, v143
  v_mfma_f32_32x32x16_bf16 v[128:143], v[192:195], v[40:43], 0
  global_load_dwordx4 a[192:195], v2, s[14:15] offset:-4096 sc1
  v_exp_f32 v112, v112
  v_exp_f32 v113, v113
  v_exp_f32 v114, v114
  v_exp_f32 v115, v115
  v_cvt_pk_bf16_f32 v144, v112, v113
  v_cvt_pk_bf16_f32 v145, v114, v115
  v_mfma_f32_32x32x16_bf16 v[128:143], v[196:199], v[44:47], v[128:143]
  global_load_dwordx4 a[196:199], v2, s[14:15] offset:-3072 sc1
  v_exp_f32 v116, v116
  v_exp_f32 v117, v117
  v_exp_f32 v118, v118
  v_exp_f32 v119, v119
  v_cvt_pk_bf16_f32 v146, v116, v117
  v_cvt_pk_bf16_f32 v147, v118, v119
  v_mfma_f32_32x32x16_bf16 v[64:79], v[200:203], v[152:155], v[64:79]
W27:
  s_cbranch_execz P_END
  global_load_dwordx4 a[200:203], v2, s[14:15] offset:-2048 sc1
  v_exp_f32 v120, v120
  v_exp_f32 v121, v121
  v_exp_f32 v122, v122
  v_exp_f32 v123, v123
  v_cvt_pk_bf16_f32 v148, v120, v121
  v_cvt_pk_bf16_f32 v149, v122, v123
  v_mfma_f32_32x32x16_bf16 v[64:79], v[204:207], v[156:159], v[64:79]
  s_waitcnt vmcnt(28)
  v_max_u32 v0, v208, v212
  v_cmp_eq_u32 vcc, -1, v0
  v_exp_f32 v124, v124
  v_exp_f32 v125, v125
  v_exp_f32 v126, v126
  v_exp_f32 v127, v127
  v_cvt_pk_bf16_f32 v150, v124, v125
  v_cvt_pk_bf16_f32 v151, v126, v127
  s_cbranch_vccnz CK15_H
CK15_B:
  v_mfma_f32_32x32x16_bf16 v[112:127], v[208:211], v[16:19], 0
  buffer_load_dword v14, v2, s[36:39], s45 offen sc1
  v_exp_f32 v128, v128
  s_mul_i32 s10, s4, 12288
  v_exp_f32 v129, v129
  v_exp_f32 v130, v130
  v_exp_f32 v131, v131
  v_cvt_pk_bf16_f32 v152, v128, v129
  v_cvt_pk_bf16_f32 v153, v130, v131
  v_add_u32 v7, s10, v2
  v_mfma_f32_32x32x16_bf16 v[112:127], v[212:215], v[20:23], v[112:127]
  global_load_dwordx4 a[204:207], v2, s[14:15] offset:-1024 sc1
  v_exp_f32 v132, v132
  s_add_u32 s10, s4, 3
  v_exp_f32 v133, v133
  s_and_b32 s10, s10, 3
  v_exp_f32 v134, v134
  s_mul_i32 s10, s10, 12288
  v_exp_f32 v135, v135
  v_cvt_pk_bf16_f32 v154, v132, v133
  v_cvt_pk_bf16_f32 v155, v134, v135
  v_add_u32 v4, s10, v2
  v_mfma_f32_32x32x16_bf16 v[80:95], v[200:203], v[144:147], v[80:95]
  global_load_dwordx4 a[208:211], v2, s[14:15] offset:0 sc1
  v_exp_f32 v136, v136
  s_add_u32 s10, s4, 2
  v_exp_f32 v137, v137
  s_and_b32 s10, s10, 3
  v_exp_f32 v138, v138
  s_mul_i32 s10, s10, 12288
  v_exp_f32 v139, v139
  s_add_u32 s10, s10, 4096
  v_cvt_pk_bf16_f32 v156, v136, v137
  v_cvt_pk_bf16_f32 v157, v138, v139
  v_add_u32 v5, s10, v2
  v_mfma_f32_32x32x16_bf16 v[80:95], v[204:207], v[148:151], v[80:95]
  v_exp_f32 v140, v140
  s_add_u32 s10, s4, 1
  v_exp_f32 v141, v141
  s_and_b32 s10, s10, 3
  v_exp_f32 v142, v142
  s_mul_i32 s10, s10, 12288
  v_exp_f32 v143, v143
  s_add_u32 s10, s10, 8192
  v_cvt_pk_bf16_f32 v158, v140, v141
  v_cvt_pk_bf16_f32 v159, v142, v143
  v_add_u32 v6, s10, v2
  v_mfma_f32_32x32x16_bf16 v[128:143], v[208:211], v[24:27], 0
  global_load_dwordx4 a[212:215], v2, s[14:15] offset:1024 sc1
  v_exp_f32 v112, v112
  v_exp_f32 v113, v113
  v_exp_f32 v114, v114
  v_exp_f32 v115, v115
  v_cvt_pk_bf16_f32 v144, v112, v113
  v_cvt_pk_bf16_f32 v145, v114, v115
  v_mfma_f32_32x32x16_bf16 v[128:143], v[212:215], v[28:31], v[128:143]
  global_load_dwordx4 a[216:219], v2, s[14:15] offset:2048 sc1
  v_exp_f32 v116, v116
  v_exp_f32 v117, v117
  v_exp_f32 v118, v118
  v_exp_f32 v119, v119
  v_cvt_pk_bf16_f32 v146, v116, v117
  v_cvt_pk_bf16_f32 v147, v118, v119
  v_mfma_f32_32x32x16_bf16 v[96:111], v[200:203], v[152:155], v[96:111]
  global_load_dwordx4 a[220:223], v2, s[14:15] offset:3072 sc1
  v_exp_f32 v120, v120
  v_exp_f32 v121, v121
  v_exp_f32 v122, v122
  v_exp_f32 v123, v123
  v_cvt_pk_bf16_f32 v148, v120, v121
  v_cvt_pk_bf16_f32 v149, v122, v123
  v_mfma_f32_32x32x16_bf16 v[96:111], v[204:207], v[156:159], v[96:111]
  v_exp_f32 v124, v124
  v_exp_f32 v125, v125
  v_exp_f32 v126, v126
  v_exp_f32 v127, v127
  v_cvt_pk_bf16_f32 v150, v124, v125
  v_cvt_pk_bf16_f32 v151, v126, v127
  v_mfma_f32_32x32x16_bf16 v[112:127], v[208:211], v[32:35], 0
  global_load_dwordx4 a[224:227], v2, s[74:75] offset:-4096 sc1
  v_exp_f32 v128, v128
  v_exp_f32 v129, v129
  v_exp_f32 v130, v130
  v_exp_f32 v131, v131
  v_cvt_pk_bf16_f32 v152, v128, v129
  v_cvt_pk_bf16_f32 v153, v130, v131
  v_mfma_f32_32x32x16_bf16 v[112:127], v[212:215], v[36:39], v[112:127]
  s_waitcnt vmcnt(32)
  v_max_u32 v0, v216, v220
  v_cmp_eq_u32 vcc, -1, v0
  v_exp_f32 v132, v132
  v_exp_f32 v133, v133
  v_exp_f32 v134, v134
  v_exp_f32 v135, v135
  v_cvt_pk_bf16_f32 v154, v132, v133
  v_cvt_pk_bf16_f32 v155, v134, v135
  s_cbranch_vccnz CV15_H
CV15_B:
  v_mfma_f32_32x32x16_bf16 v[48:63], v[216:219], v[144:147], v[48:63]
  v_exp_f32 v136, v136
  v_exp_f32 v137, v137
  v_exp_f32 v138, v138
  v_exp_f32 v139, v139
  v_cvt_pk_bf16_f32 v156, v136, v137
  v_cvt_pk_bf16_f32 v157, v138, v139
  v_mfma_f32_32x32x16_bf16 v[48:63], v[220:223], v[148:151], v[48:63]
  v_exp_f32 v140, v140
  v_exp_f32 v141, v141
  v_exp_f32 v142, v142
  v_exp_f32 v143, v143
  v_cvt_pk_bf16_f32 v158, v140, v141
  v_cvt_pk_bf16_f32 v159, v142, v143
  v_mfma_f32_32x32x16_bf16 v[128:143], v[208:211], v[40:43], 0
  v_exp_f32 v112, v112
  v_exp_f32 v113, v113
  v_exp_f32 v114, v114
  v_exp_f32 v115, v115
  v_cvt_pk_bf16_f32 v144, v112, v113
  v_cvt_pk_bf16_f32 v145, v114, v115
  v_mfma_f32_32x32x16_bf16 v[128:143], v[212:215], v[44:47], v[128:143]
  ds_write_b128 v7, v[48:51] offset:0
  v_exp_f32 v116, v116
  v_exp_f32 v117, v117
  v_exp_f32 v118, v118
  v_exp_f32 v119, v119
  v_cvt_pk_bf16_f32 v146, v116, v117
  v_cvt_pk_bf16_f32 v147, v118, v119
  v_mfma_f32_32x32x16_bf16 v[64:79], v[216:219], v[152:155], v[64:79]
  ds_write_b128 v7, v[52:55] offset:1024
  v_exp_f32 v120, v120
  v_exp_f32 v121, v121
  v_exp_f32 v122, v122
  v_exp_f32 v123, v123
  v_cvt_pk_bf16_f32 v148, v120, v121
  v_cvt_pk_bf16_f32 v149, v122, v123
  v_mfma_f32_32x32x16_bf16 v[64:79], v[220:223], v[156:159], v[64:79]
  ds_write_b128 v7, v[56:59] offset:2048
  v_exp_f32 v124, v124
  v_exp_f32 v125, v125
  v_exp_f32 v126, v126
  v_exp_f32 v127, v127
  v_cvt_pk_bf16_f32 v150, v124, v125
  v_cvt_pk_bf16_f32 v151, v126, v127
  v_mfma_f32_32x32x16_bf16 v[80:95], v[216:219], v[144:147], v[80:95]
  ds_write_b128 v7, v[60:63] offset:3072
  v_exp_f32 v128, v128
  v_exp_f32 v129, v129
  v_exp_f32 v130, v130
  v_exp_f32 v131, v131
  v_cvt_pk_bf16_f32 v152, v128, v129
  v_cvt_pk_bf16_f32 v153, v130, v131
  v_mfma_f32_32x32x16_bf16 v[80:95], v[220:223], v[148:151], v[80:95]
  ds_write_b128 v7, v[64:67] offset:4096
  v_exp_f32 v132, v132
  ds_write_b128 v7, v[68:71] offset:5120
  v_exp_f32 v133, v133
  ds_write_b128 v7, v[72:75] offset:6144
  v_exp_f32 v134, v134
  ds_write_b128 v7, v[76:79] offset:7168
W28:
  s_cbranch_execz P_END
  v_exp_f32 v135, v135
  v_cvt_pk_bf16_f32 v154, v132, v133
  v_cvt_pk_bf16_f32 v155, v134, v135
  v_exp_f32 v136, v136
  s_nop 0
  ds_write_b128 v7, v[80:83] offset:8192
  v_exp_f32 v137, v137
  v_mfma_f32_32x32x16_bf16 v[96:111], v[216:219], v[152:155], v[96:111]
  ds_write_b128 v7, v[84:87] offset:9216
  v_exp_f32 v138, v138
  ds_write_b128 v7, v[88:91] offset:10240
  v_exp_f32 v139, v139
  ds_write_b128 v7, v[92:95] offset:11264
  v_cvt_pk_bf16_f32 v156, v136, v137
  v_cvt_pk_bf16_f32 v157, v138, v139
  v_exp_f32 v140, v140
  v_exp_f32 v141, v141
  v_exp_f32 v142, v142
  v_exp_f32 v143, v143
  v_cvt_pk_bf16_f32 v158, v140, v141
  v_cvt_pk_bf16_f32 v159, v142, v143
  s_waitcnt lgkmcnt(0)
  s_nop 0
  v_mfma_f32_32x32x16_bf16 v[96:111], v[220:223], v[156:159], v[96:111]
P_EPI2:
  s_barrier
  ds_read_b128 v[160:163], v4 offset:0
  ds_read_b128 v[164:167], v4 offset:1024
  ds_read_b128 v[168:171], v4 offset:2048
  ds_read_b128 v[172:175], v4 offset:3072
  ds_read_b128 v[176:179], v5 offset:0
  ds_read_b128 v[180:183], v5 offset:1024
  ds_read_b128 v[184:187], v5 offset:2048
  ds_read_b128 v[188:191], v5 offset:3072
  ds_read_b128 v[192:195], v6 offset:0
  ds_read_b128 v[196:199], v6 offset:1024
  ds_read_b128 v[200:203], v6 offset:2048
  ds_read_b128 v[204:207], v6 offset:3072
  v_and_b32 v3, 31, v1
  v_mul_u32_u24 v15, 896, v3
  v_lshrrev_b32 v3, 5, v1
  v_lshl_add_u32 v15, v3, 3, v15
  s_lshl_b32 s10, s4, 2
  s_add_u32 s10, s10, 61440
  v_mov_b32 v3, s10
  s_movk_i32 s11, 0x207
  s_mov_b32 s10, 1652555776
  buffer_load_dwordx2 v[208:209], v15, s[40:43], s72 offen offset:0
  buffer_load_dwordx2 v[210:211], v15, s[40:43], s72 offen offset:16
  buffer_load_dwordx2 v[212:213], v15, s[40:43], s72 offen offset:32
  buffer_load_dwordx2 v[214:215], v15, s[40:43], s72 offen offset:48
  v_mov_b32 v6, 0
  v_mov_b32 v0, 61440
  s_waitcnt lgkmcnt(8)
  v_pk_add_f32 v[96:97], v[96:97], v[160:161]
  v_pk_add_f32 v[98:99], v[98:99], v[162:163]
  v_pk_add_f32 v[100:101], v[100:101], v[164:165]
  v_pk_add_f32 v[102:103], v[102:103], v[166:167]
  v_pk_add_f32 v[104:105], v[104:105], v[168:169]
  v_pk_add_f32 v[106:107], v[106:107], v[170:171]
  v_pk_add_f32 v[108:109], v[108:109], v[172:173]
  v_pk_add_f32 v[110:111], v[110:111], v[174:175]
  s_waitcnt lgkmcnt(4)
  v_pk_add_f32 v[96:97], v[96:97], v[176:177]
  v_pk_add_f32 v[98:99], v[98:99], v[178:179]
  v_pk_add_f32 v[100:101], v[100:101], v[180:181]
  v_pk_add_f32 v[102:103], v[102:103], v[182:183]
  v_pk_add_f32 v[104:105], v[104:105], v[184:185]
  v_pk_add_f32 v[106:107], v[106:107], v[186:187]
  v_pk_add_f32 v[108:109], v[108:109], v[188:189]
  v_pk_add_f32 v[110:111], v[110:111], v[190:191]
  s_waitcnt lgkmcnt(0)
  v_pk_add_f32 v[108:109], v[108:109], v[204:205]
  v_mov_b32 v8, v108
  v_mov_b32 v9, v108
  v_pk_add_f32 v[96:97], v[96:97], v[192:193]
  v_pk_add_f32 v[98:99], v[98:99], v[194:195]
  v_permlane32_swap_b32 v8, v9
  v_pk_add_f32 v[100:101], v[100:101], v[196:197]
  v_pk_add_f32 v[102:103], v[102:103], v[198:199]
  v_rcp_f32 v8, v9
  v_mul_f32 v120, s10, v9
  v_pk_add_f32 v[104:105], v[104:105], v[200:201]
  v_pk_add_f32 v[106:107], v[106:107], v[202:203]
  v_pk_add_f32 v[110:111], v[110:111], v[206:207]
  v_mov_b32 v9, v8
  v_fma_f32 v120, s10, v8, v120
  v_pk_mul_f32 v[96:97], v[96:97], v[8:9]
  v_pk_mul_f32 v[98:99], v[98:99], v[8:9]
  v_pk_mul_f32 v[100:101], v[100:101], v[8:9]
  v_pk_mul_f32 v[102:103], v[102:103], v[8:9]
  v_pk_mul_f32 v[104:105], v[104:105], v[8:9]
  v_pk_mul_f32 v[106:107], v[106:107], v[8:9]
  v_pk_mul_f32 v[108:109], v[108:109], v[8:9]
  v_pk_mul_f32 v[110:111], v[110:111], v[8:9]
  v_pk_add_f32 v[112:113], v[96:97], v[98:99]
  v_pk_add_f32 v[114:115], v[100:101], v[102:103]
  v_pk_add_f32 v[116:117], v[104:105], v[106:107]
  v_pk_add_f32 v[118:119], v[108:109], v[110:111]
  v_pk_add_f32 v[112:113], v[112:113], v[114:115]
  v_pk_add_f32 v[116:117], v[116:117], v[118:119]
  v_pk_add_f32 v[112:113], v[112:113], v[116:117]
  v_add_f32 v120, v120, v112
  v_add_f32 v112, v120, v113
  v_cmp_class_f32 vcc, v112, s11
  v_cvt_pk_bf16_f32 v128, v96, v97
  v_cvt_pk_bf16_f32 v129, v98, v99
  v_cvt_pk_bf16_f32 v130, v100, v101
  v_cvt_pk_bf16_f32 v131, v102, v103
  v_min_u32 v128, -2, v128
  v_min_u32 v129, -2, v129
  v_min_u32 v130, -2, v130
  v_min_u32 v131, -2, v131
  s_cbranch_vccnz P_BAD
P_ST:
  buffer_store_dwordx4 v[128:131], v2, s[36:39], s44 offen offset:0 sc1
  v_cvt_pk_bf16_f32 v132, v104, v105
  v_cvt_pk_bf16_f32 v133, v106, v107
  v_cvt_pk_bf16_f32 v134, v108, v109
  v_cvt_pk_bf16_f32 v135, v110, v111
  v_min_u32 v132, -2, v132
  v_min_u32 v133, -2, v133
  v_min_u32 v134, -2, v134
  v_min_u32 v135, -2, v135
  buffer_store_dwordx4 v[132:135], v2, s[36:39], s44 offen offset:1024 sc1
P_NST:
  ds_write_b32 v3, v6
  s_waitcnt lgkmcnt(0)
  s_barrier
  ds_read_b128 v[120:123], v0
  s_xor_b32 s10, s59, 0
  s_lshl_b32 s13, s56, 1
  s_add_u32 s10, s10, s13
  s_mul_i32 s10, s10, 32
  s_mul_i32 s13, s4, 8
  s_add_u32 s10, s10, s13
  s_lshl_b32 s10, s10, 10
  s_add_u32 s14, s10, 6291456
  s_add_u32 s74, s14, 4096
  s_xor_b32 s10, s59, 1
  s_lshl_b32 s13, s56, 1
  s_add_u32 s10, s10, s13
  s_mul_i32 s10, s10, 32
  s_mul_i32 s13, s4, 8
  s_add_u32 s10, s10, s13
  s_lshl_b32 s10, s10, 10
  s_add_u32 s15, s10, 6291456
  s_add_u32 s75, s15, 4096
  s_add_u32 s8, s67, 16384
  s_waitcnt lgkmcnt(0)
  v_or_b32 v120, v120, v121
  v_or3_b32 v120, v120, v122, v123
  s_nop 0
  v_readfirstlane_b32 s10, v120
  s_nop 0
  s_cmp_lg_u32 s10, 0
  s_cbranch_scc1 P_SCAN
  s_cmp_eq_u32 s57, 7
  s_cbranch_scc1 P_DONE
  s_waitcnt vmcnt(6)
  s_mov_b32 s63, 120000
P_GV:
  v_cmp_eq_u32 s[10:11], -1, v14
  buffer_load_dword v14, v2, s[36:39], s45 offen sc1
W29:
  s_cbranch_execz P_END
  s_cmp_eq_u32 s11, 0
  s_cbranch_scc1 P_GVK
  s_sub_u32 s63, s63, 1
  s_cmp_eq_u32 s63, 0
  s_cbranch_scc1 P_END
  s_waitcnt vmcnt(0)
  s_branch P_GV
P_GVK:
  s_xor_b32 s10, s4, 1
  s_mul_i32 s10, s10, 12288
  s_add_u32 s10, s10, 0
  v_add_u32 v9, s10, v2
  s_xor_b32 s10, s4, 2
  s_mul_i32 s10, s10, 12288
  s_add_u32 s10, s10, 4096
  v_add_u32 v10, s10, v2
  s_xor_b32 s10, s4, 3
  s_mul_i32 s10, s10, 12288
  s_add_u32 s10, s10, 8192
  v_add_u32 v11, s10, v2
  s_mul_i32 s10, s4, 12288
  v_add_u32 v8, s10, v2
  v_mov_b32 v12, 1065369472
  v_mov_b32 v13, 1065369472
  s_nop 1
  v_mfma_f32_4x4x4_16b_bf16 v[176:179], v[12:13], a[0:1], 0
  v_mfma_f32_4x4x4_16b_bf16 v[180:183], v[12:13], a[116:117], 0
  v_mfma_f32_4x4x4_16b_bf16 v[112:115], v[12:13], a[2:3], 0
  v_mfma_f32_4x4x4_16b_bf16 v[116:119], v[12:13], a[118:119], 0
  v_mfma_f32_4x4x4_16b_bf16 v[176:179], v[12:13], a[4:5], v[176:179]
  v_mfma_f32_4x4x4_16b_bf16 v[180:183], v[12:13], a[120:121], v[180:183]
  v_mfma_f32_4x4x4_16b_bf16 v[112:115], v[12:13], a[6:7], v[112:115]
  v_mfma_f32_4x4x4_16b_bf16 v[116:119], v[12:13], a[122:123], v[116:119]
  v_mfma_f32_4x4x4_16b_bf16 v[176:179], v[12:13], a[8:9], v[176:179]
  v_mfma_f32_4x4x4_16b_bf16 v[180:183], v[12:13], a[124:125], v[180:183]
  v_mfma_f32_4x4x4_16b_bf16 v[112:115], v[12:13], a[10:11], v[112:115]
  v_mfma_f32_4x4x4_16b_bf16 v[116:119], v[12:13], a[126:127], v[116:119]
  v_mfma_f32_4x4x4_16b_bf16 v[176:179], v[12:13], a[12:13], v[176:179]
  v_mfma_f32_4x4x4_16b_bf16 v[180:183], v[12:13], a[128:129], v[180:183]
  v_mfma_f32_4x4x4_16b_bf16 v[112:115], v[12:13], a[14:15], v[112:115]
  v_mfma_f32_4x4x4_16b_bf16 v[116:119], v[12:13], a[130:131], v[116:119]
  v_mfma_f32_4x4x4_16b_bf16 v[176:179], v[12:13], a[16:17], v[176:179]
  v_mfma_f32_4x4x4_16b_bf16 v[180:183], v[12:13], a[132:133], v[180:183]
  v_mfma_f32_4x4x4_16b_bf16 v[112:115], v[12:13], a[18:19], v[112:115]
  v_mfma_f32_4x4x4_16b_bf16 v[116:119], v[12:13], a[134:135], v[116:119]
  v_mfma_f32_4x4x4_16b_bf16 v[176:179], v[12:13], a[20:21], v[176:179]
  v_mfma_f32_4x4x4_16b_bf16 v[180:183], v[12:13], a[136:137], v[180:183]
  v_mfma_f32_4x4x4_16b_bf16 v[112:115], v[12:13], a[22:23], v[112:115]
  v_mfma_f32_4x4x4_16b_bf16 v[116:119], v[12:13], a[138:139], v[116:119]
  v_mfma_f32_4x4x4_16b_bf16 v[176:179], v[12:13], a[24:25], v[176:179]
  v_mfma_f32_4x4x4_16b_bf16 v[180:183], v[12:13], a[140:141], v[180:183]
  v_mfma_f32_4x4x4_16b_bf16 v[112:115], v[12:13], a[26:27], v[112:115]
  v_mfma_f32_4x4x4_16b_bf16 v[116:119], v[12:13], a[142:143], v[116:119]
  v_mfma_f32_4x4x4_16b_bf16 v[176:179], v[12:13], a[28:29], v[176:179]
  v_mfma_f32_4x4x4_16b_bf16 v[180:183], v[12:13], a[144:145], v[180:183]
  v_mfma_f32_4x4x4_16b_bf16 v[112:115], v[12:13], a[30:31], v[112:115]
  v_mfma_f32_4x4x4_16b_bf16 v[116:119], v[12:13], a[146:147], v[116:119]
  v_mfma_f32_4x4x4_16b_bf16 v[176:179], v[12:13], a[32:33], v[176:179]
  v_mfma_f32_4x4x4_16b_bf16 v[180:183], v[12:13], a[148:149], v[180:183]
  v_mfma_f32_4x4x4_16b_bf16 v[112:115], v[12:13], a[34:35], v[112:115]
  v_mfma_f32_4x4x4_16b_bf16 v[116:119], v[12:13], a[150:151], v[116:119]
  v_mfma_f32_4x4x4_16b_bf16 v[176:179], v[12:13], a[36:37], v[176:179]
  v_mfma_f32_4x4x4_16b_bf16 v[180:183], v[12:13], a[152:153], v[180:183]
  v_mfma_f32_4x4x4_16b_bf16 v[112:115], v[12:13], a[38:39], v[112:115]
  v_mfma_f32_4x4x4_16b_bf16 v[116:119], v[12:13], a[154:155], v[116:119]
  v_mfma_f32_4x4x4_16b_bf16 v[176:179], v[12:13], a[40:41], v[176:179]
  v_mfma_f32_4x4x4_16b_bf16 v[180:183], v[12:13], a[156:157], v[180:183]
  v_mfma_f32_4x4x4_16b_bf16 v[112:115], v[12:13], a[42:43], v[112:115]
  v_mfma_f32_4x4x4_16b_bf16 v[116:119], v[12:13], a[158:159], v[116:119]
  v_mfma_f32_4x4x4_16b_bf16 v[176:179], v[12:13], a[44:45], v[176:179]
  v_mfma_f32_4x4x4_16b_bf16 v[180:183], v[12:13], a[160:161], v[180:183]
  v_mfma_f32_4x4x4_16b_bf16 v[112:115], v[12:13], a[46:47], v[112:115]
  v_mfma_f32_4x4x4_16b_bf16 v[116:119], v[12:13], a[162:163], v[116:119]
  v_mfma_f32_4x4x4_16b_bf16 v[176:179], v[12:13], a[48:49], v[176:179]
  v_mfma_f32_4x4x4_16b_bf16 v[180:183], v[12:13], a[164:165], v[180:183]
  v_mfma_f32_4x4x4_16b_bf16 v[112:115], v[12:13], a[50:51], v[112:115]
  v_mfma_f32_4x4x4_16b_bf16 v[116:119], v[12:13], a[166:167], v[116:119]
  v_mfma_f32_4x4x4_16b_bf16 v[176:179], v[12:13], a[52:53], v[176:179]
  v_mfma_f32_4x4x4_16b_bf16 v[180:183], v[12:13], a[168:169], v[180:183]
  v_mfma_f32_4x4x4_16b_bf16 v[112:115], v[12:13], a[54:55], v[112:115]
  v_mfma_f32_4x4x4_16b_bf16 v[116:119], v[12:13], a[170:171], v[116:119]
  v_mfma_f32_4x4x4_16b_bf16 v[176:179], v[12:13], a[56:57], v[176:179]
  v_mfma_f32_4x4x4_16b_bf16 v[180:183], v[12:13], a[172:173], v[180:183]
  v_mfma_f32_4x4x4_16b_bf16 v[112:115], v[12:13], a[58:59], v[112:115]
  v_mfma_f32_4x4x4_16b_bf16 v[116:119], v[12:13], a[174:175], v[116:119]
  v_mfma_f32_4x4x4_16b_bf16 v[176:179], v[12:13], a[60:61], v[176:179]
  v_mfma_f32_4x4x4_16b_bf16 v[180:183], v[12:13], a[176:177], v[180:183]
  v_mfma_f32_4x4x4_16b_bf16 v[112:115], v[12:13], a[62:63], v[112:115]
  v_mfma_f32_4x4x4_16b_bf16 v[116:119], v[12:13], a[178:179], v[116:119]
  v_mfma_f32_4x4x4_16b_bf16 v[176:179], v[12:13], a[64:65], v[176:179]
  v_mfma_f32_4x4x4_16b_bf16 v[180:183], v[12:13], a[180:181], v[180:183]
  v_mfma_f32_4x4x4_16b_bf16 v[112:115], v[12:13], a[66:67], v[112:115]
  v_mfma_f32_4x4x4_16b_bf16 v[116:119], v[12:13], a[182:183], v[116:119]
  v_mfma_f32_4x4x4_16b_bf16 v[176:179], v[12:13], a[68:69], v[176:179]
  v_mfma_f32_4x4x4_16b_bf16 v[180:183], v[12:13], a[184:185], v[180:183]
  v_mfma_f32_4x4x4_16b_bf16 v[112:115], v[12:13], a[70:71], v[112:115]
  v_mfma_f32_4x4x4_16b_bf16 v[116:119], v[12:13], a[186:187], v[116:119]
  v_mfma_f32_4x4x4_16b_bf16 v[176:179], v[12:13], a[72:73], v[176:179]
  v_mfma_f32_4x4x4_16b_bf16 v[180:183], v[12:13], a[188:189], v[180:183]
  v_mfma_f32_4x4x4_16b_bf16 v[112:115], v[12:13], a[74:75], v[112:115]
  v_mfma_f32_4x4x4_16b_bf16 v[116:119], v[12:13], a[190:191], v[116:119]
  v_mfma_f32_4x4x4_16b_bf16 v[176:179], v[12:13], a[76:77], v[176:179]
  v_mfma_f32_4x4x4_16b_bf16 v[180:183], v[12:13], a[192:193], v[180:183]
  v_mfma_f32_4x4x4_16b_bf16 v[112:115], v[12:13], a[78:79], v[112:115]
  v_mfma_f32_4x4x4_16b_bf16 v[116:119], v[12:13], a[194:195], v[116:119]
  v_mfma_f32_4x4x4_16b_bf16 v[176:179], v[12:13], a[80:81], v[176:179]
  v_mfma_f32_4x4x4_16b_bf16 v[180:183], v[12:13], a[196:197], v[180:183]
  v_mfma_f32_4x4x4_16b_bf16 v[112:115], v[12:13], a[82:83], v[112:115]
  v_mfma_f32_4x4x4_16b_bf16 v[116:119], v[12:13], a[198:199], v[116:119]
  v_mfma_f32_4x4x4_16b_bf16 v[176:179], v[12:13], a[84:85], v[176:179]
  v_mfma_f32_4x4x4_16b_bf16 v[180:183], v[12:13], a[200:201], v[180:183]
  v_mfma_f32_4x4x4_16b_bf16 v[112:115], v[12:13], a[86:87], v[112:115]
  v_mfma_f32_4x4x4_16b_bf16 v[116:119], v[12:13], a[202:203], v[116:119]
  v_mfma_f32_4x4x4_16b_bf16 v[176:179], v[12:13], a[88:89], v[176:179]
  v_mfma_f32_4x4x4_16b_bf16 v[180:183], v[12:13], a[204:205], v[180:183]
  v_mfma_f32_4x4x4_16b_bf16 v[112:115], v[12:13], a[90:91], v[112:115]
  v_mfma_f32_4x4x4_16b_bf16 v[116:119], v[12:13], a[206:207], v[116:119]
  v_mfma_f32_4x4x4_16b_bf16 v[176:179], v[12:13], a[92:93], v[176:179]
  v_mfma_f32_4x4x4_16b_bf16 v[180:183], v[12:13], a[208:209], v[180:183]
  v_mfma_f32_4x4x4_16b_bf16 v[112:115], v[12:13], a[94:95], v[112:115]
  v_mfma_f32_4x4x4_16b_bf16 v[116:119], v[12:13], a[210:211], v[116:119]
  v_mfma_f32_4x4x4_16b_bf16 v[176:179], v[12:13], a[96:97], v[176:179]
  v_mfma_f32_4x4x4_16b_bf16 v[180:183], v[12:13], a[212:213], v[180:183]
  v_mfma_f32_4x4x4_16b_bf16 v[112:115], v[12:13], a[98:99], v[112:115]
  v_mfma_f32_4x4x4_16b_bf16 v[116:119], v[12:13], a[214:215], v[116:119]
  v_mfma_f32_4x4x4_16b_bf16 v[176:179], v[12:13], a[100:101], v[176:179]
  v_mfma_f32_4x4x4_16b_bf16 v[180:183], v[12:13], a[216:217], v[180:183]
  v_mfma_f32_4x4x4_16b_bf16 v[112:115], v[12:13], a[102:103], v[112:115]
  v_mfma_f32_4x4x4_16b_bf16 v[116:119], v[12:13], a[218:219], v[116:119]
  v_mfma_f32_4x4x4_16b_bf16 v[176:179], v[12:13], a[104:105], v[176:179]
  v_mfma_f32_4x4x4_16b_bf16 v[180:183], v[12:13], a[220:221], v[180:183]
  v_mfma_f32_4x4x4_16b_bf16 v[112:115], v[12:13], a[106:107], v[112:115]
  v_mfma_f32_4x4x4_16b_bf16 v[116:119], v[12:13], a[222:223], v[116:119]
  v_mfma_f32_4x4x4_16b_bf16 v[176:179], v[12:13], a[108:109], v[176:179]
  v_mfma_f32_4x4x4_16b_bf16 v[180:183], v[12:13], a[224:225], v[180:183]
  v_mfma_f32_4x4x4_16b_bf16 v[112:115], v[12:13], a[110:111], v[112:115]
W30:
  s_cbranch_execz P_END
  v_mfma_f32_4x4x4_16b_bf16 v[116:119], v[12:13], a[226:227], v[116:119]
  s_nop 1
  s_nop 1
  v_add_f32 v176, v176, v112
  v_add_f32 v180, v180, v116
  buffer_load_dwordx4 v[144:147], v2, s[36:39], s15 offen offset:0 sc1
  buffer_load_dwordx4 v[148:151], v2, s[36:39], s15 offen offset:1024 sc1
  buffer_load_dwordx4 v[152:155], v2, s[36:39], s15 offen offset:2048 sc1
  buffer_load_dwordx4 v[156:159], v2, s[36:39], s15 offen offset:3072 sc1
  buffer_load_dwordx4 v[160:163], v2, s[36:39], s75 offen offset:0 sc1
  buffer_load_dwordx4 v[164:167], v2, s[36:39], s75 offen offset:1024 sc1
  buffer_load_dwordx4 v[168:171], v2, s[36:39], s75 offen offset:2048 sc1
  buffer_load_dwordx4 v[172:175], v2, s[36:39], s75 offen offset:3072 sc1
  buffer_load_dwordx4 v[184:187], v2, s[36:39], s14 offen offset:0 sc1
  buffer_load_dwordx4 v[188:191], v2, s[36:39], s14 offen offset:1024 sc1
  buffer_load_dwordx4 v[192:195], v2, s[36:39], s14 offen offset:2048 sc1
  buffer_load_dwordx4 v[196:199], v2, s[36:39], s14 offen offset:3072 sc1
  buffer_load_dwordx4 v[200:203], v2, s[36:39], s74 offen offset:0 sc1
  buffer_load_dwordx4 v[204:207], v2, s[36:39], s74 offen offset:1024 sc1
  buffer_load_dwordx4 v[216:219], v2, s[36:39], s74 offen offset:2048 sc1
  buffer_load_dwordx4 v[220:223], v2, s[36:39], s74 offen offset:3072 sc1
  s_mov_b64 exec, 0
  s_cmp_eq_u32 s4, 0
  s_cbranch_scc1 W32
  s_cmp_eq_u32 s4, 1
  s_cbranch_scc1 W33
  s_cmp_eq_u32 s4, 2
  s_cbranch_scc1 W34
  s_branch W35
WR_PO:
  s_mov_b64 exec, -1
  s_mov_b32 s62, 65535
  s_waitcnt vmcnt(15)
  v_max3_u32 v4, v144, v145, v146
  v_max_u32 v4, v4, v147
  v_cmp_eq_u32 vcc, -1, v4
  s_nop 1
  s_cbranch_vccnz PO_E0
  v_mfma_f32_32x32x16_bf16 v[48:63], v[224:227], v[144:147], 0
  s_waitcnt vmcnt(14)
  v_max3_u32 v4, v148, v149, v150
  v_max_u32 v4, v4, v151
  v_cmp_eq_u32 vcc, -1, v4
  v_mfma_f32_32x32x16_bf16 v[64:79], a[232:235], v[144:147], 0
  s_add_u32 s9, s8, 0
  buffer_load_dwordx4 v[80:83], v2, s[36:39], s9 offen offset:0 sc1
  s_cbranch_vccnz PO_E1
PO_J1:
  v_mfma_f32_32x32x16_bf16 v[48:63], v[228:231], v[148:151], v[48:63]
  s_waitcnt vmcnt(14)
  v_max3_u32 v4, v152, v153, v154
  v_max_u32 v4, v4, v155
  v_cmp_eq_u32 vcc, -1, v4
  v_mfma_f32_32x32x16_bf16 v[64:79], a[236:239], v[148:151], v[64:79]
  buffer_load_dwordx4 v[84:87], v2, s[36:39], s9 offen offset:1024 sc1
  s_cbranch_vccnz PO_E2
PO_J2:
  v_mfma_f32_32x32x16_bf16 v[48:63], v[232:235], v[152:155], v[48:63]
  s_waitcnt vmcnt(14)
  v_max3_u32 v4, v156, v157, v158
  v_max_u32 v4, v4, v159
  v_cmp_eq_u32 vcc, -1, v4
  v_mfma_f32_32x32x16_bf16 v[64:79], a[240:243], v[152:155], v[64:79]
  buffer_load_dwordx4 v[88:91], v2, s[36:39], s9 offen offset:2048 sc1
  s_cbranch_vccnz PO_E3
PO_J3:
  v_mfma_f32_32x32x16_bf16 v[48:63], v[236:239], v[156:159], v[48:63]
  s_waitcnt vmcnt(14)
  v_max3_u32 v4, v160, v161, v162
  v_max_u32 v4, v4, v163
  v_cmp_eq_u32 vcc, -1, v4
  v_mfma_f32_32x32x16_bf16 v[64:79], a[244:247], v[156:159], v[64:79]
  buffer_load_dwordx4 v[92:95], v2, s[36:39], s9 offen offset:3072 sc1
  s_cbranch_vccnz PO_E4
PO_J4:
  v_mfma_f32_32x32x16_bf16 v[48:63], v[240:243], v[160:163], v[48:63]
  s_waitcnt vmcnt(14)
  v_max3_u32 v4, v164, v165, v166
  v_max_u32 v4, v4, v167
  v_cmp_eq_u32 vcc, -1, v4
  v_mfma_f32_32x32x16_bf16 v[64:79], a[248:251], v[160:163], v[64:79]
  s_add_u32 s9, s8, 4096
  buffer_load_dwordx4 v[96:99], v2, s[36:39], s9 offen offset:0 sc1
  s_cbranch_vccnz PO_E5
PO_J5:
  v_mfma_f32_32x32x16_bf16 v[48:63], v[244:247], v[164:167], v[48:63]
  s_waitcnt vmcnt(14)
  v_max3_u32 v4, v168, v169, v170
  v_max_u32 v4, v4, v171
  v_cmp_eq_u32 vcc, -1, v4
  v_mfma_f32_32x32x16_bf16 v[64:79], a[252:255], v[164:167], v[64:79]
  buffer_load_dwordx4 v[100:103], v2, s[36:39], s9 offen offset:1024 sc1
  s_cbranch_vccnz PO_E6
PO_J6:
  v_mfma_f32_32x32x16_bf16 v[48:63], v[248:251], v[168:171], v[48:63]
  s_waitcnt vmcnt(14)
  v_max3_u32 v4, v172, v173, v174
  v_max_u32 v4, v4, v175
  v_cmp_eq_u32 vcc, -1, v4
  v_mfma_f32_32x32x16_bf16 v[64:79], a[112:115], v[168:171], v[64:79]
  buffer_load_dwordx4 v[104:107], v2, s[36:39], s9 offen offset:2048 sc1
  s_cbranch_vccnz PO_E7
PO_J7:
  v_mfma_f32_32x32x16_bf16 v[48:63], v[252:255], v[172:175], v[48:63]
  s_waitcnt vmcnt(14)
  v_max3_u32 v4, v184, v185, v186
  v_max_u32 v4, v4, v187
  v_cmp_eq_u32 vcc, -1, v4
  v_mfma_f32_32x32x16_bf16 v[64:79], a[228:231], v[172:175], v[64:79]
  buffer_load_dwordx4 v[108:111], v2, s[36:39], s9 offen offset:3072 sc1
  s_cbranch_vccnz PO_E8
PO_J8:
  v_mfma_f32_32x32x16_bf16 v[32:47], a[232:235], v[184:187], 0
  s_waitcnt vmcnt(14)
  v_max3_u32 v4, v188, v189, v190
  v_max_u32 v4, v4, v191
  v_cmp_eq_u32 vcc, -1, v4
  v_mfma_f32_32x32x16_bf16 v[16:31], v[224:227], v[184:187], 0
  s_add_u32 s9, s8, 8192
  buffer_load_dwordx4 v[112:115], v2, s[36:39], s9 offen offset:0 sc1
  ds_write_b128 v10, v[48:51] offset:0
  s_cbranch_vccnz PO_E9
PO_J9:
  v_mfma_f32_32x32x16_bf16 v[32:47], a[236:239], v[188:191], v[32:47]
  s_waitcnt vmcnt(14)
  v_max3_u32 v4, v192, v193, v194
  v_max_u32 v4, v4, v195
  v_cmp_eq_u32 vcc, -1, v4
  v_mfma_f32_32x32x16_bf16 v[16:31], v[228:231], v[188:191], v[16:31]
  buffer_load_dwordx4 v[116:119], v2, s[36:39], s9 offen offset:1024 sc1
  ds_write_b128 v10, v[52:55] offset:1024
  s_cbranch_vccnz PO_E10
PO_J10:
  v_mfma_f32_32x32x16_bf16 v[32:47], a[240:243], v[192:195], v[32:47]
  s_waitcnt vmcnt(14)
  v_max3_u32 v4, v196, v197, v198
  v_max_u32 v4, v4, v199
  v_cmp_eq_u32 vcc, -1, v4
  v_mfma_f32_32x32x16_bf16 v[16:31], v[232:235], v[192:195], v[16:31]
  buffer_load_dwordx4 v[120:123], v2, s[36:39], s9 offen offset:2048 sc1
  ds_write_b128 v10, v[56:59] offset:2048
  s_cbranch_vccnz PO_E11
PO_J11:
  v_mfma_f32_32x32x16_bf16 v[32:47], a[244:247], v[196:199], v[32:47]
  s_waitcnt vmcnt(14)
  v_max3_u32 v4, v200, v201, v202
  v_max_u32 v4, v4, v203
  v_cmp_eq_u32 vcc, -1, v4
  v_mfma_f32_32x32x16_bf16 v[16:31], v[236:239], v[196:199], v[16:31]
  buffer_load_dwordx4 v[124:127], v2, s[36:39], s9 offen offset:3072 sc1
  ds_write_b128 v10, v[60:63] offset:3072
  s_cbranch_vccnz PO_E12
PO_J12:
  v_mfma_f32_32x32x16_bf16 v[32:47], a[248:251], v[200:203], v[32:47]
  s_waitcnt vmcnt(14)
  v_max3_u32 v4, v204, v205, v206
  v_max_u32 v4, v4, v207
  v_cmp_eq_u32 vcc, -1, v4
  v_mfma_f32_32x32x16_bf16 v[16:31], v[240:243], v[200:203], v[16:31]
  s_add_u32 s9, s8, 12288
  buffer_load_dwordx4 v[128:131], v2, s[36:39], s9 offen offset:0 sc1
  ds_write_b128 v11, v[64:67] offset:0
  s_cbranch_vccnz PO_E13
PO_J13:
  v_mfma_f32_32x32x16_bf16 v[32:47], a[252:255], v[204:207], v[32:47]
  s_waitcnt vmcnt(14)
  v_max3_u32 v4, v216, v217, v218
  v_max_u32 v4, v4, v219
  v_cmp_eq_u32 vcc, -1, v4
  v_mfma_f32_32x32x16_bf16 v[16:31], v[244:247], v[204:207], v[16:31]
  buffer_load_dwordx4 v[132:135], v2, s[36:39], s9 offen offset:1024 sc1
  ds_write_b128 v11, v[68:71] offset:1024
  s_cbranch_vccnz PO_E14
PO_J14:
  v_mfma_f32_32x32x16_bf16 v[32:47], a[112:115], v[216:219], v[32:47]
  s_waitcnt vmcnt(14)
  v_max3_u32 v4, v220, v221, v222
  v_max_u32 v4, v4, v223
  v_cmp_eq_u32 vcc, -1, v4
  v_mfma_f32_32x32x16_bf16 v[16:31], v[248:251], v[216:219], v[16:31]
  buffer_load_dwordx4 v[136:139], v2, s[36:39], s9 offen offset:2048 sc1
  ds_write_b128 v11, v[72:75] offset:2048
W31:
  s_cbranch_execz P_END
  s_cbranch_vccnz PO_E15
PO_J15:
  v_mfma_f32_32x32x16_bf16 v[32:47], a[228:231], v[220:223], v[32:47]
  v_mfma_f32_32x32x16_bf16 v[16:31], v[252:255], v[220:223], v[16:31]
  buffer_load_dwordx4 v[140:143], v2, s[36:39], s9 offen offset:3072 sc1
  ds_write_b128 v11, v[76:79] offset:3072
  s_cmp_eq_u32 s62, 65535
  s_cbranch_scc0 PO_L
PO_O:
  v_mov_b32 v248, v176
  v_mov_b32 v252, v180
  v_mov_b32 v244, 0
  s_nop 3
  ds_write_b128 v9, v[32:35] offset:0
  ds_write_b128 v9, v[36:39] offset:1024
  ds_write_b128 v9, v[40:43] offset:2048
  ds_write_b128 v9, v[44:47] offset:3072
  s_waitcnt lgkmcnt(0)
  s_barrier
  ds_read_b128 v[144:147], v8 offset:0
  ds_read_b128 v[148:151], v8 offset:1024
  ds_read_b128 v[152:155], v8 offset:2048
  ds_read_b128 v[156:159], v8 offset:3072
  ds_read_b128 v[160:163], v8 offset:4096
  ds_read_b128 v[164:167], v8 offset:5120
  ds_read_b128 v[168:171], v8 offset:6144
  ds_read_b128 v[172:175], v8 offset:7168
  ds_read_b128 v[184:187], v8 offset:8192
  ds_read_b128 v[188:191], v8 offset:9216
  ds_read_b128 v[192:195], v8 offset:10240
  ds_read_b128 v[196:199], v8 offset:11264
  v_lshlrev_b32 v32, 16, v208
  v_and_b32 v33, 0xffff0000, v208
  v_lshlrev_b32 v34, 16, v209
  v_and_b32 v35, 0xffff0000, v209
  v_lshlrev_b32 v36, 16, v210
  v_and_b32 v37, 0xffff0000, v210
  v_lshlrev_b32 v38, 16, v211
  v_and_b32 v39, 0xffff0000, v211
  v_lshlrev_b32 v40, 16, v212
  v_and_b32 v41, 0xffff0000, v212
  v_lshlrev_b32 v42, 16, v213
  v_and_b32 v43, 0xffff0000, v213
  v_lshlrev_b32 v44, 16, v214
  v_and_b32 v45, 0xffff0000, v214
  v_lshlrev_b32 v46, 16, v215
  v_and_b32 v47, 0xffff0000, v215
  v_pk_add_f32 v[16:17], v[16:17], v[32:33]
  v_pk_add_f32 v[18:19], v[18:19], v[34:35]
  v_pk_add_f32 v[20:21], v[20:21], v[36:37]
  v_pk_add_f32 v[22:23], v[22:23], v[38:39]
  v_pk_add_f32 v[24:25], v[24:25], v[40:41]
  v_pk_add_f32 v[26:27], v[26:27], v[42:43]
  v_pk_add_f32 v[28:29], v[28:29], v[44:45]
  v_pk_add_f32 v[30:31], v[30:31], v[46:47]
  s_mov_b32 s63, 120000
P_GW:
  v_cmp_ne_u32 vcc, s73, v14
  v_cmp_eq_u32 s[10:11], -1, v14
  s_nop 0
  s_and_b32 s13, vcc_lo, 0x0fffffff
  s_cselect_b32 s61, 0, 1
  s_or_b32 s71, s10, s11
  s_cmp_eq_u32 s71, 0
  s_cbranch_scc1 P_GOK
  buffer_load_dword v14, v2, s[36:39], s45 offen sc1
  s_sub_u32 s63, s63, 1
  s_cmp_eq_u32 s63, 0
  s_cbranch_scc1 P_END
  s_waitcnt vmcnt(0)
  s_branch P_GW
P_GOK:
  s_waitcnt lgkmcnt(8)
  v_pk_add_f32 v[16:17], v[16:17], v[144:145]
  v_pk_add_f32 v[18:19], v[18:19], v[146:147]
  v_pk_add_f32 v[20:21], v[20:21], v[148:149]
  v_pk_add_f32 v[22:23], v[22:23], v[150:151]
  v_pk_add_f32 v[24:25], v[24:25], v[152:153]
  v_pk_add_f32 v[26:27], v[26:27], v[154:155]
  v_pk_add_f32 v[28:29], v[28:29], v[156:157]
  v_pk_add_f32 v[30:31], v[30:31], v[158:159]
  s_waitcnt lgkmcnt(4)
  v_pk_add_f32 v[16:17], v[16:17], v[160:161]
  v_pk_add_f32 v[18:19], v[18:19], v[162:163]
  v_pk_add_f32 v[20:21], v[20:21], v[164:165]
  v_pk_add_f32 v[22:23], v[22:23], v[166:167]
  v_pk_add_f32 v[24:25], v[24:25], v[168:169]
  v_pk_add_f32 v[26:27], v[26:27], v[170:171]
  v_pk_add_f32 v[28:29], v[28:29], v[172:173]
  v_pk_add_f32 v[30:31], v[30:31], v[174:175]
  s_waitcnt lgkmcnt(0)
  v_pk_add_f32 v[16:17], v[16:17], v[184:185]
  v_pk_add_f32 v[18:19], v[18:19], v[186:187]
  v_pk_add_f32 v[20:21], v[20:21], v[188:189]
  v_pk_add_f32 v[22:23], v[22:23], v[190:191]
  v_pk_add_f32 v[24:25], v[24:25], v[192:193]
  v_pk_add_f32 v[26:27], v[26:27], v[194:195]
  v_pk_add_f32 v[28:29], v[28:29], v[196:197]
  v_pk_add_f32 v[30:31], v[30:31], v[198:199]
  v_cvt_pk_bf16_f32 v176, v16, v17
  v_cvt_pk_bf16_f32 v177, v18, v19
  v_cvt_pk_bf16_f32 v178, v20, v21
  v_cvt_pk_bf16_f32 v179, v22, v23
  v_cvt_pk_bf16_f32 v180, v24, v25
  v_cvt_pk_bf16_f32 v181, v26, v27
  v_cvt_pk_bf16_f32 v182, v28, v29
  v_cvt_pk_bf16_f32 v183, v30, v31
  v_min_u32 v32, -2, v176
  v_min_u32 v33, -2, v177
  v_min_u32 v34, -2, v178
  v_min_u32 v35, -2, v179
  v_min_u32 v36, -2, v180
  v_min_u32 v37, -2, v181
  v_min_u32 v38, -2, v182
  v_min_u32 v39, -2, v183
  v_permlane32_swap_b32 v32, v34
  v_permlane32_swap_b32 v33, v35
  v_permlane32_swap_b32 v36, v38
  v_permlane32_swap_b32 v37, v39
  s_cmp_eq_u32 s61, 0
  s_cbranch_scc1 P_SA1
  buffer_store_dwordx4 v[32:35], v2, s[36:39], s68 offen offset:0
  buffer_store_dwordx4 v[36:39], v2, s[36:39], s68 offen offset:1024
  s_branch P_SB1
P_SA1:
  buffer_store_dwordx4 v[32:35], v2, s[36:39], s68 offen offset:0 sc1
  buffer_store_dwordx4 v[36:39], v2, s[36:39], s68 offen offset:1024 sc1
P_SB1:
  s_mul_i32 s14, s56, 57344
  s_mul_i32 s10, s4, 14336
  s_add_u32 s14, s14, s10
  s_add_u32 s14, s14, 8388608
  s_add_u32 s15, s14, 4096
  s_add_u32 s74, s14, 8192
  s_add_u32 s75, s14, 12288
  buffer_load_dwordx4 v[144:147], v2, s[36:39], s14 offen offset:0 sc1
  buffer_load_dwordx4 v[148:151], v2, s[36:39], s14 offen offset:1024 sc1
  buffer_load_dwordx4 v[152:155], v2, s[36:39], s14 offen offset:2048 sc1
  buffer_load_dwordx4 v[156:159], v2, s[36:39], s14 offen offset:3072 sc1
  buffer_load_dwordx4 v[160:163], v2, s[36:39], s15 offen offset:0 sc1
  buffer_load_dwordx4 v[164:167], v2, s[36:39], s15 offen offset:1024 sc1
  buffer_load_dwordx4 v[168:171], v2, s[36:39], s15 offen offset:2048 sc1
  buffer_load_dwordx4 v[172:175], v2, s[36:39], s15 offen offset:3072 sc1
  buffer_load_dwordx4 v[184:187], v2, s[36:39], s74 offen offset:0 sc1
  buffer_load_dwordx4 v[188:191], v2, s[36:39], s74 offen offset:1024 sc1
  buffer_load_dwordx4 v[192:195], v2, s[36:39], s74 offen offset:2048 sc1
  buffer_load_dwordx4 v[196:199], v2, s[36:39], s74 offen offset:3072 sc1
  buffer_load_dwordx4 v[200:203], v2, s[36:39], s75 offen offset:0 sc1
  buffer_load_dwordx4 v[204:207], v2, s[36:39], s75 offen offset:1024 sc1
  v_mov_b32 v8, 0
  v_mov_b32 v9, 0
  v_mov_b32 v10, 0
  v_mov_b32 v11, 0
  v_mov_b32 v12, 0
  v_mov_b32 v13, 0
  v_mov_b32 v14, 0
  v_mov_b32 v15, 0
  v_mov_b32 v6, 1065369472
  v_mov_b32 v7, 1065369472
  s_lshl_b32 s10, s59, 15
  s_mul_i32 s13, s58, 14336
W32:
  s_cbranch_execz W36
  s_add_u32 s10, s10, s13
  v_add_u32 v5, s10, v2
  s_lshl_b32 s9, s4, 14
  s_add_u32 s9, s9, 65536
  s_barrier
  s_mov_b64 exec, 0
  s_cmp_eq_u32 s4, 0
  s_cbranch_scc1 WR_PH
  s_cmp_eq_u32 s4, 1
  s_cbranch_scc1 WR_PH
  s_cmp_eq_u32 s4, 2
  s_cbranch_scc1 WR_PH
  s_branch WR_PH
WR_PH:
  s_mov_b64 exec, -1
  s_mov_b32 s62, 16383
  s_waitcnt vmcnt(13)
  v_max3_u32 v4, v144, v145, v146
  v_max_u32 v4, v4, v147
  v_cmp_eq_u32 vcc, -1, v4
  s_nop 1
  s_cbranch_vccnz PH_E0
  ds_write_b128 v5, v[144:147] offset:0
  v_mfma_f32_4x4x4_16b_bf16 v[8:11], v[6:7], v[144:145], v[8:11]
  v_mfma_f32_4x4x4_16b_bf16 v[12:15], v[144:145], v[144:145], v[12:15]
  s_waitcnt vmcnt(12)
  v_max3_u32 v4, v148, v149, v150
  v_max_u32 v4, v4, v151
  v_cmp_eq_u32 vcc, -1, v4
  v_mfma_f32_4x4x4_16b_bf16 v[8:11], v[6:7], v[146:147], v[8:11]
  v_mfma_f32_4x4x4_16b_bf16 v[12:15], v[146:147], v[146:147], v[12:15]
  s_cbranch_vccnz PH_E1
PH_J1:
  ds_write_b128 v5, v[148:151] offset:1024
  v_mfma_f32_4x4x4_16b_bf16 v[8:11], v[6:7], v[148:149], v[8:11]
  v_mfma_f32_4x4x4_16b_bf16 v[12:15], v[148:149], v[148:149], v[12:15]
  s_waitcnt vmcnt(11)
  v_max3_u32 v4, v152, v153, v154
  v_max_u32 v4, v4, v155
  v_cmp_eq_u32 vcc, -1, v4
  v_mfma_f32_4x4x4_16b_bf16 v[8:11], v[6:7], v[150:151], v[8:11]
  v_mfma_f32_4x4x4_16b_bf16 v[12:15], v[150:151], v[150:151], v[12:15]
  s_cbranch_vccnz PH_E2
PH_J2:
  ds_write_b128 v5, v[152:155] offset:2048
  v_mfma_f32_4x4x4_16b_bf16 v[8:11], v[6:7], v[152:153], v[8:11]
  v_mfma_f32_4x4x4_16b_bf16 v[12:15], v[152:153], v[152:153], v[12:15]
  s_waitcnt vmcnt(10)
  v_max3_u32 v4, v156, v157, v158
  v_max_u32 v4, v4, v159
  v_cmp_eq_u32 vcc, -1, v4
  v_mfma_f32_4x4x4_16b_bf16 v[8:11], v[6:7], v[154:155], v[8:11]
  v_mfma_f32_4x4x4_16b_bf16 v[12:15], v[154:155], v[154:155], v[12:15]
  s_cbranch_vccnz PH_E3
PH_J3:
  ds_write_b128 v5, v[156:159] offset:3072
  v_mfma_f32_4x4x4_16b_bf16 v[8:11], v[6:7], v[156:157], v[8:11]
  v_mfma_f32_4x4x4_16b_bf16 v[12:15], v[156:157], v[156:157], v[12:15]
  s_waitcnt vmcnt(9)
  v_max3_u32 v4, v160, v161, v162
  v_max_u32 v4, v4, v163
  v_cmp_eq_u32 vcc, -1, v4
  v_mfma_f32_4x4x4_16b_bf16 v[8:11], v[6:7], v[158:159], v[8:11]
  v_mfma_f32_4x4x4_16b_bf16 v[12:15], v[158:159], v[158:159], v[12:15]
  s_cbranch_vccnz PH_E4
PH_J4:
  ds_write_b128 v5, v[160:163] offset:4096
  v_mfma_f32_4x4x4_16b_bf16 v[8:11], v[6:7], v[160:161], v[8:11]
  v_mfma_f32_4x4x4_16b_bf16 v[12:15], v[160:161], v[160:161], v[12:15]
  s_waitcnt vmcnt(8)
  v_max3_u32 v4, v164, v165, v166
  v_max_u32 v4, v4, v167
  v_cmp_eq_u32 vcc, -1, v4
  v_mfma_f32_4x4x4_16b_bf16 v[8:11], v[6:7], v[162:163], v[8:11]
  v_mfma_f32_4x4x4_16b_bf16 v[12:15], v[162:163], v[162:163], v[12:15]
  s_cbranch_vccnz PH_E5
PH_J5:
  ds_write_b128 v5, v[164:167] offset:5120
  v_mfma_f32_4x4x4_16b_bf16 v[8:11], v[6:7], v[164:165], v[8:11]
  v_mfma_f32_4x4x4_16b_bf16 v[12:15], v[164:165], v[164:165], v[12:15]
  s_waitcnt vmcnt(7)
  v_max3_u32 v4, v168, v169, v170
  v_max_u32 v4, v4, v171
  v_cmp_eq_u32 vcc, -1, v4
  v_mfma_f32_4x4x4_16b_bf16 v[8:11], v[6:7], v[166:167], v[8:11]
  v_mfma_f32_4x4x4_16b_bf16 v[12:15], v[166:167], v[166:167], v[12:15]
  s_cbranch_vccnz PH_E6
PH_J6:
  ds_write_b128 v5, v[168:171] offset:6144
  v_mfma_f32_4x4x4_16b_bf16 v[8:11], v[6:7], v[168:169], v[8:11]
  v_mfma_f32_4x4x4_16b_bf16 v[12:15], v[168:169], v[168:169], v[12:15]
  s_waitcnt vmcnt(6)
  v_max3_u32 v4, v172, v173, v174
  v_max_u32 v4, v4, v175
  v_cmp_eq_u32 vcc, -1, v4
  v_mfma_f32_4x4x4_16b_bf16 v[8:11], v[6:7], v[170:171], v[8:11]
  v_mfma_f32_4x4x4_16b_bf16 v[12:15], v[170:171], v[170:171], v[12:15]
  s_cbranch_vccnz PH_E7
PH_J7:
  ds_write_b128 v5, v[172:175] offset:7168
  v_mfma_f32_4x4x4_16b_bf16 v[8:11], v[6:7], v[172:173], v[8:11]
  v_mfma_f32_4x4x4_16b_bf16 v[12:15], v[172:173], v[172:173], v[12:15]
  s_waitcnt vmcnt(5)
  v_max3_u32 v4, v184, v185, v186
  v_max_u32 v4, v4, v187
  v_cmp_eq_u32 vcc, -1, v4
  v_mfma_f32_4x4x4_16b_bf16 v[8:11], v[6:7], v[174:175], v[8:11]
  v_mfma_f32_4x4x4_16b_bf16 v[12:15], v[174:175], v[174:175], v[12:15]
  s_cbranch_vccnz PH_E8
PH_J8:
  ds_write_b128 v5, v[184:187] offset:8192
  v_mfma_f32_4x4x4_16b_bf16 v[8:11], v[6:7], v[184:185], v[8:11]
  v_mfma_f32_4x4x4_16b_bf16 v[12:15], v[184:185], v[184:185], v[12:15]
  s_waitcnt vmcnt(4)
  v_max3_u32 v4, v188, v189, v190
  v_max_u32 v4, v4, v191
  v_cmp_eq_u32 vcc, -1, v4
  v_mfma_f32_4x4x4_16b_bf16 v[8:11], v[6:7], v[186:187], v[8:11]
  v_mfma_f32_4x4x4_16b_bf16 v[12:15], v[186:187], v[186:187], v[12:15]
  s_cbranch_vccnz PH_E9
PH_J9:
  ds_write_b128 v5, v[188:191] offset:9216
  v_mfma_f32_4x4x4_16b_bf16 v[8:11], v[6:7], v[188:189], v[8:11]
  v_mfma_f32_4x4x4_16b_bf16 v[12:15], v[188:189], v[188:189], v[12:15]
  s_waitcnt vmcnt(3)
  v_max3_u32 v4, v192, v193, v194
  v_max_u32 v4, v4, v195
  v_cmp_eq_u32 vcc, -1, v4
  v_mfma_f32_4x4x4_16b_bf16 v[8:11], v[6:7], v[190:191], v[8:11]
  v_mfma_f32_4x4x4_16b_bf16 v[12:15], v[190:191], v[190:191], v[12:15]
  s_cbranch_vccnz PH_E10
PH_J10:
  ds_write_b128 v5, v[192:195] offset:10240
  v_mfma_f32_4x4x4_16b_bf16 v[8:11], v[6:7], v[192:193], v[8:11]
  v_mfma_f32_4x4x4_16b_bf16 v[12:15], v[192:193], v[192:193], v[12:15]
  s_waitcnt vmcnt(2)
  v_max3_u32 v4, v196, v197, v198
  v_max_u32 v4, v4, v199
  v_cmp_eq_u32 vcc, -1, v4
  v_mfma_f32_4x4x4_16b_bf16 v[8:11], v[6:7], v[194:195], v[8:11]
  v_mfma_f32_4x4x4_16b_bf16 v[12:15], v[194:195], v[194:195], v[12:15]
  s_cbranch_vccnz PH_E11
PH_J11:
  ds_write_b128 v5, v[196:199] offset:11264
  v_mfma_f32_4x4x4_16b_bf16 v[8:11], v[6:7], v[196:197], v[8:11]
  v_mfma_f32_4x4x4_16b_bf16 v[12:15], v[196:197], v[196:197], v[12:15]
  s_waitcnt vmcnt(1)
  v_max3_u32 v4, v200, v201, v202
  v_max_u32 v4, v4, v203
  v_cmp_eq_u32 vcc, -1, v4
  v_mfma_f32_4x4x4_16b_bf16 v[8:11], v[6:7], v[198:199], v[8:11]
  v_mfma_f32_4x4x4_16b_bf16 v[12:15], v[198:199], v[198:199], v[12:15]
  s_cbranch_vccnz PH_E12
PH_J12:
  ds_write_b128 v5, v[200:203] offset:12288
  v_mfma_f32_4x4x4_16b_bf16 v[8:11], v[6:7], v[200:201], v[8:11]
  v_mfma_f32_4x4x4_16b_bf16 v[12:15], v[200:201], v[200:201], v[12:15]
  s_waitcnt vmcnt(0)
  v_max3_u32 v4, v204, v205, v206
  v_max_u32 v4, v4, v207
  v_cmp_eq_u32 vcc, -1, v4
  v_mfma_f32_4x4x4_16b_bf16 v[8:11], v[6:7], v[202:203], v[8:11]
  v_mfma_f32_4x4x4_16b_bf16 v[12:15], v[202:203], v[202:203], v[12:15]
  s_cbranch_vccnz PH_E13
PH_J13:
  ds_write_b128 v5, v[204:207] offset:13312
  v_mfma_f32_4x4x4_16b_bf16 v[8:11], v[6:7], v[204:205], v[8:11]
  v_mfma_f32_4x4x4_16b_bf16 v[12:15], v[204:205], v[204:205], v[12:15]
  s_nop 0
  v_mfma_f32_4x4x4_16b_bf16 v[8:11], v[6:7], v[206:207], v[8:11]
  v_mfma_f32_4x4x4_16b_bf16 v[12:15], v[206:207], v[206:207], v[12:15]
  s_cmp_eq_u32 s62, 16383
  s_cbranch_scc0 PH_L
PH_O:
  s_mov_b32 s10, 0xaaaaaaaa
  s_mov_b32 s11, 0xaaaaaaaa
  s_mov_b32 s14, 0xcccccccc
  s_mov_b32 s15, 0xcccccccc
W33:
  s_cbranch_execz W37
  v_and_b32 v4, 31, v1
  v_lshlrev_b32 v4, 4, v4
  s_lshl_b32 s13, s59, 9
  s_lshl_b32 s8, s58, 3
  s_add_u32 s13, s13, s8
  v_add_u32 v5, s13, v4
  v_cndmask_b32 v12, v12, v13, s[10:11]
  v_cndmask_b32 v14, v14, v15, s[10:11]
  v_cndmask_b32 v9, v12, v14, s[14:15]
  v_mov_b32 v10, v8
  s_nop 1
  v_permlane32_swap_b32 v8, v10
  v_add_f32 v8, v8, v10
  v_mov_b32 v11, v9
  s_nop 1
  v_permlane32_swap_b32 v9, v11
  v_add_f32 v9, v9, v11
  ds_write_b64 v5, v[8:9] offset:64000
  s_waitcnt lgkmcnt(0)
  s_barrier
  ds_read_b128 a[232:235], v2 offset:0
  ds_read_b128 a[236:239], v2 offset:1024
  ds_read_b128 a[240:243], v2 offset:2048
  ds_read_b128 v[144:147], v4 offset:64000
  ds_read_b128 v[148:151], v4 offset:64512
  s_mov_b32 s13, 991054117
  s_mov_b32 s15, 0x07060302
  s_waitcnt lgkmcnt(4)
  v_mfma_f32_32x32x16_bf16 v[16:31], a[0:3], a[232:235], 0
  ds_read_b128 a[244:247], v2 offset:3072
  v_mov_b32 v172, v248
  v_and_b32 v173, 0xffff0000, v172
  v_mfma_f32_32x32x16_bf16 v[32:47], a[116:119], a[232:235], 0
  s_add_u32 s8, s67, 32768
  buffer_load_dwordx4 v[192:195], v2, s[36:39], s8 offen offset:0 sc1
  v_sub_f32 v175, v172, v173
  v_and_b32 v174, 0xffff0000, v175
  s_waitcnt lgkmcnt(4)
  v_mfma_f32_32x32x16_bf16 v[16:31], a[4:7], a[236:239], v[16:31]
  ds_read_b128 a[232:235], v2 offset:4096
  v_sub_f32 v175, v175, v174
  v_perm_b32 v164, v173, v173, s15
  v_mfma_f32_32x32x16_bf16 v[32:47], a[120:123], a[236:239], v[32:47]
  buffer_load_dwordx4 v[196:199], v2, s[36:39], s8 offen offset:1024 sc1
  v_perm_b32 v165, v174, v174, s15
  v_perm_b32 v166, v175, v173, s15
  s_waitcnt lgkmcnt(4)
  v_mfma_f32_32x32x16_bf16 v[16:31], a[8:11], a[240:243], v[16:31]
  ds_read_b128 a[236:239], v2 offset:5120
  v_mov_b32 v167, 0
  v_mov_b32 v172, v252
  v_mfma_f32_32x32x16_bf16 v[32:47], a[124:127], a[240:243], v[32:47]
  buffer_load_dwordx4 v[200:203], v2, s[36:39], s8 offen offset:2048 sc1
  v_and_b32 v173, 0xffff0000, v172
  v_sub_f32 v175, v172, v173
  s_waitcnt lgkmcnt(2)
  v_mfma_f32_32x32x16_bf16 v[16:31], a[12:15], a[244:247], v[16:31]
  ds_read_b128 a[240:243], v2 offset:6144
  v_and_b32 v174, 0xffff0000, v175
  v_sub_f32 v175, v175, v174
  v_mfma_f32_32x32x16_bf16 v[32:47], a[128:131], a[244:247], v[32:47]
  buffer_load_dwordx4 v[204:207], v2, s[36:39], s8 offen offset:3072 sc1
  v_perm_b32 v168, v173, v173, s15
  v_perm_b32 v169, v174, v174, s15
  s_waitcnt lgkmcnt(2)
  v_mfma_f32_32x32x16_bf16 v[16:31], a[16:19], a[232:235], v[16:31]
  ds_read_b128 a[244:247], v2 offset:7168
  v_perm_b32 v170, v175, v173, s15
  v_mov_b32 v171, 0
  v_mfma_f32_32x32x16_bf16 v[32:47], a[132:135], a[232:235], v[32:47]
  s_add_u32 s8, s67, 36864
  buffer_load_dwordx4 v[208:211], v2, s[36:39], s8 offen offset:0 sc1
  s_waitcnt lgkmcnt(5)
  v_add_f32 v144, v144, v146
  s_waitcnt lgkmcnt(2)
  v_mfma_f32_32x32x16_bf16 v[16:31], a[20:23], a[236:239], v[16:31]
  ds_read_b128 a[232:235], v2 offset:8192
  v_add_f32 v145, v145, v147
  v_mul_f32 v144, s13, v144
  v_mfma_f32_32x32x16_bf16 v[32:47], a[136:139], a[236:239], v[32:47]
  buffer_load_dwordx4 v[212:215], v2, s[36:39], s8 offen offset:1024 sc1
  v_mul_f32 v145, s13, v145
  v_fma_f32 v145, -v144, v144, v145
  s_waitcnt lgkmcnt(2)
  v_mfma_f32_32x32x16_bf16 v[16:31], a[24:27], a[240:243], v[16:31]
  ds_read_b128 a[236:239], v2 offset:9216
  v_max_f32 v145, 0, v145
  v_add_f32 v145, 925353388, v145
  v_mfma_f32_32x32x16_bf16 v[32:47], a[140:143], a[240:243], v[32:47]
  buffer_load_dwordx4 v[216:219], v2, s[36:39], s8 offen offset:2048 sc1
  v_rsq_f32 v145, v145
  v_sub_f32 v144, 0, v144
  s_waitcnt lgkmcnt(2)
  v_mfma_f32_32x32x16_bf16 v[16:31], a[28:31], a[244:247], v[16:31]
  ds_read_b128 a[240:243], v2 offset:10240
  v_and_b32 v160, 0xffff0000, v144
  v_sub_f32 v162, v144, v160
  v_mfma_f32_32x32x16_bf16 v[32:47], a[144:147], a[244:247], v[32:47]
  buffer_load_dwordx4 v[220:223], v2, s[36:39], s8 offen offset:3072 sc1
  v_and_b32 v161, 0xffff0000, v162
  v_sub_f32 v162, v162, v161
  s_waitcnt lgkmcnt(2)
  v_mfma_f32_32x32x16_bf16 v[16:31], a[32:35], a[232:235], v[16:31]
  ds_read_b128 a[244:247], v2 offset:11264
  v_perm_b32 v152, v161, v160, s15
  v_perm_b32 v153, v161, v160, s15
  v_mfma_f32_32x32x16_bf16 v[32:47], a[148:151], a[232:235], v[32:47]
  s_add_u32 s8, s67, 40960
  buffer_load_dwordx4 v[224:227], v2, s[36:39], s8 offen offset:0 sc1
  v_perm_b32 v154, v160, v162, s15
  v_mov_b32 v155, 0
  s_waitcnt lgkmcnt(2)
  v_mfma_f32_32x32x16_bf16 v[16:31], a[36:39], a[236:239], v[16:31]
  ds_read_b128 a[232:235], v2 offset:12288
  v_add_f32 v148, v148, v150
  v_add_f32 v149, v149, v151
  v_mfma_f32_32x32x16_bf16 v[32:47], a[152:155], a[236:239], v[32:47]
  buffer_load_dwordx4 v[228:231], v2, s[36:39], s8 offen offset:1024 sc1
  v_mul_f32 v148, s13, v148
  v_mul_f32 v149, s13, v149
  s_waitcnt lgkmcnt(2)
  v_mfma_f32_32x32x16_bf16 v[16:31], a[40:43], a[240:243], v[16:31]
  ds_read_b128 a[236:239], v2 offset:13312
  v_fma_f32 v149, -v148, v148, v149
  v_max_f32 v149, 0, v149
  v_mfma_f32_32x32x16_bf16 v[32:47], a[156:159], a[240:243], v[32:47]
  buffer_load_dwordx4 v[232:235], v2, s[36:39], s8 offen offset:2048 sc1
  v_add_f32 v149, 925353388, v149
  v_rsq_f32 v149, v149
  s_waitcnt lgkmcnt(2)
  v_mfma_f32_32x32x16_bf16 v[16:31], a[44:47], a[244:247], v[16:31]
  ds_read_b128 a[240:243], v2 offset:14336
  v_sub_f32 v148, 0, v148
  v_and_b32 v160, 0xffff0000, v148
  v_mfma_f32_32x32x16_bf16 v[32:47], a[160:163], a[244:247], v[32:47]
  buffer_load_dwordx4 v[236:239], v2, s[36:39], s8 offen offset:3072 sc1
  v_sub_f32 v162, v148, v160
  v_and_b32 v161, 0xffff0000, v162
  s_waitcnt lgkmcnt(2)
  v_mfma_f32_32x32x16_bf16 v[16:31], a[48:51], a[232:235], v[16:31]
  ds_read_b128 a[244:247], v2 offset:15360
  v_sub_f32 v162, v162, v161
  v_perm_b32 v156, v161, v160, s15
  v_mfma_f32_32x32x16_bf16 v[32:47], a[164:167], a[232:235], v[32:47]
  s_add_u32 s8, s67, 45056
  buffer_load_dwordx4 v[240:243], v2, s[36:39], s8 offen offset:0 sc1
  v_perm_b32 v157, v161, v160, s15
  v_perm_b32 v158, v160, v162, s15
  s_waitcnt lgkmcnt(2)
  v_mfma_f32_32x32x16_bf16 v[16:31], a[52:55], a[236:239], v[16:31]
  ds_read_b128 a[232:235], v2 offset:16384
  v_mov_b32 v159, 0
  s_cmp_eq_u32 s59, 0
  s_cselect_b64 s[10:11], -1, 0
  v_mfma_f32_32x32x16_bf16 v[32:47], a[168:171], a[236:239], v[32:47]
  buffer_load_dwordx4 v[244:247], v2, s[36:39], s8 offen offset:1024 sc1
  s_nop 0
  v_cndmask_b32 v3, v149, v145, s[10:11]
  s_waitcnt lgkmcnt(2)
W34:
  s_cbranch_execz W38
  v_mfma_f32_32x32x16_bf16 v[16:31], a[56:59], a[240:243], v[16:31]
  ds_read_b128 a[236:239], v2 offset:17408
  v_mfma_f32_32x32x16_bf16 v[32:47], a[172:175], a[240:243], v[32:47]
  buffer_load_dwordx4 v[248:251], v2, s[36:39], s8 offen offset:2048 sc1
  s_waitcnt lgkmcnt(2)
  v_mfma_f32_32x32x16_bf16 v[16:31], a[60:63], a[244:247], v[16:31]
  ds_read_b128 a[240:243], v2 offset:18432
  v_mfma_f32_32x32x16_bf16 v[32:47], a[176:179], a[244:247], v[32:47]
  buffer_load_dwordx4 v[252:255], v2, s[36:39], s8 offen offset:3072 sc1
  s_waitcnt lgkmcnt(2)
  v_mfma_f32_32x32x16_bf16 v[16:31], a[64:67], a[232:235], v[16:31]
  ds_read_b128 a[244:247], v2 offset:19456
  v_mfma_f32_32x32x16_bf16 v[32:47], a[180:183], a[232:235], v[32:47]
  s_waitcnt lgkmcnt(2)
  v_mfma_f32_32x32x16_bf16 v[16:31], a[68:71], a[236:239], v[16:31]
  ds_read_b128 a[232:235], v2 offset:20480
  v_mfma_f32_32x32x16_bf16 v[32:47], a[184:187], a[236:239], v[32:47]
  s_waitcnt lgkmcnt(2)
  v_mfma_f32_32x32x16_bf16 v[16:31], a[72:75], a[240:243], v[16:31]
  ds_read_b128 a[236:239], v2 offset:21504
  v_mfma_f32_32x32x16_bf16 v[32:47], a[188:191], a[240:243], v[32:47]
  s_waitcnt lgkmcnt(2)
  v_mfma_f32_32x32x16_bf16 v[16:31], a[76:79], a[244:247], v[16:31]
  ds_read_b128 a[240:243], v2 offset:22528
  v_mfma_f32_32x32x16_bf16 v[32:47], a[192:195], a[244:247], v[32:47]
  s_waitcnt lgkmcnt(2)
  v_mfma_f32_32x32x16_bf16 v[16:31], a[80:83], a[232:235], v[16:31]
  ds_read_b128 a[244:247], v2 offset:23552
  v_mfma_f32_32x32x16_bf16 v[32:47], a[196:199], a[232:235], v[32:47]
  s_waitcnt lgkmcnt(2)
  v_mfma_f32_32x32x16_bf16 v[16:31], a[84:87], a[236:239], v[16:31]
  ds_read_b128 a[232:235], v2 offset:24576
  v_mfma_f32_32x32x16_bf16 v[32:47], a[200:203], a[236:239], v[32:47]
  s_waitcnt lgkmcnt(2)
  v_mfma_f32_32x32x16_bf16 v[16:31], a[88:91], a[240:243], v[16:31]
  ds_read_b128 a[236:239], v2 offset:25600
  v_mfma_f32_32x32x16_bf16 v[32:47], a[204:207], a[240:243], v[32:47]
  s_waitcnt lgkmcnt(2)
  v_mfma_f32_32x32x16_bf16 v[16:31], a[92:95], a[244:247], v[16:31]
  ds_read_b128 a[240:243], v2 offset:26624
  v_mfma_f32_32x32x16_bf16 v[32:47], a[208:211], a[244:247], v[32:47]
  s_waitcnt lgkmcnt(2)
  v_mfma_f32_32x32x16_bf16 v[16:31], a[96:99], a[232:235], v[16:31]
  ds_read_b128 a[244:247], v2 offset:27648
  v_mfma_f32_32x32x16_bf16 v[32:47], a[212:215], a[232:235], v[32:47]
  s_waitcnt lgkmcnt(2)
  v_mfma_f32_32x32x16_bf16 v[16:31], a[100:103], a[236:239], v[16:31]
  ds_read_b128 a[232:235], v2 offset:32768
  v_mfma_f32_32x32x16_bf16 v[32:47], a[216:219], a[236:239], v[32:47]
  s_waitcnt lgkmcnt(2)
  v_mfma_f32_32x32x16_bf16 v[16:31], a[104:107], a[240:243], v[16:31]
  ds_read_b128 a[236:239], v2 offset:33792
  v_mfma_f32_32x32x16_bf16 v[32:47], a[220:223], a[240:243], v[32:47]
  s_waitcnt lgkmcnt(2)
  v_mfma_f32_32x32x16_bf16 v[16:31], a[108:111], a[244:247], v[16:31]
  ds_read_b128 a[240:243], v2 offset:34816
  v_mfma_f32_32x32x16_bf16 v[32:47], a[224:227], a[244:247], v[32:47]
  v_mfma_f32_32x32x16_bf16 v[16:31], v[164:167], v[152:155], v[16:31]
  v_mfma_f32_32x32x16_bf16 v[32:47], v[168:171], v[152:155], v[32:47]
  s_waitcnt lgkmcnt(2)
  v_mfma_f32_32x32x16_bf16 v[48:63], a[0:3], a[232:235], 0
  ds_read_b128 a[244:247], v2 offset:35840
  s_barrier
  s_lshl_b32 s10, s4, 12
  v_mfma_f32_32x32x16_bf16 v[64:79], a[116:119], a[232:235], 0
  s_add_u32 s8, s67, 0
  buffer_load_dwordx4 a[116:119], v2, s[36:39], s8 offen offset:0 sc1
  v_add_u32 v5, s10, v2
  v_add_u32 v6, s9, v2
  s_waitcnt lgkmcnt(2)
  v_mfma_f32_32x32x16_bf16 v[48:63], a[4:7], a[236:239], v[48:63]
  ds_read_b128 a[232:235], v2 offset:36864
  s_lshl_b32 s10, s59, 14
  v_add_u32 v7, s10, v2
  v_mfma_f32_32x32x16_bf16 v[64:79], a[120:123], a[236:239], v[64:79]
  buffer_load_dwordx4 a[120:123], v2, s[36:39], s8 offen offset:1024 sc1
  s_lshl_b32 s10, s58, 14
  s_add_u32 s10, s10, 131072
  s_waitcnt lgkmcnt(2)
  v_mfma_f32_32x32x16_bf16 v[48:63], a[8:11], a[240:243], v[48:63]
  ds_read_b128 a[236:239], v2 offset:37888
  v_add_u32 v8, s10, v2
  v_cvt_pk_bf16_f32 v16, v16, v17
  v_mfma_f32_32x32x16_bf16 v[64:79], a[124:127], a[240:243], v[64:79]
  buffer_load_dwordx4 a[124:127], v2, s[36:39], s8 offen offset:2048 sc1
  v_cvt_pk_bf16_f32 v17, v18, v19
  v_pk_max_i16 v16, v16, 0
  s_waitcnt lgkmcnt(2)
  v_mfma_f32_32x32x16_bf16 v[48:63], a[12:15], a[244:247], v[48:63]
  ds_read_b128 a[240:243], v2 offset:38912
  v_cvt_pk_bf16_f32 v18, v20, v21
  v_pk_max_i16 v17, v17, 0
  v_mfma_f32_32x32x16_bf16 v[64:79], a[128:131], a[244:247], v[64:79]
  buffer_load_dwordx4 a[128:131], v2, s[36:39], s8 offen offset:3072 sc1
  v_cvt_pk_bf16_f32 v19, v22, v23
  v_pk_max_i16 v18, v18, 0
  s_waitcnt lgkmcnt(2)
  v_mfma_f32_32x32x16_bf16 v[48:63], a[16:19], a[232:235], v[48:63]
  ds_read_b128 a[244:247], v2 offset:39936
  v_cvt_pk_bf16_f32 v20, v24, v25
  v_pk_max_i16 v19, v19, 0
  v_mfma_f32_32x32x16_bf16 v[64:79], a[132:135], a[232:235], v[64:79]
  s_add_u32 s8, s67, 4096
  buffer_load_dwordx4 a[132:135], v2, s[36:39], s8 offen offset:0 sc1
  ds_write_b128 v5, v[16:19] offset:0
  v_cvt_pk_bf16_f32 v21, v26, v27
  s_waitcnt lgkmcnt(3)
  v_mfma_f32_32x32x16_bf16 v[48:63], a[20:23], a[236:239], v[48:63]
  ds_read_b128 a[232:235], v2 offset:40960
  v_pk_max_i16 v20, v20, 0
  v_cvt_pk_bf16_f32 v22, v28, v29
  v_mfma_f32_32x32x16_bf16 v[64:79], a[136:139], a[236:239], v[64:79]
  buffer_load_dwordx4 a[136:139], v2, s[36:39], s8 offen offset:1024 sc1
  v_pk_max_i16 v21, v21, 0
  v_cvt_pk_bf16_f32 v23, v30, v31
  s_waitcnt lgkmcnt(3)
  v_mfma_f32_32x32x16_bf16 v[48:63], a[24:27], a[240:243], v[48:63]
  ds_read_b128 a[236:239], v2 offset:41984
  v_pk_max_i16 v22, v22, 0
  v_pk_max_i16 v23, v23, 0
  v_mfma_f32_32x32x16_bf16 v[64:79], a[140:143], a[240:243], v[64:79]
  buffer_load_dwordx4 a[140:143], v2, s[36:39], s8 offen offset:2048 sc1
  ds_write_b128 v5, v[20:23] offset:1024
  v_cvt_pk_bf16_f32 v32, v32, v33
  s_waitcnt lgkmcnt(4)
  v_mfma_f32_32x32x16_bf16 v[48:63], a[28:31], a[244:247], v[48:63]
  ds_read_b128 a[240:243], v2 offset:43008
  v_cvt_pk_bf16_f32 v33, v34, v35
  v_pk_max_i16 v32, v32, 0
  v_mfma_f32_32x32x16_bf16 v[64:79], a[144:147], a[244:247], v[64:79]
  buffer_load_dwordx4 a[144:147], v2, s[36:39], s8 offen offset:3072 sc1
  v_cvt_pk_bf16_f32 v34, v36, v37
  v_pk_max_i16 v33, v33, 0
  s_waitcnt lgkmcnt(3)
  v_mfma_f32_32x32x16_bf16 v[48:63], a[32:35], a[232:235], v[48:63]
  ds_read_b128 a[244:247], v2 offset:44032
  v_cvt_pk_bf16_f32 v35, v38, v39
  v_pk_max_i16 v34, v34, 0
  v_mfma_f32_32x32x16_bf16 v[64:79], a[148:151], a[232:235], v[64:79]
  s_add_u32 s8, s67, 8192
  buffer_load_dwordx4 a[148:151], v2, s[36:39], s8 offen offset:0 sc1
  v_cvt_pk_bf16_f32 v36, v40, v41
  v_pk_max_i16 v35, v35, 0
W35:
  s_cbranch_execz W39
  s_waitcnt lgkmcnt(3)
  v_mfma_f32_32x32x16_bf16 v[48:63], a[36:39], a[236:239], v[48:63]
  ds_read_b128 a[232:235], v2 offset:45056
  ds_write_b128 v5, v[32:35] offset:2048
  v_cvt_pk_bf16_f32 v37, v42, v43
  v_mfma_f32_32x32x16_bf16 v[64:79], a[152:155], a[236:239], v[64:79]
  buffer_load_dwordx4 a[152:155], v2, s[36:39], s8 offen offset:1024 sc1
  v_pk_max_i16 v36, v36, 0
  v_cvt_pk_bf16_f32 v38, v44, v45
  s_waitcnt lgkmcnt(3)
  v_mfma_f32_32x32x16_bf16 v[48:63], a[40:43], a[240:243], v[48:63]
  ds_read_b128 a[236:239], v2 offset:46080
  v_pk_max_i16 v37, v37, 0
  v_cvt_pk_bf16_f32 v39, v46, v47
  v_mfma_f32_32x32x16_bf16 v[64:79], a[156:159], a[240:243], v[64:79]
  buffer_load_dwordx4 a[156:159], v2, s[36:39], s8 offen offset:2048 sc1
  v_pk_max_i16 v38, v38, 0
  v_pk_max_i16 v39, v39, 0
  s_waitcnt lgkmcnt(3)
  v_mfma_f32_32x32x16_bf16 v[48:63], a[44:47], a[244:247], v[48:63]
  ds_read_b128 a[240:243], v2 offset:47104
  ds_write_b128 v5, v[36:39] offset:3072
  v_mfma_f32_32x32x16_bf16 v[64:79], a[160:163], a[244:247], v[64:79]
  buffer_load_dwordx4 a[160:163], v2, s[36:39], s8 offen offset:3072 sc1
  s_waitcnt lgkmcnt(4)
  v_mfma_f32_32x32x16_bf16 v[48:63], a[48:51], a[232:235], v[48:63]
  ds_read_b128 a[244:247], v2 offset:48128
  v_mfma_f32_32x32x16_bf16 v[64:79], a[164:167], a[232:235], v[64:79]
  s_add_u32 s8, s67, 12288
  buffer_load_dwordx4 a[164:167], v2, s[36:39], s8 offen offset:0 sc1
  s_waitcnt lgkmcnt(3)
  v_mfma_f32_32x32x16_bf16 v[48:63], a[52:55], a[236:239], v[48:63]
  ds_read_b128 a[232:235], v2 offset:49152
  s_waitcnt lgkmcnt(2)
  s_barrier
  v_mfma_f32_32x32x16_bf16 v[64:79], a[168:171], a[236:239], v[64:79]
  buffer_load_dwordx4 a[168:171], v2, s[36:39], s8 offen offset:1024 sc1
  s_waitcnt lgkmcnt(3)
  v_mfma_f32_32x32x16_bf16 v[48:63], a[56:59], a[240:243], v[48:63]
  ds_read_b128 a[236:239], v2 offset:50176
  v_mfma_f32_32x32x16_bf16 v[64:79], a[172:175], a[240:243], v[64:79]
  buffer_load_dwordx4 a[172:175], v2, s[36:39], s8 offen offset:2048 sc1
  s_waitcnt lgkmcnt(2)
  v_mfma_f32_32x32x16_bf16 v[48:63], a[60:63], a[244:247], v[48:63]
  ds_read_b128 a[240:243], v2 offset:51200
  v_mfma_f32_32x32x16_bf16 v[64:79], a[176:179], a[244:247], v[64:79]
  buffer_load_dwordx4 a[176:179], v2, s[36:39], s8 offen offset:3072 sc1
  s_waitcnt lgkmcnt(2)
  v_mfma_f32_32x32x16_bf16 v[48:63], a[64:67], a[232:235], v[48:63]
  ds_read_b128 a[244:247], v2 offset:52224
  v_mfma_f32_32x32x16_bf16 v[64:79], a[180:183], a[232:235], v[64:79]
  s_mul_i32 s74, s57, 14
  s_add_u32 s74, s74, s58
  s_add_u32 s74, s74, 12
  s_lshl_b32 s74, s74, 14
  s_add_u32 s74, s74, 12582912
  s_add_u32 s8, s74, 0
  buffer_load_dwordx4 a[180:183], v2, s[36:39], s8 offen offset:0 sc1
  s_waitcnt lgkmcnt(2)
  v_mfma_f32_32x32x16_bf16 v[48:63], a[68:71], a[236:239], v[48:63]
  ds_read_b128 a[232:235], v2 offset:53248
  v_mfma_f32_32x32x16_bf16 v[64:79], a[184:187], a[236:239], v[64:79]
  buffer_load_dwordx4 a[184:187], v2, s[36:39], s8 offen offset:1024 sc1
  s_waitcnt lgkmcnt(2)
  v_mfma_f32_32x32x16_bf16 v[48:63], a[72:75], a[240:243], v[48:63]
  ds_read_b128 a[236:239], v2 offset:54272
  v_mfma_f32_32x32x16_bf16 v[64:79], a[188:191], a[240:243], v[64:79]
  buffer_load_dwordx4 a[188:191], v2, s[36:39], s8 offen offset:2048 sc1
  s_waitcnt lgkmcnt(2)
  v_mfma_f32_32x32x16_bf16 v[48:63], a[76:79], a[244:247], v[48:63]
  ds_read_b128 a[240:243], v2 offset:55296
  v_mfma_f32_32x32x16_bf16 v[64:79], a[192:195], a[244:247], v[64:79]
  buffer_load_dwordx4 a[192:195], v2, s[36:39], s8 offen offset:3072 sc1
  s_waitcnt lgkmcnt(2)
  v_mfma_f32_32x32x16_bf16 v[48:63], a[80:83], a[232:235], v[48:63]
  ds_read_b128 a[244:247], v2 offset:56320
  v_mfma_f32_32x32x16_bf16 v[64:79], a[196:199], a[232:235], v[64:79]
  s_add_u32 s8, s74, 4096
  buffer_load_dwordx4 a[196:199], v2, s[36:39], s8 offen offset:0 sc1
  s_waitcnt lgkmcnt(2)
  v_mfma_f32_32x32x16_bf16 v[48:63], a[84:87], a[236:239], v[48:63]
  ds_read_b128 a[232:235], v2 offset:57344
  v_mfma_f32_32x32x16_bf16 v[64:79], a[200:203], a[236:239], v[64:79]
  buffer_load_dwordx4 a[200:203], v2, s[36:39], s8 offen offset:1024 sc1
  s_waitcnt lgkmcnt(2)
  v_mfma_f32_32x32x16_bf16 v[48:63], a[88:91], a[240:243], v[48:63]
  ds_read_b128 a[236:239], v2 offset:58368
  v_mfma_f32_32x32x16_bf16 v[64:79], a[204:207], a[240:243], v[64:79]
  buffer_load_dwordx4 a[204:207], v2, s[36:39], s8 offen offset:2048 sc1
  s_waitcnt lgkmcnt(2)
  v_mfma_f32_32x32x16_bf16 v[48:63], a[92:95], a[244:247], v[48:63]
  ds_read_b128 a[240:243], v2 offset:59392
  v_mfma_f32_32x32x16_bf16 v[64:79], a[208:211], a[244:247], v[64:79]
  buffer_load_dwordx4 a[208:211], v2, s[36:39], s8 offen offset:3072 sc1
  s_waitcnt lgkmcnt(2)
  v_mfma_f32_32x32x16_bf16 v[48:63], a[96:99], a[232:235], v[48:63]
  ds_read_b128 a[244:247], v2 offset:60416
  v_mfma_f32_32x32x16_bf16 v[64:79], a[212:215], a[232:235], v[64:79]
  s_add_u32 s8, s74, 8192
  buffer_load_dwordx4 a[212:215], v2, s[36:39], s8 offen offset:0 sc1
  s_waitcnt lgkmcnt(2)
  v_mfma_f32_32x32x16_bf16 v[48:63], a[100:103], a[236:239], v[48:63]
  v_mfma_f32_32x32x16_bf16 v[64:79], a[216:219], a[236:239], v[64:79]
  buffer_load_dwordx4 a[216:219], v2, s[36:39], s8 offen offset:1024 sc1
  s_waitcnt lgkmcnt(1)
  v_mfma_f32_32x32x16_bf16 v[48:63], a[104:107], a[240:243], v[48:63]
  v_mfma_f32_32x32x16_bf16 v[64:79], a[220:223], a[240:243], v[64:79]
  buffer_load_dwordx4 a[220:223], v2, s[36:39], s8 offen offset:2048 sc1
  ds_read_b128 a[32:35], v2 offset:0
  s_waitcnt lgkmcnt(1)
  v_mfma_f32_32x32x16_bf16 v[48:63], a[108:111], a[244:247], v[48:63]
  v_mfma_f32_32x32x16_bf16 v[64:79], a[224:227], a[244:247], v[64:79]
  buffer_load_dwordx4 a[224:227], v2, s[36:39], s8 offen offset:3072 sc1
  ds_read_b128 a[36:39], v2 offset:1024
  v_mfma_f32_32x32x16_bf16 v[48:63], v[164:167], v[156:159], v[48:63]
  v_mfma_f32_32x32x16_bf16 v[64:79], v[168:171], v[156:159], v[64:79]
  s_add_u32 s8, s74, 12288
  buffer_load_dwordx4 a[16:19], v2, s[36:39], s8 offen offset:0 sc1
  ds_read_b128 a[40:43], v2 offset:2048
  s_waitcnt lgkmcnt(2) vmcnt(29)
  v_mfma_f32_32x32x16_bf16 v[32:47], v[80:83], a[32:35], 0
  buffer_load_dwordx4 a[20:23], v2, s[36:39], s8 offen offset:1024 sc1
  ds_read_b128 a[44:47], v2 offset:3072
  s_waitcnt lgkmcnt(2)
  v_mfma_f32_32x32x16_bf16 v[32:47], v[84:87], a[36:39], v[32:47]
  buffer_load_dwordx4 a[24:27], v2, s[36:39], s8 offen offset:2048 sc1
  ds_read_b128 a[48:51], v2 offset:4096
  s_waitcnt lgkmcnt(2)
  v_mfma_f32_32x32x16_bf16 v[32:47], v[88:91], a[40:43], v[32:47]
  buffer_load_dwordx4 a[28:31], v2, s[36:39], s8 offen offset:3072 sc1
  ds_read_b128 a[52:55], v2 offset:5120
  v_cvt_pk_bf16_f32 v48, v48, v49
  v_cvt_pk_bf16_f32 v49, v50, v51
  v_pk_max_i16 v48, v48, 0
  s_waitcnt lgkmcnt(2)
  v_mfma_f32_32x32x16_bf16 v[32:47], v[92:95], a[44:47], v[32:47]
  ds_read_b128 a[56:59], v2 offset:6144
  v_cvt_pk_bf16_f32 v50, v52, v53
  v_pk_max_i16 v49, v49, 0
  v_cvt_pk_bf16_f32 v51, v54, v55
  s_waitcnt lgkmcnt(2)
  v_mfma_f32_32x32x16_bf16 v[32:47], v[96:99], a[48:51], v[32:47]
  ds_read_b128 a[60:63], v2 offset:7168
W36:
  s_cbranch_execz WR_PO
  v_pk_max_i16 v50, v50, 0
  v_cvt_pk_bf16_f32 v52, v56, v57
  v_pk_max_i16 v51, v51, 0
  s_waitcnt lgkmcnt(2)
  v_mfma_f32_32x32x16_bf16 v[32:47], v[100:103], a[52:55], v[32:47]
  ds_read_b128 a[64:67], v2 offset:8192
  ds_write_b128 v5, v[48:51] offset:16384
  v_cvt_pk_bf16_f32 v53, v58, v59
  v_pk_max_i16 v52, v52, 0
  s_waitcnt lgkmcnt(3)
  v_mfma_f32_32x32x16_bf16 v[32:47], v[104:107], a[56:59], v[32:47]
  ds_read_b128 a[68:71], v2 offset:9216
  v_cvt_pk_bf16_f32 v54, v60, v61
  v_pk_max_i16 v53, v53, 0
  v_cvt_pk_bf16_f32 v55, v62, v63
  s_waitcnt lgkmcnt(3)
  v_mfma_f32_32x32x16_bf16 v[32:47], v[108:111], a[60:63], v[32:47]
  ds_read_b128 a[72:75], v2 offset:10240
  v_pk_max_i16 v54, v54, 0
  v_pk_max_i16 v55, v55, 0
  ds_write_b128 v5, v[52:55] offset:17408
  s_waitcnt lgkmcnt(4)
  v_mfma_f32_32x32x16_bf16 v[32:47], v[112:115], a[64:67], v[32:47]
  ds_read_b128 a[76:79], v2 offset:11264
  v_cvt_pk_bf16_f32 v64, v64, v65
  v_cvt_pk_bf16_f32 v65, v66, v67
  v_pk_max_i16 v64, v64, 0
  s_waitcnt lgkmcnt(3)
  v_mfma_f32_32x32x16_bf16 v[32:47], v[116:119], a[68:71], v[32:47]
  ds_read_b128 a[80:83], v2 offset:12288
  v_cvt_pk_bf16_f32 v66, v68, v69
  v_pk_max_i16 v65, v65, 0
  v_cvt_pk_bf16_f32 v67, v70, v71
  s_waitcnt lgkmcnt(3)
  v_mfma_f32_32x32x16_bf16 v[32:47], v[120:123], a[72:75], v[32:47]
  ds_read_b128 a[84:87], v2 offset:13312
  v_pk_max_i16 v66, v66, 0
  v_cvt_pk_bf16_f32 v68, v72, v73
  v_pk_max_i16 v67, v67, 0
  s_waitcnt lgkmcnt(2)
  v_mfma_f32_32x32x16_bf16 v[32:47], v[124:127], a[76:79], v[32:47]
  ds_read_b128 a[88:91], v2 offset:14336
  ds_write_b128 v5, v[64:67] offset:18432
  v_cvt_pk_bf16_f32 v69, v74, v75
  v_pk_max_i16 v68, v68, 0
  s_waitcnt lgkmcnt(3)
  v_mfma_f32_32x32x16_bf16 v[32:47], v[128:131], a[80:83], v[32:47]
  ds_read_b128 a[92:95], v2 offset:15360
  v_cvt_pk_bf16_f32 v70, v76, v77
  v_pk_max_i16 v69, v69, 0
  v_cvt_pk_bf16_f32 v71, v78, v79
  s_waitcnt lgkmcnt(3)
  v_mfma_f32_32x32x16_bf16 v[32:47], v[132:135], a[84:87], v[32:47]
  v_pk_max_i16 v70, v70, 0
  v_pk_max_i16 v71, v71, 0
  ds_write_b128 v5, v[68:71] offset:19456
  s_waitcnt lgkmcnt(3)
  v_mfma_f32_32x32x16_bf16 v[32:47], v[136:139], a[88:91], v[32:47]
  s_waitcnt lgkmcnt(1)
  v_mfma_f32_32x32x16_bf16 v[32:47], v[140:143], a[92:95], v[32:47]
  v_mfma_f32_32x32x16_bf16 v[144:159], v[192:195], a[32:35], 0
  s_nop 5
  v_mfma_f32_32x32x16_bf16 v[144:159], v[196:199], a[36:39], v[144:159]
  s_nop 3
  v_cvt_pk_bf16_f32 v32, v32, v33
  v_cvt_pk_bf16_f32 v33, v34, v35
  v_min_u32 v32, -2, v32
  v_cvt_pk_bf16_f32 v34, v36, v37
  v_mfma_f32_32x32x16_bf16 v[144:159], v[200:203], a[40:43], v[144:159]
  v_min_u32 v33, -2, v33
  v_cvt_pk_bf16_f32 v35, v38, v39
  v_min_u32 v34, -2, v34
  v_cvt_pk_bf16_f32 v36, v40, v41
  v_mfma_f32_32x32x16_bf16 v[144:159], v[204:207], a[44:47], v[144:159]
  v_min_u32 v35, -2, v35
  v_cvt_pk_bf16_f32 v37, v42, v43
  v_min_u32 v36, -2, v36
  v_cvt_pk_bf16_f32 v38, v44, v45
  v_mfma_f32_32x32x16_bf16 v[144:159], v[208:211], a[48:51], v[144:159]
  v_min_u32 v37, -2, v37
  v_cvt_pk_bf16_f32 v39, v46, v47
  v_min_u32 v38, -2, v38
  v_min_u32 v39, -2, v39
  v_mfma_f32_32x32x16_bf16 v[144:159], v[212:215], a[52:55], v[144:159]
  s_add_u32 s10, s70, 0
  buffer_store_dwordx4 v[32:35], v2, s[36:39], s10 offen offset:0 sc1
  buffer_store_dwordx4 v[36:39], v2, s[36:39], s10 offen offset:1024 sc1
  v_mfma_f32_32x32x16_bf16 v[144:159], v[216:219], a[56:59], v[144:159]
  v_mfma_f32_32x32x16_bf16 v[144:159], v[220:223], a[60:63], v[144:159]
  s_waitcnt lgkmcnt(0)
  s_barrier
  v_mfma_f32_32x32x16_bf16 v[144:159], v[224:227], a[64:67], v[144:159]
  v_mfma_f32_32x32x16_bf16 v[144:159], v[228:231], a[68:71], v[144:159]
  v_mfma_f32_32x32x16_bf16 v[144:159], v[232:235], a[72:75], v[144:159]
  v_mfma_f32_32x32x16_bf16 v[144:159], v[236:239], a[76:79], v[144:159]
  v_mfma_f32_32x32x16_bf16 v[144:159], v[240:243], a[80:83], v[144:159]
  v_mfma_f32_32x32x16_bf16 v[144:159], v[244:247], a[84:87], v[144:159]
  v_mfma_f32_32x32x16_bf16 v[144:159], v[248:251], a[88:91], v[144:159]
  v_mfma_f32_32x32x16_bf16 v[144:159], v[252:255], a[92:95], v[144:159]
  s_waitcnt vmcnt(33)
  v_mfma_f32_32x32x16_bf16 v[16:31], a[116:119], a[32:35], 0
  s_nop 5
  s_waitcnt vmcnt(32)
  v_mfma_f32_32x32x16_bf16 v[16:31], a[120:123], a[36:39], v[16:31]
  ds_read_b128 a[32:35], v2 offset:16384
  s_nop 0
  v_cvt_pk_bf16_f32 v144, v144, v145
  v_cvt_pk_bf16_f32 v145, v146, v147
  v_min_u32 v144, -2, v144
  v_cvt_pk_bf16_f32 v146, v148, v149
  s_waitcnt vmcnt(31)
  v_mfma_f32_32x32x16_bf16 v[16:31], a[124:127], a[40:43], v[16:31]
  ds_read_b128 a[36:39], v2 offset:17408
  v_min_u32 v145, -2, v145
  v_cvt_pk_bf16_f32 v147, v150, v151
  v_min_u32 v146, -2, v146
  v_cvt_pk_bf16_f32 v148, v152, v153
  s_waitcnt vmcnt(30)
  v_mfma_f32_32x32x16_bf16 v[16:31], a[128:131], a[44:47], v[16:31]
  ds_read_b128 a[40:43], v2 offset:18432
  v_min_u32 v147, -2, v147
  v_cvt_pk_bf16_f32 v149, v154, v155
  v_min_u32 v148, -2, v148
  v_cvt_pk_bf16_f32 v150, v156, v157
  s_waitcnt vmcnt(29)
  v_mfma_f32_32x32x16_bf16 v[16:31], a[132:135], a[48:51], v[16:31]
  ds_read_b128 a[44:47], v2 offset:19456
  v_min_u32 v149, -2, v149
  v_cvt_pk_bf16_f32 v151, v158, v159
  v_min_u32 v150, -2, v150
  v_min_u32 v151, -2, v151
  s_waitcnt vmcnt(28)
  v_mfma_f32_32x32x16_bf16 v[16:31], a[136:139], a[52:55], v[16:31]
  ds_read_b128 a[48:51], v2 offset:20480
  s_add_u32 s10, s47, 0
  buffer_store_dwordx4 v[144:147], v2, s[36:39], s10 offen offset:0 sc1
  buffer_store_dwordx4 v[148:151], v2, s[36:39], s10 offen offset:1024 sc1
  s_waitcnt vmcnt(29)
  v_mfma_f32_32x32x16_bf16 v[16:31], a[140:143], a[56:59], v[16:31]
  ds_read_b128 a[52:55], v2 offset:21504
  s_waitcnt vmcnt(28)
  v_mfma_f32_32x32x16_bf16 v[16:31], a[144:147], a[60:63], v[16:31]
  ds_read_b128 a[56:59], v2 offset:22528
  s_waitcnt vmcnt(27)
  v_mfma_f32_32x32x16_bf16 v[16:31], a[148:151], a[64:67], v[16:31]
  ds_read_b128 a[60:63], v2 offset:23552
  s_waitcnt vmcnt(26)
  v_mfma_f32_32x32x16_bf16 v[16:31], a[152:155], a[68:71], v[16:31]
  ds_read_b128 a[64:67], v2 offset:24576
  s_waitcnt vmcnt(25)
  v_mfma_f32_32x32x16_bf16 v[16:31], a[156:159], a[72:75], v[16:31]
W37:
  s_cbranch_execz WR_PO
  ds_read_b128 a[68:71], v2 offset:25600
  s_waitcnt vmcnt(24)
  v_mfma_f32_32x32x16_bf16 v[16:31], a[160:163], a[76:79], v[16:31]
  ds_read_b128 a[72:75], v2 offset:26624
  s_waitcnt vmcnt(23)
  v_mfma_f32_32x32x16_bf16 v[16:31], a[164:167], a[80:83], v[16:31]
  ds_read_b128 a[76:79], v2 offset:27648
  s_waitcnt vmcnt(22)
  v_mfma_f32_32x32x16_bf16 v[16:31], a[168:171], a[84:87], v[16:31]
  ds_read_b128 a[80:83], v2 offset:28672
  s_waitcnt vmcnt(21)
  v_mfma_f32_32x32x16_bf16 v[16:31], a[172:175], a[88:91], v[16:31]
  ds_read_b128 a[84:87], v2 offset:29696
  s_waitcnt vmcnt(20)
  v_mfma_f32_32x32x16_bf16 v[16:31], a[176:179], a[92:95], v[16:31]
  ds_read_b128 a[88:91], v2 offset:30720
  s_waitcnt lgkmcnt(3)
  v_mfma_f32_32x32x16_bf16 v[48:63], a[116:119], a[32:35], 0
  ds_read_b128 a[92:95], v2 offset:31744
  s_nop 5
  v_mfma_f32_32x32x16_bf16 v[48:63], a[120:123], a[36:39], v[48:63]
  s_nop 0
  v_cvt_pk_bf16_f32 v16, v16, v17
  v_cvt_pk_bf16_f32 v17, v18, v19
  v_min_u32 v16, -2, v16
  v_cvt_pk_bf16_f32 v18, v20, v21
  v_mfma_f32_32x32x16_bf16 v[48:63], a[124:127], a[40:43], v[48:63]
  v_min_u32 v17, -2, v17
  v_cvt_pk_bf16_f32 v19, v22, v23
  v_min_u32 v18, -2, v18
  v_cvt_pk_bf16_f32 v20, v24, v25
  v_mfma_f32_32x32x16_bf16 v[48:63], a[128:131], a[44:47], v[48:63]
  v_min_u32 v19, -2, v19
  v_cvt_pk_bf16_f32 v21, v26, v27
  v_min_u32 v20, -2, v20
  v_cvt_pk_bf16_f32 v22, v28, v29
  v_mfma_f32_32x32x16_bf16 v[48:63], a[132:135], a[48:51], v[48:63]
  v_min_u32 v21, -2, v21
  v_cvt_pk_bf16_f32 v23, v30, v31
  v_min_u32 v22, -2, v22
  v_min_u32 v23, -2, v23
  v_mfma_f32_32x32x16_bf16 v[48:63], a[136:139], a[52:55], v[48:63]
  s_add_u32 s10, s69, 0
  buffer_store_dwordx4 v[16:19], v2, s[36:39], s10 offen offset:0 sc1
  buffer_store_dwordx4 v[20:23], v2, s[36:39], s10 offen offset:1024 sc1
  s_mul_i32 s10, s56, 28
  s_lshl_b32 s13, s57, 2
  v_mfma_f32_32x32x16_bf16 v[48:63], a[140:143], a[56:59], v[48:63]
  s_add_u32 s10, s10, s13
  s_lshl_b32 s13, s58, 1
  s_add_u32 s10, s10, s13
  s_add_u32 s10, s10, s59
  v_mfma_f32_32x32x16_bf16 v[48:63], a[144:147], a[60:63], v[48:63]
  s_mul_i32 s14, s10, 12288
  s_add_u32 s14, s14, 16777216
  s_add_u32 s15, s14, 4096
  s_add_u32 s74, s14, 8192
  v_mfma_f32_32x32x16_bf16 v[48:63], a[148:151], a[64:67], v[48:63]
  v_mfma_f32_32x32x16_bf16 v[48:63], a[152:155], a[68:71], v[48:63]
  v_mfma_f32_32x32x16_bf16 v[48:63], a[156:159], a[72:75], v[48:63]
  v_mfma_f32_32x32x16_bf16 v[48:63], a[160:163], a[76:79], v[48:63]
  s_waitcnt lgkmcnt(0)
  v_mfma_f32_32x32x16_bf16 v[48:63], a[164:167], a[80:83], v[48:63]
  v_mfma_f32_32x32x16_bf16 v[48:63], a[168:171], a[84:87], v[48:63]
  v_mfma_f32_32x32x16_bf16 v[48:63], a[172:175], a[88:91], v[48:63]
  v_mfma_f32_32x32x16_bf16 v[48:63], a[176:179], a[92:95], v[48:63]
  v_mfma_f32_32x32x16_bf16 v[64:79], v[80:83], a[32:35], 0
  s_nop 5
  v_mfma_f32_32x32x16_bf16 v[64:79], v[84:87], a[36:39], v[64:79]
  s_nop 3
  v_cvt_pk_bf16_f32 v48, v48, v49
  v_cvt_pk_bf16_f32 v49, v50, v51
  v_min_u32 v48, -2, v48
  v_cvt_pk_bf16_f32 v50, v52, v53
  v_mfma_f32_32x32x16_bf16 v[64:79], v[88:91], a[40:43], v[64:79]
  v_min_u32 v49, -2, v49
  v_cvt_pk_bf16_f32 v51, v54, v55
  v_min_u32 v50, -2, v50
  v_cvt_pk_bf16_f32 v52, v56, v57
  v_mfma_f32_32x32x16_bf16 v[64:79], v[92:95], a[44:47], v[64:79]
  v_min_u32 v51, -2, v51
  v_cvt_pk_bf16_f32 v53, v58, v59
  v_min_u32 v52, -2, v52
  v_cvt_pk_bf16_f32 v54, v60, v61
  v_mfma_f32_32x32x16_bf16 v[64:79], v[96:99], a[48:51], v[64:79]
  v_min_u32 v53, -2, v53
  v_cvt_pk_bf16_f32 v55, v62, v63
  v_min_u32 v54, -2, v54
  v_min_u32 v55, -2, v55
  v_mfma_f32_32x32x16_bf16 v[64:79], v[100:103], a[52:55], v[64:79]
  s_add_u32 s10, s69, 12288
  buffer_store_dwordx4 v[48:51], v2, s[36:39], s10 offen offset:0 sc1
  buffer_store_dwordx4 v[52:55], v2, s[36:39], s10 offen offset:1024 sc1
  v_mfma_f32_32x32x16_bf16 v[64:79], v[104:107], a[56:59], v[64:79]
  v_mfma_f32_32x32x16_bf16 v[64:79], v[108:111], a[60:63], v[64:79]
  v_mfma_f32_32x32x16_bf16 v[64:79], v[112:115], a[64:67], v[64:79]
  v_mfma_f32_32x32x16_bf16 v[64:79], v[116:119], a[68:71], v[64:79]
  v_mfma_f32_32x32x16_bf16 v[64:79], v[120:123], a[72:75], v[64:79]
  v_mfma_f32_32x32x16_bf16 v[64:79], v[124:127], a[76:79], v[64:79]
  v_mfma_f32_32x32x16_bf16 v[64:79], v[128:131], a[80:83], v[64:79]
  v_mfma_f32_32x32x16_bf16 v[64:79], v[132:135], a[84:87], v[64:79]
  v_mfma_f32_32x32x16_bf16 v[64:79], v[136:139], a[88:91], v[64:79]
  v_mfma_f32_32x32x16_bf16 v[64:79], v[140:143], a[92:95], v[64:79]
  v_mfma_f32_32x32x16_bf16 v[160:175], v[192:195], a[32:35], 0
  s_nop 5
  v_mfma_f32_32x32x16_bf16 v[160:175], v[196:199], a[36:39], v[160:175]
  ds_read_b128 a[32:35], v7 offset:0
  s_nop 2
  v_cvt_pk_bf16_f32 v64, v64, v65
  v_cvt_pk_bf16_f32 v65, v66, v67
  v_min_u32 v64, -2, v64
  v_cvt_pk_bf16_f32 v66, v68, v69
  v_mfma_f32_32x32x16_bf16 v[160:175], v[200:203], a[40:43], v[160:175]
  ds_read_b128 a[36:39], v7 offset:1024
  v_min_u32 v65, -2, v65
  v_cvt_pk_bf16_f32 v67, v70, v71
  v_min_u32 v66, -2, v66
  v_cvt_pk_bf16_f32 v68, v72, v73
  v_mfma_f32_32x32x16_bf16 v[160:175], v[204:207], a[44:47], v[160:175]
  ds_read_b128 a[40:43], v7 offset:2048
  v_min_u32 v67, -2, v67
  v_cvt_pk_bf16_f32 v69, v74, v75
  v_min_u32 v68, -2, v68
  v_cvt_pk_bf16_f32 v70, v76, v77
  v_mfma_f32_32x32x16_bf16 v[160:175], v[208:211], a[48:51], v[160:175]
  ds_read_b128 a[44:47], v7 offset:3072
  v_min_u32 v69, -2, v69
  v_cvt_pk_bf16_f32 v71, v78, v79
  v_min_u32 v70, -2, v70
  v_min_u32 v71, -2, v71
  v_mfma_f32_32x32x16_bf16 v[160:175], v[212:215], a[52:55], v[160:175]
  ds_read_b128 a[48:51], v7 offset:4096
  s_add_u32 s10, s70, 12288
  s_cmp_eq_u32 s61, 0
  s_cbranch_scc1 P_SA2
  buffer_store_dwordx4 v[64:67], v2, s[36:39], s10 offen offset:0
  buffer_store_dwordx4 v[68:71], v2, s[36:39], s10 offen offset:1024
  s_branch P_SB2
P_SA2:
  buffer_store_dwordx4 v[64:67], v2, s[36:39], s10 offen offset:0 sc1
  buffer_store_dwordx4 v[68:71], v2, s[36:39], s10 offen offset:1024 sc1
P_SB2:
  v_mfma_f32_32x32x16_bf16 v[160:175], v[216:219], a[56:59], v[160:175]
  ds_read_b128 a[52:55], v7 offset:5120
  v_mfma_f32_32x32x16_bf16 v[160:175], v[220:223], a[60:63], v[160:175]
  ds_read_b128 a[56:59], v7 offset:6144
  v_mfma_f32_32x32x16_bf16 v[160:175], v[224:227], a[64:67], v[160:175]
  ds_read_b128 a[60:63], v7 offset:7168
  v_mfma_f32_32x32x16_bf16 v[160:175], v[228:231], a[68:71], v[160:175]
  ds_read_b128 a[64:67], v7 offset:8192
  v_mfma_f32_32x32x16_bf16 v[160:175], v[232:235], a[72:75], v[160:175]
  ds_read_b128 a[68:71], v7 offset:9216
  v_mfma_f32_32x32x16_bf16 v[160:175], v[236:239], a[76:79], v[160:175]
W38:
  s_cbranch_execz WR_PO
  ds_read_b128 a[72:75], v7 offset:10240
  v_mfma_f32_32x32x16_bf16 v[160:175], v[240:243], a[80:83], v[160:175]
  ds_read_b128 a[76:79], v7 offset:11264
  v_mfma_f32_32x32x16_bf16 v[160:175], v[244:247], a[84:87], v[160:175]
  ds_read_b128 a[80:83], v7 offset:12288
  v_mfma_f32_32x32x16_bf16 v[160:175], v[248:251], a[88:91], v[160:175]
  ds_read_b128 a[84:87], v7 offset:13312
  v_mfma_f32_32x32x16_bf16 v[160:175], v[252:255], a[92:95], v[160:175]
  ds_read_b128 a[88:91], v7 offset:14336
  s_waitcnt lgkmcnt(3) vmcnt(10)
  v_mfma_f32_32x32x16_bf16 v[16:31], a[180:183], a[32:35], 0
  ds_read_b128 a[92:95], v7 offset:15360
  s_nop 5
  v_mfma_f32_32x32x16_bf16 v[16:31], a[184:187], a[36:39], v[16:31]
  s_nop 0
  v_cvt_pk_bf16_f32 v160, v160, v161
  v_cvt_pk_bf16_f32 v161, v162, v163
  v_min_u32 v160, -2, v160
  v_cvt_pk_bf16_f32 v162, v164, v165
  v_min_u32 v161, -2, v161
  v_cvt_pk_bf16_f32 v163, v166, v167
  v_min_u32 v162, -2, v162
  v_cvt_pk_bf16_f32 v164, v168, v169
  v_mfma_f32_32x32x16_bf16 v[16:31], a[188:191], a[40:43], v[16:31]
  v_min_u32 v163, -2, v163
  v_cvt_pk_bf16_f32 v165, v170, v171
  v_min_u32 v164, -2, v164
  v_cvt_pk_bf16_f32 v166, v172, v173
  v_min_u32 v165, -2, v165
  v_cvt_pk_bf16_f32 v167, v174, v175
  v_min_u32 v166, -2, v166
  v_min_u32 v167, -2, v167
  v_mfma_f32_32x32x16_bf16 v[16:31], a[192:195], a[44:47], v[16:31]
  s_add_u32 s10, s47, 12288
  s_cmp_eq_u32 s61, 0
  s_cbranch_scc1 P_SA3
  buffer_store_dwordx4 v[160:163], v2, s[36:39], s10 offen offset:0
  buffer_store_dwordx4 v[164:167], v2, s[36:39], s10 offen offset:1024
  s_branch P_SB3
P_SA3:
  buffer_store_dwordx4 v[160:163], v2, s[36:39], s10 offen offset:0 sc1
  buffer_store_dwordx4 v[164:167], v2, s[36:39], s10 offen offset:1024 sc1
P_SB3:
  v_mfma_f32_32x32x16_bf16 v[16:31], a[196:199], a[48:51], v[16:31]
  v_mfma_f32_32x32x16_bf16 v[16:31], a[200:203], a[52:55], v[16:31]
  v_mfma_f32_32x32x16_bf16 v[16:31], a[204:207], a[56:59], v[16:31]
  v_mfma_f32_32x32x16_bf16 v[16:31], a[208:211], a[60:63], v[16:31]
  v_mfma_f32_32x32x16_bf16 v[16:31], a[212:215], a[64:67], v[16:31]
  v_mfma_f32_32x32x16_bf16 v[16:31], a[216:219], a[68:71], v[16:31]
  v_mfma_f32_32x32x16_bf16 v[16:31], a[220:223], a[72:75], v[16:31]
  v_mfma_f32_32x32x16_bf16 v[16:31], a[224:227], a[76:79], v[16:31]
  s_waitcnt lgkmcnt(0)
  v_mfma_f32_32x32x16_bf16 v[16:31], a[16:19], a[80:83], v[16:31]
  v_mfma_f32_32x32x16_bf16 v[16:31], a[20:23], a[84:87], v[16:31]
  v_mfma_f32_32x32x16_bf16 v[16:31], a[24:27], a[88:91], v[16:31]
  v_mfma_f32_32x32x16_bf16 v[16:31], a[28:31], a[92:95], v[16:31]
  buffer_load_dwordx4 v[80:83], v2, s[36:39], s14 offen offset:0 sc1
  buffer_load_dwordx4 v[84:87], v2, s[36:39], s14 offen offset:1024 sc1
  buffer_load_dwordx4 v[88:91], v2, s[36:39], s14 offen offset:2048 sc1
  buffer_load_dwordx4 v[92:95], v2, s[36:39], s14 offen offset:3072 sc1
  buffer_load_dwordx4 v[96:99], v2, s[36:39], s15 offen offset:0 sc1
  buffer_load_dwordx4 v[100:103], v2, s[36:39], s15 offen offset:1024 sc1
  buffer_load_dwordx4 v[104:107], v2, s[36:39], s15 offen offset:2048 sc1
  buffer_load_dwordx4 v[108:111], v2, s[36:39], s15 offen offset:3072 sc1
  buffer_load_dwordx4 v[112:115], v2, s[36:39], s74 offen offset:0 sc1
  buffer_load_dwordx4 v[116:119], v2, s[36:39], s74 offen offset:1024 sc1
  buffer_load_dwordx4 v[120:123], v2, s[36:39], s74 offen offset:2048 sc1
  buffer_load_dwordx4 v[124:127], v2, s[36:39], s74 offen offset:3072 sc1
P_G1:
  v_lshlrev_b32 v32, 16, v176
  v_and_b32 v33, 0xffff0000, v176
  v_lshlrev_b32 v34, 16, v177
  v_and_b32 v35, 0xffff0000, v177
  v_lshlrev_b32 v36, 16, v178
  v_and_b32 v37, 0xffff0000, v178
  v_lshlrev_b32 v38, 16, v179
  v_and_b32 v39, 0xffff0000, v179
  v_lshlrev_b32 v40, 16, v180
  v_and_b32 v41, 0xffff0000, v180
  v_lshlrev_b32 v42, 16, v181
  v_and_b32 v43, 0xffff0000, v181
  v_lshlrev_b32 v44, 16, v182
  v_and_b32 v45, 0xffff0000, v182
  v_lshlrev_b32 v46, 16, v183
  v_and_b32 v47, 0xffff0000, v183
  v_and_b32 v8, 1, v1
  v_lshlrev_b32 v8, 4, v8
  v_mov_b32 v9, 0x3f80
  v_lshlrev_b32 v8, v8, v9
  s_mov_b32 s10, 0xcccccccc
  s_mov_b32 s11, 0xcccccccc
  v_cndmask_b32 v6, v8, 0, s[10:11]
  v_cndmask_b32 v7, 0, v8, s[10:11]
  v_and_b32 v5, 31, v1
  v_mul_u32_u24 v5, 896, v5
  v_lshrrev_b32 v8, 5, v1
  v_lshlrev_b32 v8, 4, v8
  v_add_u32 v5, v5, v8
  s_mov_b32 s62, 63
  s_waitcnt vmcnt(10)
  v_max3_u32 v4, v80, v81, v82
  v_max3_u32 v4, v4, v83, v84
  v_max3_u32 v4, v4, v85, v86
  v_max_u32 v4, v4, v87
  v_cmp_eq_u32 vcc, -1, v4
  s_nop 1
  s_cbranch_vccnz PP_E0
  v_mfma_f32_4x4x4_16b_bf16 v[16:19], v[6:7], v[80:81], v[16:19]
  v_mfma_f32_4x4x4_16b_bf16 v[20:23], v[6:7], v[82:83], v[20:23]
  v_mfma_f32_4x4x4_16b_bf16 v[24:27], v[6:7], v[84:85], v[24:27]
  v_mfma_f32_4x4x4_16b_bf16 v[28:31], v[6:7], v[86:87], v[28:31]
  s_waitcnt vmcnt(8)
  v_max3_u32 v4, v88, v89, v90
  v_max3_u32 v4, v4, v91, v92
  v_max3_u32 v4, v4, v93, v94
  v_max_u32 v4, v4, v95
  v_cmp_eq_u32 vcc, -1, v4
  s_nop 1
  s_cbranch_vccnz PP_E1
PP_J1:
  v_mfma_f32_4x4x4_16b_bf16 v[16:19], v[6:7], v[88:89], v[16:19]
  v_mfma_f32_4x4x4_16b_bf16 v[20:23], v[6:7], v[90:91], v[20:23]
  v_mfma_f32_4x4x4_16b_bf16 v[24:27], v[6:7], v[92:93], v[24:27]
  v_mfma_f32_4x4x4_16b_bf16 v[28:31], v[6:7], v[94:95], v[28:31]
  s_waitcnt vmcnt(6)
  v_max3_u32 v4, v96, v97, v98
  v_max3_u32 v4, v4, v99, v100
  v_max3_u32 v4, v4, v101, v102
  v_max_u32 v4, v4, v103
  v_cmp_eq_u32 vcc, -1, v4
  s_nop 1
  s_cbranch_vccnz PP_E2
PP_J2:
  v_mfma_f32_4x4x4_16b_bf16 v[16:19], v[6:7], v[96:97], v[16:19]
  v_mfma_f32_4x4x4_16b_bf16 v[20:23], v[6:7], v[98:99], v[20:23]
  v_mfma_f32_4x4x4_16b_bf16 v[24:27], v[6:7], v[100:101], v[24:27]
  v_mfma_f32_4x4x4_16b_bf16 v[28:31], v[6:7], v[102:103], v[28:31]
  s_waitcnt vmcnt(4)
  v_max3_u32 v4, v104, v105, v106
  v_max3_u32 v4, v4, v107, v108
  v_max3_u32 v4, v4, v109, v110
  v_max_u32 v4, v4, v111
  v_cmp_eq_u32 vcc, -1, v4
  s_nop 1
  s_cbranch_vccnz PP_E3
PP_J3:
  v_mfma_f32_4x4x4_16b_bf16 v[16:19], v[6:7], v[104:105], v[16:19]
  v_mfma_f32_4x4x4_16b_bf16 v[20:23], v[6:7], v[106:107], v[20:23]
  v_mfma_f32_4x4x4_16b_bf16 v[24:27], v[6:7], v[108:109], v[24:27]
  v_mfma_f32_4x4x4_16b_bf16 v[28:31], v[6:7], v[110:111], v[28:31]
  s_waitcnt vmcnt(2)
  v_max3_u32 v4, v112, v113, v114
  v_max3_u32 v4, v4, v115, v116
  v_max3_u32 v4, v4, v117, v118
  v_max_u32 v4, v4, v119
  v_cmp_eq_u32 vcc, -1, v4
  s_nop 1
  s_cbranch_vccnz PP_E4
PP_J4:
  v_mfma_f32_4x4x4_16b_bf16 v[16:19], v[6:7], v[112:113], v[16:19]
  v_mfma_f32_4x4x4_16b_bf16 v[20:23], v[6:7], v[114:115], v[20:23]
  v_mfma_f32_4x4x4_16b_bf16 v[24:27], v[6:7], v[116:117], v[24:27]
W39:
  s_cbranch_execz WR_PO
  v_mfma_f32_4x4x4_16b_bf16 v[28:31], v[6:7], v[118:119], v[28:31]
  s_waitcnt vmcnt(0)
  v_max3_u32 v4, v120, v121, v122
  v_max3_u32 v4, v4, v123, v124
  v_max3_u32 v4, v4, v125, v126
  v_max_u32 v4, v4, v127
  v_cmp_eq_u32 vcc, -1, v4
  s_nop 1
  s_cbranch_vccnz PP_E5
PP_J5:
  v_mfma_f32_4x4x4_16b_bf16 v[16:19], v[6:7], v[120:121], v[16:19]
  v_mfma_f32_4x4x4_16b_bf16 v[20:23], v[6:7], v[122:123], v[20:23]
  v_mfma_f32_4x4x4_16b_bf16 v[24:27], v[6:7], v[124:125], v[24:27]
  v_mfma_f32_4x4x4_16b_bf16 v[28:31], v[6:7], v[126:127], v[28:31]
  s_nop 1
  s_cmp_eq_u32 s62, 63
  s_cbranch_scc0 PP_L
PP_O:
  s_nop 3
  v_pk_fma_f32 v[16:17], v[16:17], v[2:3], v[32:33] op_sel:[0,1,0] op_sel_hi:[1,1,1]
  v_pk_fma_f32 v[18:19], v[18:19], v[2:3], v[34:35] op_sel:[0,1,0] op_sel_hi:[1,1,1]
  v_pk_fma_f32 v[20:21], v[20:21], v[2:3], v[36:37] op_sel:[0,1,0] op_sel_hi:[1,1,1]
  v_pk_fma_f32 v[22:23], v[22:23], v[2:3], v[38:39] op_sel:[0,1,0] op_sel_hi:[1,1,1]
  v_pk_fma_f32 v[24:25], v[24:25], v[2:3], v[40:41] op_sel:[0,1,0] op_sel_hi:[1,1,1]
  v_pk_fma_f32 v[26:27], v[26:27], v[2:3], v[42:43] op_sel:[0,1,0] op_sel_hi:[1,1,1]
  v_pk_fma_f32 v[28:29], v[28:29], v[2:3], v[44:45] op_sel:[0,1,0] op_sel_hi:[1,1,1]
  v_pk_fma_f32 v[30:31], v[30:31], v[2:3], v[46:47] op_sel:[0,1,0] op_sel_hi:[1,1,1]
  v_cvt_pk_bf16_f32 v32, v16, v17
  v_cvt_pk_bf16_f32 v33, v18, v19
  v_cvt_pk_bf16_f32 v34, v20, v21
  v_cvt_pk_bf16_f32 v35, v22, v23
  s_nop 0
  v_permlane32_swap_b32 v32, v34
  v_permlane32_swap_b32 v33, v35
  v_cvt_pk_bf16_f32 v36, v24, v25
  v_cvt_pk_bf16_f32 v37, v26, v27
  v_cvt_pk_bf16_f32 v38, v28, v29
  v_cvt_pk_bf16_f32 v39, v30, v31
  buffer_store_dwordx4 v[32:35], v5, s[48:51], s72 offen offset:0
  v_permlane32_swap_b32 v36, v38
  v_permlane32_swap_b32 v37, v39
  buffer_store_dwordx4 v[36:39], v5, s[48:51], s72 offen offset:32
P_DONE:
  s_waitcnt vmcnt(0)
  s_endpgm
P_COLD:
PP_E0:
  buffer_load_dwordx4 v[80:83], v2, s[36:39], s14 offen offset:0 sc1
  buffer_load_dwordx4 v[84:87], v2, s[36:39], s14 offen offset:1024 sc1
  s_bitset0_b32 s62, 0
  s_mov_b32 s63, 29999
  s_waitcnt vmcnt(8)
  v_max3_u32 v4, v88, v89, v90
  v_max3_u32 v4, v4, v91, v92
  v_max3_u32 v4, v4, v93, v94
  v_max_u32 v4, v4, v95
  v_cmp_eq_u32 vcc, -1, v4
  s_nop 0
  s_cbranch_vccz PP_J1
PP_E1:
  buffer_load_dwordx4 v[88:91], v2, s[36:39], s14 offen offset:2048 sc1
  buffer_load_dwordx4 v[92:95], v2, s[36:39], s14 offen offset:3072 sc1
  s_bitset0_b32 s62, 1
  s_mov_b32 s63, 29999
  s_waitcnt vmcnt(6)
  v_max3_u32 v4, v96, v97, v98
  v_max3_u32 v4, v4, v99, v100
  v_max3_u32 v4, v4, v101, v102
  v_max_u32 v4, v4, v103
  v_cmp_eq_u32 vcc, -1, v4
  s_nop 0
  s_cbranch_vccz PP_J2
PP_E2:
  buffer_load_dwordx4 v[96:99], v2, s[36:39], s15 offen offset:0 sc1
  buffer_load_dwordx4 v[100:103], v2, s[36:39], s15 offen offset:1024 sc1
  s_bitset0_b32 s62, 2
  s_mov_b32 s63, 29999
  s_waitcnt vmcnt(4)
  v_max3_u32 v4, v104, v105, v106
  v_max3_u32 v4, v4, v107, v108
  v_max3_u32 v4, v4, v109, v110
  v_max_u32 v4, v4, v111
  v_cmp_eq_u32 vcc, -1, v4
  s_nop 0
  s_cbranch_vccz PP_J3
PP_E3:
  buffer_load_dwordx4 v[104:107], v2, s[36:39], s15 offen offset:2048 sc1
  buffer_load_dwordx4 v[108:111], v2, s[36:39], s15 offen offset:3072 sc1
  s_bitset0_b32 s62, 3
  s_mov_b32 s63, 29999
  s_waitcnt vmcnt(2)
  v_max3_u32 v4, v112, v113, v114
  v_max3_u32 v4, v4, v115, v116
  v_max3_u32 v4, v4, v117, v118
  v_max_u32 v4, v4, v119
  v_cmp_eq_u32 vcc, -1, v4
  s_nop 0
  s_cbranch_vccz PP_J4
PP_E4:
  buffer_load_dwordx4 v[112:115], v2, s[36:39], s74 offen offset:0 sc1
  buffer_load_dwordx4 v[116:119], v2, s[36:39], s74 offen offset:1024 sc1
  s_bitset0_b32 s62, 4
  s_mov_b32 s63, 29999
  s_waitcnt vmcnt(0)
  v_max3_u32 v4, v120, v121, v122
  v_max3_u32 v4, v4, v123, v124
  v_max3_u32 v4, v4, v125, v126
  v_max_u32 v4, v4, v127
  v_cmp_eq_u32 vcc, -1, v4
  s_nop 0
  s_cbranch_vccz PP_J5
PP_E5:
  buffer_load_dwordx4 v[120:123], v2, s[36:39], s74 offen offset:2048 sc1
  buffer_load_dwordx4 v[124:127], v2, s[36:39], s74 offen offset:3072 sc1
  s_bitset0_b32 s62, 5
  s_mov_b32 s63, 29999
PP_L:
  s_bitcmp1_b32 s62, 0
  s_cbranch_scc1 PP_S0
  s_waitcnt vmcnt(0)
  v_max3_u32 v4, v80, v81, v82
  v_max3_u32 v4, v4, v83, v84
  v_max3_u32 v4, v4, v85, v86
  v_max_u32 v4, v4, v87
  v_cmp_eq_u32 vcc, -1, v4
  s_bitset1_b32 s62, 0
  s_nop 0
  s_cbranch_vccnz PP_R0
  v_mfma_f32_4x4x4_16b_bf16 v[16:19], v[6:7], v[80:81], v[16:19]
  v_mfma_f32_4x4x4_16b_bf16 v[20:23], v[6:7], v[82:83], v[20:23]
  v_mfma_f32_4x4x4_16b_bf16 v[24:27], v[6:7], v[84:85], v[24:27]
  v_mfma_f32_4x4x4_16b_bf16 v[28:31], v[6:7], v[86:87], v[28:31]
PP_S0:
  s_bitcmp1_b32 s62, 1
  s_cbranch_scc1 PP_S1
  s_waitcnt vmcnt(0)
  v_max3_u32 v4, v88, v89, v90
  v_max3_u32 v4, v4, v91, v92
  v_max3_u32 v4, v4, v93, v94
  v_max_u32 v4, v4, v95
  v_cmp_eq_u32 vcc, -1, v4
  s_bitset1_b32 s62, 1
  s_nop 0
  s_cbranch_vccnz PP_R1
  v_mfma_f32_4x4x4_16b_bf16 v[16:19], v[6:7], v[88:89], v[16:19]
  v_mfma_f32_4x4x4_16b_bf16 v[20:23], v[6:7], v[90:91], v[20:23]
  v_mfma_f32_4x4x4_16b_bf16 v[24:27], v[6:7], v[92:93], v[24:27]
  v_mfma_f32_4x4x4_16b_bf16 v[28:31], v[6:7], v[94:95], v[28:31]
PP_S1:
  s_bitcmp1_b32 s62, 2
  s_cbranch_scc1 PP_S2
  s_waitcnt vmcnt(0)
  v_max3_u32 v4, v96, v97, v98
  v_max3_u32 v4, v4, v99, v100
  v_max3_u32 v4, v4, v101, v102
  v_max_u32 v4, v4, v103
  v_cmp_eq_u32 vcc, -1, v4
  s_bitset1_b32 s62, 2
  s_nop 0
  s_cbranch_vccnz PP_R2
  v_mfma_f32_4x4x4_16b_bf16 v[16:19], v[6:7], v[96:97], v[16:19]
  v_mfma_f32_4x4x4_16b_bf16 v[20:23], v[6:7], v[98:99], v[20:23]
  v_mfma_f32_4x4x4_16b_bf16 v[24:27], v[6:7], v[100:101], v[24:27]
  v_mfma_f32_4x4x4_16b_bf16 v[28:31], v[6:7], v[102:103], v[28:31]
PP_S2:
  s_bitcmp1_b32 s62, 3
  s_cbranch_scc1 PP_S3
  s_waitcnt vmcnt(0)
  v_max3_u32 v4, v104, v105, v106
  v_max3_u32 v4, v4, v107, v108
  v_max3_u32 v4, v4, v109, v110
  v_max_u32 v4, v4, v111
  v_cmp_eq_u32 vcc, -1, v4
  s_bitset1_b32 s62, 3
  s_nop 0
  s_cbranch_vccnz PP_R3
  v_mfma_f32_4x4x4_16b_bf16 v[16:19], v[6:7], v[104:105], v[16:19]
  v_mfma_f32_4x4x4_16b_bf16 v[20:23], v[6:7], v[106:107], v[20:23]
  v_mfma_f32_4x4x4_16b_bf16 v[24:27], v[6:7], v[108:109], v[24:27]
  v_mfma_f32_4x4x4_16b_bf16 v[28:31], v[6:7], v[110:111], v[28:31]
PP_S3:
  s_bitcmp1_b32 s62, 4
  s_cbranch_scc1 PP_S4
W40:
  s_cbranch_execz W42
  s_waitcnt vmcnt(0)
  v_max3_u32 v4, v112, v113, v114
  v_max3_u32 v4, v4, v115, v116
  v_max3_u32 v4, v4, v117, v118
  v_max_u32 v4, v4, v119
  v_cmp_eq_u32 vcc, -1, v4
  s_bitset1_b32 s62, 4
  s_nop 0
  s_cbranch_vccnz PP_R4
  v_mfma_f32_4x4x4_16b_bf16 v[16:19], v[6:7], v[112:113], v[16:19]
  v_mfma_f32_4x4x4_16b_bf16 v[20:23], v[6:7], v[114:115], v[20:23]
  v_mfma_f32_4x4x4_16b_bf16 v[24:27], v[6:7], v[116:117], v[24:27]
  v_mfma_f32_4x4x4_16b_bf16 v[28:31], v[6:7], v[118:119], v[28:31]
PP_S4:
  s_bitcmp1_b32 s62, 5
  s_cbranch_scc1 PP_S5
  s_waitcnt vmcnt(0)
  v_max3_u32 v4, v120, v121, v122
  v_max3_u32 v4, v4, v123, v124
  v_max3_u32 v4, v4, v125, v126
  v_max_u32 v4, v4, v127
  v_cmp_eq_u32 vcc, -1, v4
  s_bitset1_b32 s62, 5
  s_nop 0
  s_cbranch_vccnz PP_R5
  v_mfma_f32_4x4x4_16b_bf16 v[16:19], v[6:7], v[120:121], v[16:19]
  v_mfma_f32_4x4x4_16b_bf16 v[20:23], v[6:7], v[122:123], v[20:23]
  v_mfma_f32_4x4x4_16b_bf16 v[24:27], v[6:7], v[124:125], v[24:27]
  v_mfma_f32_4x4x4_16b_bf16 v[28:31], v[6:7], v[126:127], v[28:31]
PP_S5:
PP_G6:
  s_cmp_eq_u32 s62, 63
  s_cbranch_scc1 PP_O
  s_waitcnt vmcnt(0)
  s_sub_u32 s63, s63, 1
  s_cmp_eq_u32 s63, 0
  s_cbranch_scc1 P_END
  s_branch PP_L
PP_R0:
  buffer_load_dwordx4 v[80:83], v2, s[36:39], s14 offen offset:0 sc1
  buffer_load_dwordx4 v[84:87], v2, s[36:39], s14 offen offset:1024 sc1
  s_bitset0_b32 s62, 0
  s_branch PP_S0
PP_R1:
  buffer_load_dwordx4 v[88:91], v2, s[36:39], s14 offen offset:2048 sc1
  buffer_load_dwordx4 v[92:95], v2, s[36:39], s14 offen offset:3072 sc1
  s_bitset0_b32 s62, 1
  s_branch PP_S1
PP_R2:
  buffer_load_dwordx4 v[96:99], v2, s[36:39], s15 offen offset:0 sc1
  buffer_load_dwordx4 v[100:103], v2, s[36:39], s15 offen offset:1024 sc1
  s_bitset0_b32 s62, 2
  s_branch PP_S2
PP_R3:
  buffer_load_dwordx4 v[104:107], v2, s[36:39], s15 offen offset:2048 sc1
  buffer_load_dwordx4 v[108:111], v2, s[36:39], s15 offen offset:3072 sc1
  s_bitset0_b32 s62, 3
  s_branch PP_S3
PP_R4:
  buffer_load_dwordx4 v[112:115], v2, s[36:39], s74 offen offset:0 sc1
  buffer_load_dwordx4 v[116:119], v2, s[36:39], s74 offen offset:1024 sc1
  s_bitset0_b32 s62, 4
  s_branch PP_S4
PP_R5:
  buffer_load_dwordx4 v[120:123], v2, s[36:39], s74 offen offset:2048 sc1
  buffer_load_dwordx4 v[124:127], v2, s[36:39], s74 offen offset:3072 sc1
  s_bitset0_b32 s62, 5
  s_branch PP_S5
PH_E0:
  buffer_load_dwordx4 v[144:147], v2, s[36:39], s14 offen offset:0 sc1
  s_bitset0_b32 s62, 0
  s_mov_b32 s63, 29999
  s_waitcnt vmcnt(12)
  v_max3_u32 v4, v148, v149, v150
  v_max_u32 v4, v4, v151
  v_cmp_eq_u32 vcc, -1, v4
  s_nop 0
  s_cbranch_vccz PH_J1
PH_E1:
  buffer_load_dwordx4 v[148:151], v2, s[36:39], s14 offen offset:1024 sc1
  s_bitset0_b32 s62, 1
  s_mov_b32 s63, 29999
  s_waitcnt vmcnt(11)
  v_max3_u32 v4, v152, v153, v154
  v_max_u32 v4, v4, v155
  v_cmp_eq_u32 vcc, -1, v4
  s_nop 0
  s_cbranch_vccz PH_J2
PH_E2:
  buffer_load_dwordx4 v[152:155], v2, s[36:39], s14 offen offset:2048 sc1
  s_bitset0_b32 s62, 2
  s_mov_b32 s63, 29999
  s_waitcnt vmcnt(10)
  v_max3_u32 v4, v156, v157, v158
  v_max_u32 v4, v4, v159
  v_cmp_eq_u32 vcc, -1, v4
  s_nop 0
  s_cbranch_vccz PH_J3
PH_E3:
  buffer_load_dwordx4 v[156:159], v2, s[36:39], s14 offen offset:3072 sc1
  s_bitset0_b32 s62, 3
  s_mov_b32 s63, 29999
  s_waitcnt vmcnt(9)
  v_max3_u32 v4, v160, v161, v162
  v_max_u32 v4, v4, v163
  v_cmp_eq_u32 vcc, -1, v4
  s_nop 0
  s_cbranch_vccz PH_J4
PH_E4:
  buffer_load_dwordx4 v[160:163], v2, s[36:39], s15 offen offset:0 sc1
  s_bitset0_b32 s62, 4
  s_mov_b32 s63, 29999
  s_waitcnt vmcnt(8)
  v_max3_u32 v4, v164, v165, v166
  v_max_u32 v4, v4, v167
  v_cmp_eq_u32 vcc, -1, v4
  s_nop 0
  s_cbranch_vccz PH_J5
PH_E5:
  buffer_load_dwordx4 v[164:167], v2, s[36:39], s15 offen offset:1024 sc1
  s_bitset0_b32 s62, 5
  s_mov_b32 s63, 29999
  s_waitcnt vmcnt(7)
  v_max3_u32 v4, v168, v169, v170
  v_max_u32 v4, v4, v171
  v_cmp_eq_u32 vcc, -1, v4
  s_nop 0
  s_cbranch_vccz PH_J6
PH_E6:
  buffer_load_dwordx4 v[168:171], v2, s[36:39], s15 offen offset:2048 sc1
  s_bitset0_b32 s62, 6
  s_mov_b32 s63, 29999
  s_waitcnt vmcnt(6)
  v_max3_u32 v4, v172, v173, v174
  v_max_u32 v4, v4, v175
  v_cmp_eq_u32 vcc, -1, v4
  s_nop 0
  s_cbranch_vccz PH_J7
PH_E7:
  buffer_load_dwordx4 v[172:175], v2, s[36:39], s15 offen offset:3072 sc1
  s_bitset0_b32 s62, 7
  s_mov_b32 s63, 29999
  s_waitcnt vmcnt(5)
  v_max3_u32 v4, v184, v185, v186
  v_max_u32 v4, v4, v187
  v_cmp_eq_u32 vcc, -1, v4
  s_nop 0
  s_cbranch_vccz PH_J8
PH_E8:
  buffer_load_dwordx4 v[184:187], v2, s[36:39], s74 offen offset:0 sc1
  s_bitset0_b32 s62, 8
  s_mov_b32 s63, 29999
  s_waitcnt vmcnt(4)
  v_max3_u32 v4, v188, v189, v190
  v_max_u32 v4, v4, v191
  v_cmp_eq_u32 vcc, -1, v4
  s_nop 0
  s_cbranch_vccz PH_J9
PH_E9:
  buffer_load_dwordx4 v[188:191], v2, s[36:39], s74 offen offset:1024 sc1
  s_bitset0_b32 s62, 9
  s_mov_b32 s63, 29999
  s_waitcnt vmcnt(3)
  v_max3_u32 v4, v192, v193, v194
  v_max_u32 v4, v4, v195
  v_cmp_eq_u32 vcc, -1, v4
  s_nop 0
  s_cbranch_vccz PH_J10
PH_E10:
  buffer_load_dwordx4 v[192:195], v2, s[36:39], s74 offen offset:2048 sc1
  s_bitset0_b32 s62, 10
  s_mov_b32 s63, 29999
  s_waitcnt vmcnt(2)
  v_max3_u32 v4, v196, v197, v198
  v_max_u32 v4, v4, v199
  v_cmp_eq_u32 vcc, -1, v4
  s_nop 0
  s_cbranch_vccz PH_J11
PH_E11:
  buffer_load_dwordx4 v[196:199], v2, s[36:39], s74 offen offset:3072 sc1
  s_bitset0_b32 s62, 11
  s_mov_b32 s63, 29999
  s_waitcnt vmcnt(1)
  v_max3_u32 v4, v200, v201, v202
  v_max_u32 v4, v4, v203
  v_cmp_eq_u32 vcc, -1, v4
  s_nop 0
  s_cbranch_vccz PH_J12
PH_E12:
  buffer_load_dwordx4 v[200:203], v2, s[36:39], s75 offen offset:0 sc1
  s_bitset0_b32 s62, 12
  s_mov_b32 s63, 29999
  s_waitcnt vmcnt(0)
  v_max3_u32 v4, v204, v205, v206
  v_max_u32 v4, v4, v207
  v_cmp_eq_u32 vcc, -1, v4
  s_nop 0
  s_cbranch_vccz PH_J13
PH_E13:
  buffer_load_dwordx4 v[204:207], v2, s[36:39], s75 offen offset:1024 sc1
  s_bitset0_b32 s62, 13
  s_mov_b32 s63, 29999
PH_L:
PH_G0:
  s_andn2_b32 s10, 15, s62
  s_cbranch_scc0 PH_G4
  s_bitcmp1_b32 s62, 0
  s_cbranch_scc1 PH_S0
  s_waitcnt vmcnt(0)
  v_max3_u32 v4, v144, v145, v146
  v_max_u32 v4, v4, v147
  v_cmp_eq_u32 vcc, -1, v4
W41:
  s_cbranch_execz W43
  s_bitset1_b32 s62, 0
  s_nop 0
  s_cbranch_vccnz PH_R0
  ds_write_b128 v5, v[144:147] offset:0
  v_mfma_f32_4x4x4_16b_bf16 v[8:11], v[6:7], v[144:145], v[8:11]
  v_mfma_f32_4x4x4_16b_bf16 v[12:15], v[144:145], v[144:145], v[12:15]
  s_nop 0
  v_mfma_f32_4x4x4_16b_bf16 v[8:11], v[6:7], v[146:147], v[8:11]
  v_mfma_f32_4x4x4_16b_bf16 v[12:15], v[146:147], v[146:147], v[12:15]
PH_S0:
  s_bitcmp1_b32 s62, 1
  s_cbranch_scc1 PH_S1
  s_waitcnt vmcnt(0)
  v_max3_u32 v4, v148, v149, v150
  v_max_u32 v4, v4, v151
  v_cmp_eq_u32 vcc, -1, v4
  s_bitset1_b32 s62, 1
  s_nop 0
  s_cbranch_vccnz PH_R1
  ds_write_b128 v5, v[148:151] offset:1024
  v_mfma_f32_4x4x4_16b_bf16 v[8:11], v[6:7], v[148:149], v[8:11]
  v_mfma_f32_4x4x4_16b_bf16 v[12:15], v[148:149], v[148:149], v[12:15]
  s_nop 0
  v_mfma_f32_4x4x4_16b_bf16 v[8:11], v[6:7], v[150:151], v[8:11]
  v_mfma_f32_4x4x4_16b_bf16 v[12:15], v[150:151], v[150:151], v[12:15]
PH_S1:
  s_bitcmp1_b32 s62, 2
  s_cbranch_scc1 PH_S2
  s_waitcnt vmcnt(0)
  v_max3_u32 v4, v152, v153, v154
  v_max_u32 v4, v4, v155
  v_cmp_eq_u32 vcc, -1, v4
  s_bitset1_b32 s62, 2
  s_nop 0
  s_cbranch_vccnz PH_R2
  ds_write_b128 v5, v[152:155] offset:2048
  v_mfma_f32_4x4x4_16b_bf16 v[8:11], v[6:7], v[152:153], v[8:11]
  v_mfma_f32_4x4x4_16b_bf16 v[12:15], v[152:153], v[152:153], v[12:15]
  s_nop 0
  v_mfma_f32_4x4x4_16b_bf16 v[8:11], v[6:7], v[154:155], v[8:11]
  v_mfma_f32_4x4x4_16b_bf16 v[12:15], v[154:155], v[154:155], v[12:15]
PH_S2:
  s_bitcmp1_b32 s62, 3
  s_cbranch_scc1 PH_S3
  s_waitcnt vmcnt(0)
  v_max3_u32 v4, v156, v157, v158
  v_max_u32 v4, v4, v159
  v_cmp_eq_u32 vcc, -1, v4
  s_bitset1_b32 s62, 3
  s_nop 0
  s_cbranch_vccnz PH_R3
  ds_write_b128 v5, v[156:159] offset:3072
  v_mfma_f32_4x4x4_16b_bf16 v[8:11], v[6:7], v[156:157], v[8:11]
  v_mfma_f32_4x4x4_16b_bf16 v[12:15], v[156:157], v[156:157], v[12:15]
  s_nop 0
  v_mfma_f32_4x4x4_16b_bf16 v[8:11], v[6:7], v[158:159], v[8:11]
  v_mfma_f32_4x4x4_16b_bf16 v[12:15], v[158:159], v[158:159], v[12:15]
PH_S3:
PH_G4:
  s_andn2_b32 s10, 240, s62
  s_cbranch_scc0 PH_G8
  s_bitcmp1_b32 s62, 4
  s_cbranch_scc1 PH_S4
  s_waitcnt vmcnt(0)
  v_max3_u32 v4, v160, v161, v162
  v_max_u32 v4, v4, v163
  v_cmp_eq_u32 vcc, -1, v4
  s_bitset1_b32 s62, 4
  s_nop 0
  s_cbranch_vccnz PH_R4
  ds_write_b128 v5, v[160:163] offset:4096
  v_mfma_f32_4x4x4_16b_bf16 v[8:11], v[6:7], v[160:161], v[8:11]
  v_mfma_f32_4x4x4_16b_bf16 v[12:15], v[160:161], v[160:161], v[12:15]
  s_nop 0
  v_mfma_f32_4x4x4_16b_bf16 v[8:11], v[6:7], v[162:163], v[8:11]
  v_mfma_f32_4x4x4_16b_bf16 v[12:15], v[162:163], v[162:163], v[12:15]
PH_S4:
  s_bitcmp1_b32 s62, 5
  s_cbranch_scc1 PH_S5
  s_waitcnt vmcnt(0)
  v_max3_u32 v4, v164, v165, v166
  v_max_u32 v4, v4, v167
  v_cmp_eq_u32 vcc, -1, v4
  s_bitset1_b32 s62, 5
  s_nop 0
  s_cbranch_vccnz PH_R5
  ds_write_b128 v5, v[164:167] offset:5120
  v_mfma_f32_4x4x4_16b_bf16 v[8:11], v[6:7], v[164:165], v[8:11]
  v_mfma_f32_4x4x4_16b_bf16 v[12:15], v[164:165], v[164:165], v[12:15]
  s_nop 0
  v_mfma_f32_4x4x4_16b_bf16 v[8:11], v[6:7], v[166:167], v[8:11]
  v_mfma_f32_4x4x4_16b_bf16 v[12:15], v[166:167], v[166:167], v[12:15]
PH_S5:
  s_bitcmp1_b32 s62, 6
  s_cbranch_scc1 PH_S6
  s_waitcnt vmcnt(0)
  v_max3_u32 v4, v168, v169, v170
  v_max_u32 v4, v4, v171
  v_cmp_eq_u32 vcc, -1, v4
  s_bitset1_b32 s62, 6
  s_nop 0
  s_cbranch_vccnz PH_R6
  ds_write_b128 v5, v[168:171] offset:6144
  v_mfma_f32_4x4x4_16b_bf16 v[8:11], v[6:7], v[168:169], v[8:11]
  v_mfma_f32_4x4x4_16b_bf16 v[12:15], v[168:169], v[168:169], v[12:15]
  s_nop 0
  v_mfma_f32_4x4x4_16b_bf16 v[8:11], v[6:7], v[170:171], v[8:11]
  v_mfma_f32_4x4x4_16b_bf16 v[12:15], v[170:171], v[170:171], v[12:15]
PH_S6:
  s_bitcmp1_b32 s62, 7
  s_cbranch_scc1 PH_S7
  s_waitcnt vmcnt(0)
  v_max3_u32 v4, v172, v173, v174
  v_max_u32 v4, v4, v175
  v_cmp_eq_u32 vcc, -1, v4
  s_bitset1_b32 s62, 7
  s_nop 0
  s_cbranch_vccnz PH_R7
  ds_write_b128 v5, v[172:175] offset:7168
  v_mfma_f32_4x4x4_16b_bf16 v[8:11], v[6:7], v[172:173], v[8:11]
  v_mfma_f32_4x4x4_16b_bf16 v[12:15], v[172:173], v[172:173], v[12:15]
  s_nop 0
  v_mfma_f32_4x4x4_16b_bf16 v[8:11], v[6:7], v[174:175], v[8:11]
  v_mfma_f32_4x4x4_16b_bf16 v[12:15], v[174:175], v[174:175], v[12:15]
PH_S7:
PH_G8:
  s_andn2_b32 s10, 3840, s62
  s_cbranch_scc0 PH_G12
  s_bitcmp1_b32 s62, 8
  s_cbranch_scc1 PH_S8
  s_waitcnt vmcnt(0)
  v_max3_u32 v4, v184, v185, v186
  v_max_u32 v4, v4, v187
  v_cmp_eq_u32 vcc, -1, v4
  s_bitset1_b32 s62, 8
  s_nop 0
  s_cbranch_vccnz PH_R8
  ds_write_b128 v5, v[184:187] offset:8192
  v_mfma_f32_4x4x4_16b_bf16 v[8:11], v[6:7], v[184:185], v[8:11]
  v_mfma_f32_4x4x4_16b_bf16 v[12:15], v[184:185], v[184:185], v[12:15]
  s_nop 0
  v_mfma_f32_4x4x4_16b_bf16 v[8:11], v[6:7], v[186:187], v[8:11]
  v_mfma_f32_4x4x4_16b_bf16 v[12:15], v[186:187], v[186:187], v[12:15]
PH_S8:
  s_bitcmp1_b32 s62, 9
  s_cbranch_scc1 PH_S9
  s_waitcnt vmcnt(0)
  v_max3_u32 v4, v188, v189, v190
  v_max_u32 v4, v4, v191
  v_cmp_eq_u32 vcc, -1, v4
  s_bitset1_b32 s62, 9
  s_nop 0
  s_cbranch_vccnz PH_R9
  ds_write_b128 v5, v[188:191] offset:9216
  v_mfma_f32_4x4x4_16b_bf16 v[8:11], v[6:7], v[188:189], v[8:11]
  v_mfma_f32_4x4x4_16b_bf16 v[12:15], v[188:189], v[188:189], v[12:15]
  s_nop 0
  v_mfma_f32_4x4x4_16b_bf16 v[8:11], v[6:7], v[190:191], v[8:11]
  v_mfma_f32_4x4x4_16b_bf16 v[12:15], v[190:191], v[190:191], v[12:15]
PH_S9:
  s_bitcmp1_b32 s62, 10
  s_cbranch_scc1 PH_S10
  s_waitcnt vmcnt(0)
  v_max3_u32 v4, v192, v193, v194
  v_max_u32 v4, v4, v195
  v_cmp_eq_u32 vcc, -1, v4
  s_bitset1_b32 s62, 10
  s_nop 0
  s_cbranch_vccnz PH_R10
  ds_write_b128 v5, v[192:195] offset:10240
  v_mfma_f32_4x4x4_16b_bf16 v[8:11], v[6:7], v[192:193], v[8:11]
  v_mfma_f32_4x4x4_16b_bf16 v[12:15], v[192:193], v[192:193], v[12:15]
  s_nop 0
  v_mfma_f32_4x4x4_16b_bf16 v[8:11], v[6:7], v[194:195], v[8:11]
  v_mfma_f32_4x4x4_16b_bf16 v[12:15], v[194:195], v[194:195], v[12:15]
PH_S10:
  s_bitcmp1_b32 s62, 11
  s_cbranch_scc1 PH_S11
  s_waitcnt vmcnt(0)
  v_max3_u32 v4, v196, v197, v198
  v_max_u32 v4, v4, v199
  v_cmp_eq_u32 vcc, -1, v4
  s_bitset1_b32 s62, 11
  s_nop 0
  s_cbranch_vccnz PH_R11
  ds_write_b128 v5, v[196:199] offset:11264
  v_mfma_f32_4x4x4_16b_bf16 v[8:11], v[6:7], v[196:197], v[8:11]
  v_mfma_f32_4x4x4_16b_bf16 v[12:15], v[196:197], v[196:197], v[12:15]
  s_nop 0
  v_mfma_f32_4x4x4_16b_bf16 v[8:11], v[6:7], v[198:199], v[8:11]
  v_mfma_f32_4x4x4_16b_bf16 v[12:15], v[198:199], v[198:199], v[12:15]
PH_S11:
PH_G12:
  s_andn2_b32 s10, 12288, s62
  s_cbranch_scc0 PH_G14
  s_bitcmp1_b32 s62, 12
W42:
  s_cbranch_execz W44
  s_cbranch_scc1 PH_S12
  s_waitcnt vmcnt(0)
  v_max3_u32 v4, v200, v201, v202
  v_max_u32 v4, v4, v203
  v_cmp_eq_u32 vcc, -1, v4
  s_bitset1_b32 s62, 12
  s_nop 0
  s_cbranch_vccnz PH_R12
  ds_write_b128 v5, v[200:203] offset:12288
  v_mfma_f32_4x4x4_16b_bf16 v[8:11], v[6:7], v[200:201], v[8:11]
  v_mfma_f32_4x4x4_16b_bf16 v[12:15], v[200:201], v[200:201], v[12:15]
  s_nop 0
  v_mfma_f32_4x4x4_16b_bf16 v[8:11], v[6:7], v[202:203], v[8:11]
  v_mfma_f32_4x4x4_16b_bf16 v[12:15], v[202:203], v[202:203], v[12:15]
PH_S12:
  s_bitcmp1_b32 s62, 13
  s_cbranch_scc1 PH_S13
  s_waitcnt vmcnt(0)
  v_max3_u32 v4, v204, v205, v206
  v_max_u32 v4, v4, v207
  v_cmp_eq_u32 vcc, -1, v4
  s_bitset1_b32 s62, 13
  s_nop 0
  s_cbranch_vccnz PH_R13
  ds_write_b128 v5, v[204:207] offset:13312
  v_mfma_f32_4x4x4_16b_bf16 v[8:11], v[6:7], v[204:205], v[8:11]
  v_mfma_f32_4x4x4_16b_bf16 v[12:15], v[204:205], v[204:205], v[12:15]
  s_nop 0
  v_mfma_f32_4x4x4_16b_bf16 v[8:11], v[6:7], v[206:207], v[8:11]
  v_mfma_f32_4x4x4_16b_bf16 v[12:15], v[206:207], v[206:207], v[12:15]
PH_S13:
PH_G14:
  s_cmp_eq_u32 s62, 16383
  s_cbranch_scc1 PH_O
  s_waitcnt vmcnt(0)
  s_sub_u32 s63, s63, 1
  s_cmp_eq_u32 s63, 0
  s_cbranch_scc1 P_END
  s_branch PH_L
PH_R0:
  buffer_load_dwordx4 v[144:147], v2, s[36:39], s14 offen offset:0 sc1
  s_bitset0_b32 s62, 0
  s_branch PH_S0
PH_R1:
  buffer_load_dwordx4 v[148:151], v2, s[36:39], s14 offen offset:1024 sc1
  s_bitset0_b32 s62, 1
  s_branch PH_S1
PH_R2:
  buffer_load_dwordx4 v[152:155], v2, s[36:39], s14 offen offset:2048 sc1
  s_bitset0_b32 s62, 2
  s_branch PH_S2
PH_R3:
  buffer_load_dwordx4 v[156:159], v2, s[36:39], s14 offen offset:3072 sc1
  s_bitset0_b32 s62, 3
  s_branch PH_S3
PH_R4:
  buffer_load_dwordx4 v[160:163], v2, s[36:39], s15 offen offset:0 sc1
  s_bitset0_b32 s62, 4
  s_branch PH_S4
PH_R5:
  buffer_load_dwordx4 v[164:167], v2, s[36:39], s15 offen offset:1024 sc1
  s_bitset0_b32 s62, 5
  s_branch PH_S5
PH_R6:
  buffer_load_dwordx4 v[168:171], v2, s[36:39], s15 offen offset:2048 sc1
  s_bitset0_b32 s62, 6
  s_branch PH_S6
PH_R7:
  buffer_load_dwordx4 v[172:175], v2, s[36:39], s15 offen offset:3072 sc1
  s_bitset0_b32 s62, 7
  s_branch PH_S7
PH_R8:
  buffer_load_dwordx4 v[184:187], v2, s[36:39], s74 offen offset:0 sc1
  s_bitset0_b32 s62, 8
  s_branch PH_S8
PH_R9:
  buffer_load_dwordx4 v[188:191], v2, s[36:39], s74 offen offset:1024 sc1
  s_bitset0_b32 s62, 9
  s_branch PH_S9
PH_R10:
  buffer_load_dwordx4 v[192:195], v2, s[36:39], s74 offen offset:2048 sc1
  s_bitset0_b32 s62, 10
  s_branch PH_S10
PH_R11:
  buffer_load_dwordx4 v[196:199], v2, s[36:39], s74 offen offset:3072 sc1
  s_bitset0_b32 s62, 11
  s_branch PH_S11
PH_R12:
  buffer_load_dwordx4 v[200:203], v2, s[36:39], s75 offen offset:0 sc1
  s_bitset0_b32 s62, 12
  s_branch PH_S12
PH_R13:
  buffer_load_dwordx4 v[204:207], v2, s[36:39], s75 offen offset:1024 sc1
  s_bitset0_b32 s62, 13
  s_branch PH_S13
PO_E0:
  buffer_load_dwordx4 v[144:147], v2, s[36:39], s15 offen offset:0 sc1
  s_bitset0_b32 s62, 0
  s_mov_b32 s63, 29999
  s_waitcnt vmcnt(14)
  v_max3_u32 v4, v148, v149, v150
  v_max_u32 v4, v4, v151
  v_cmp_eq_u32 vcc, -1, v4
  s_add_u32 s9, s8, 0
  buffer_load_dwordx4 v[80:83], v2, s[36:39], s9 offen offset:0 sc1
  v_mov_b32 v48, 0
  v_mov_b32 v49, 0
  v_mov_b32 v50, 0
  v_mov_b32 v51, 0
  v_mov_b32 v52, 0
  v_mov_b32 v53, 0
  v_mov_b32 v54, 0
  v_mov_b32 v55, 0
  v_mov_b32 v56, 0
  v_mov_b32 v57, 0
  v_mov_b32 v58, 0
  v_mov_b32 v59, 0
  v_mov_b32 v60, 0
  v_mov_b32 v61, 0
  v_mov_b32 v62, 0
  v_mov_b32 v63, 0
  v_mov_b32 v64, 0
  v_mov_b32 v65, 0
  v_mov_b32 v66, 0
  v_mov_b32 v67, 0
  v_mov_b32 v68, 0
  v_mov_b32 v69, 0
  v_mov_b32 v70, 0
  v_mov_b32 v71, 0
  v_mov_b32 v72, 0
  v_mov_b32 v73, 0
  v_mov_b32 v74, 0
  v_mov_b32 v75, 0
  v_mov_b32 v76, 0
  v_mov_b32 v77, 0
  v_mov_b32 v78, 0
  v_mov_b32 v79, 0
  s_nop 0
  s_cbranch_vccz PO_J1
PO_E1:
  buffer_load_dwordx4 v[148:151], v2, s[36:39], s15 offen offset:1024 sc1
  s_bitset0_b32 s62, 1
  s_mov_b32 s63, 29999
  s_waitcnt vmcnt(14)
  v_max3_u32 v4, v152, v153, v154
  v_max_u32 v4, v4, v155
  v_cmp_eq_u32 vcc, -1, v4
  buffer_load_dwordx4 v[84:87], v2, s[36:39], s9 offen offset:1024 sc1
  s_nop 0
  s_cbranch_vccz PO_J2
PO_E2:
  buffer_load_dwordx4 v[152:155], v2, s[36:39], s15 offen offset:2048 sc1
  s_bitset0_b32 s62, 2
  s_mov_b32 s63, 29999
  s_waitcnt vmcnt(14)
  v_max3_u32 v4, v156, v157, v158
  v_max_u32 v4, v4, v159
  v_cmp_eq_u32 vcc, -1, v4
  buffer_load_dwordx4 v[88:91], v2, s[36:39], s9 offen offset:2048 sc1
  s_nop 0
  s_cbranch_vccz PO_J3
PO_E3:
  buffer_load_dwordx4 v[156:159], v2, s[36:39], s15 offen offset:3072 sc1
  s_bitset0_b32 s62, 3
  s_mov_b32 s63, 29999
  s_waitcnt vmcnt(14)
  v_max3_u32 v4, v160, v161, v162
  v_max_u32 v4, v4, v163
  v_cmp_eq_u32 vcc, -1, v4
  buffer_load_dwordx4 v[92:95], v2, s[36:39], s9 offen offset:3072 sc1
  s_nop 0
  s_cbranch_vccz PO_J4
PO_E4:
  buffer_load_dwordx4 v[160:163], v2, s[36:39], s75 offen offset:0 sc1
  s_bitset0_b32 s62, 4
  s_mov_b32 s63, 29999
  s_waitcnt vmcnt(14)
  v_max3_u32 v4, v164, v165, v166
  v_max_u32 v4, v4, v167
  v_cmp_eq_u32 vcc, -1, v4
  s_add_u32 s9, s8, 4096
  buffer_load_dwordx4 v[96:99], v2, s[36:39], s9 offen offset:0 sc1
  s_nop 0
  s_cbranch_vccz PO_J5
PO_E5:
  buffer_load_dwordx4 v[164:167], v2, s[36:39], s75 offen offset:1024 sc1
  s_bitset0_b32 s62, 5
  s_mov_b32 s63, 29999
  s_waitcnt vmcnt(14)
  v_max3_u32 v4, v168, v169, v170
  v_max_u32 v4, v4, v171
  v_cmp_eq_u32 vcc, -1, v4
  buffer_load_dwordx4 v[100:103], v2, s[36:39], s9 offen offset:1024 sc1
  s_nop 0
  s_cbranch_vccz PO_J6
PO_E6:
  buffer_load_dwordx4 v[168:171], v2, s[36:39], s75 offen offset:2048 sc1
  s_bitset0_b32 s62, 6
  s_mov_b32 s63, 29999
  s_waitcnt vmcnt(14)
  v_max3_u32 v4, v172, v173, v174
  v_max_u32 v4, v4, v175
  v_cmp_eq_u32 vcc, -1, v4
  buffer_load_dwordx4 v[104:107], v2, s[36:39], s9 offen offset:2048 sc1
  s_nop 0
  s_cbranch_vccz PO_J7
PO_E7:
  buffer_load_dwordx4 v[172:175], v2, s[36:39], s75 offen offset:3072 sc1
  s_bitset0_b32 s62, 7
  s_mov_b32 s63, 29999
  s_waitcnt vmcnt(14)
  v_max3_u32 v4, v184, v185, v186
  v_max_u32 v4, v4, v187
  v_cmp_eq_u32 vcc, -1, v4
  buffer_load_dwordx4 v[108:111], v2, s[36:39], s9 offen offset:3072 sc1
  s_nop 0
  s_cbranch_vccz PO_J8
PO_E8:
  buffer_load_dwordx4 v[184:187], v2, s[36:39], s14 offen offset:0 sc1
  s_bitset0_b32 s62, 8
W43:
  s_cbranch_execz F_H2
  s_mov_b32 s63, 29999
  s_waitcnt vmcnt(14)
  v_max3_u32 v4, v188, v189, v190
  v_max_u32 v4, v4, v191
  v_cmp_eq_u32 vcc, -1, v4
  s_add_u32 s9, s8, 8192
  buffer_load_dwordx4 v[112:115], v2, s[36:39], s9 offen offset:0 sc1
  ds_write_b128 v10, v[48:51] offset:0
  v_mov_b32 v16, 0
  v_mov_b32 v17, 0
  v_mov_b32 v18, 0
  v_mov_b32 v19, 0
  v_mov_b32 v20, 0
  v_mov_b32 v21, 0
  v_mov_b32 v22, 0
  v_mov_b32 v23, 0
  v_mov_b32 v24, 0
  v_mov_b32 v25, 0
  v_mov_b32 v26, 0
  v_mov_b32 v27, 0
  v_mov_b32 v28, 0
  v_mov_b32 v29, 0
  v_mov_b32 v30, 0
  v_mov_b32 v31, 0
  v_mov_b32 v32, 0
  v_mov_b32 v33, 0
  v_mov_b32 v34, 0
  v_mov_b32 v35, 0
  v_mov_b32 v36, 0
  v_mov_b32 v37, 0
  v_mov_b32 v38, 0
  v_mov_b32 v39, 0
  v_mov_b32 v40, 0
  v_mov_b32 v41, 0
  v_mov_b32 v42, 0
  v_mov_b32 v43, 0
  v_mov_b32 v44, 0
  v_mov_b32 v45, 0
  v_mov_b32 v46, 0
  v_mov_b32 v47, 0
  s_nop 0
  s_cbranch_vccz PO_J9
PO_E9:
  buffer_load_dwordx4 v[188:191], v2, s[36:39], s14 offen offset:1024 sc1
  s_bitset0_b32 s62, 9
  s_mov_b32 s63, 29999
  s_waitcnt vmcnt(14)
  v_max3_u32 v4, v192, v193, v194
  v_max_u32 v4, v4, v195
  v_cmp_eq_u32 vcc, -1, v4
  buffer_load_dwordx4 v[116:119], v2, s[36:39], s9 offen offset:1024 sc1
  ds_write_b128 v10, v[52:55] offset:1024
  s_nop 0
  s_cbranch_vccz PO_J10
PO_E10:
  buffer_load_dwordx4 v[192:195], v2, s[36:39], s14 offen offset:2048 sc1
  s_bitset0_b32 s62, 10
  s_mov_b32 s63, 29999
  s_waitcnt vmcnt(14)
  v_max3_u32 v4, v196, v197, v198
  v_max_u32 v4, v4, v199
  v_cmp_eq_u32 vcc, -1, v4
  buffer_load_dwordx4 v[120:123], v2, s[36:39], s9 offen offset:2048 sc1
  ds_write_b128 v10, v[56:59] offset:2048
  s_nop 0
  s_cbranch_vccz PO_J11
PO_E11:
  buffer_load_dwordx4 v[196:199], v2, s[36:39], s14 offen offset:3072 sc1
  s_bitset0_b32 s62, 11
  s_mov_b32 s63, 29999
  s_waitcnt vmcnt(14)
  v_max3_u32 v4, v200, v201, v202
  v_max_u32 v4, v4, v203
  v_cmp_eq_u32 vcc, -1, v4
  buffer_load_dwordx4 v[124:127], v2, s[36:39], s9 offen offset:3072 sc1
  ds_write_b128 v10, v[60:63] offset:3072
  s_nop 0
  s_cbranch_vccz PO_J12
PO_E12:
  buffer_load_dwordx4 v[200:203], v2, s[36:39], s74 offen offset:0 sc1
  s_bitset0_b32 s62, 12
  s_mov_b32 s63, 29999
  s_waitcnt vmcnt(14)
  v_max3_u32 v4, v204, v205, v206
  v_max_u32 v4, v4, v207
  v_cmp_eq_u32 vcc, -1, v4
  s_add_u32 s9, s8, 12288
  buffer_load_dwordx4 v[128:131], v2, s[36:39], s9 offen offset:0 sc1
  ds_write_b128 v11, v[64:67] offset:0
  s_nop 0
  s_cbranch_vccz PO_J13
PO_E13:
  buffer_load_dwordx4 v[204:207], v2, s[36:39], s74 offen offset:1024 sc1
  s_bitset0_b32 s62, 13
  s_mov_b32 s63, 29999
  s_waitcnt vmcnt(14)
  v_max3_u32 v4, v216, v217, v218
  v_max_u32 v4, v4, v219
  v_cmp_eq_u32 vcc, -1, v4
  buffer_load_dwordx4 v[132:135], v2, s[36:39], s9 offen offset:1024 sc1
  ds_write_b128 v11, v[68:71] offset:1024
  s_nop 0
  s_cbranch_vccz PO_J14
PO_E14:
  buffer_load_dwordx4 v[216:219], v2, s[36:39], s74 offen offset:2048 sc1
  s_bitset0_b32 s62, 14
  s_mov_b32 s63, 29999
  s_waitcnt vmcnt(14)
  v_max3_u32 v4, v220, v221, v222
  v_max_u32 v4, v4, v223
  v_cmp_eq_u32 vcc, -1, v4
  buffer_load_dwordx4 v[136:139], v2, s[36:39], s9 offen offset:2048 sc1
  ds_write_b128 v11, v[72:75] offset:2048
  s_nop 0
  s_cbranch_vccz PO_J15
PO_E15:
  buffer_load_dwordx4 v[220:223], v2, s[36:39], s74 offen offset:3072 sc1
  s_bitset0_b32 s62, 15
  s_mov_b32 s63, 29999
  buffer_load_dwordx4 v[140:143], v2, s[36:39], s9 offen offset:3072 sc1
  ds_write_b128 v11, v[76:79] offset:3072
PO_L:
PO_G0:
  s_andn2_b32 s10, 15, s62
  s_cbranch_scc0 PO_G4
  s_bitcmp1_b32 s62, 0
  s_cbranch_scc1 PO_S0
  s_waitcnt vmcnt(16)
  v_max3_u32 v4, v144, v145, v146
  v_max_u32 v4, v4, v147
  v_cmp_eq_u32 vcc, -1, v4
  s_bitset1_b32 s62, 0
  s_nop 0
  s_cbranch_vccnz PO_R0
  v_mfma_f32_32x32x16_bf16 v[48:63], v[224:227], v[144:147], v[48:63]
  v_mfma_f32_32x32x16_bf16 v[64:79], a[232:235], v[144:147], v[64:79]
PO_S0:
  s_bitcmp1_b32 s62, 1
  s_cbranch_scc1 PO_S1
  s_waitcnt vmcnt(15)
  v_max3_u32 v4, v148, v149, v150
  v_max_u32 v4, v4, v151
  v_cmp_eq_u32 vcc, -1, v4
  s_bitset1_b32 s62, 1
  s_nop 0
  s_cbranch_vccnz PO_R1
  v_mfma_f32_32x32x16_bf16 v[48:63], v[228:231], v[148:151], v[48:63]
  v_mfma_f32_32x32x16_bf16 v[64:79], a[236:239], v[148:151], v[64:79]
PO_S1:
  s_bitcmp1_b32 s62, 2
  s_cbranch_scc1 PO_S2
  s_waitcnt vmcnt(14)
  v_max3_u32 v4, v152, v153, v154
  v_max_u32 v4, v4, v155
  v_cmp_eq_u32 vcc, -1, v4
  s_bitset1_b32 s62, 2
  s_nop 0
  s_cbranch_vccnz PO_R2
  v_mfma_f32_32x32x16_bf16 v[48:63], v[232:235], v[152:155], v[48:63]
  v_mfma_f32_32x32x16_bf16 v[64:79], a[240:243], v[152:155], v[64:79]
PO_S2:
  s_bitcmp1_b32 s62, 3
  s_cbranch_scc1 PO_S3
  s_waitcnt vmcnt(13)
  v_max3_u32 v4, v156, v157, v158
  v_max_u32 v4, v4, v159
  v_cmp_eq_u32 vcc, -1, v4
  s_bitset1_b32 s62, 3
  s_nop 0
  s_cbranch_vccnz PO_R3
  v_mfma_f32_32x32x16_bf16 v[48:63], v[236:239], v[156:159], v[48:63]
  v_mfma_f32_32x32x16_bf16 v[64:79], a[244:247], v[156:159], v[64:79]
PO_S3:
PO_G4:
  s_andn2_b32 s10, 240, s62
  s_cbranch_scc0 PO_G8
  s_bitcmp1_b32 s62, 4
  s_cbranch_scc1 PO_S4
  s_waitcnt vmcnt(12)
  v_max3_u32 v4, v160, v161, v162
  v_max_u32 v4, v4, v163
  v_cmp_eq_u32 vcc, -1, v4
  s_bitset1_b32 s62, 4
  s_nop 0
  s_cbranch_vccnz PO_R4
  v_mfma_f32_32x32x16_bf16 v[48:63], v[240:243], v[160:163], v[48:63]
  v_mfma_f32_32x32x16_bf16 v[64:79], a[248:251], v[160:163], v[64:79]
PO_S4:
  s_bitcmp1_b32 s62, 5
  s_cbranch_scc1 PO_S5
  s_waitcnt vmcnt(11)
  v_max3_u32 v4, v164, v165, v166
  v_max_u32 v4, v4, v167
  v_cmp_eq_u32 vcc, -1, v4
  s_bitset1_b32 s62, 5
  s_nop 0
  s_cbranch_vccnz PO_R5
  v_mfma_f32_32x32x16_bf16 v[48:63], v[244:247], v[164:167], v[48:63]
  v_mfma_f32_32x32x16_bf16 v[64:79], a[252:255], v[164:167], v[64:79]
PO_S5:
  s_bitcmp1_b32 s62, 6
  s_cbranch_scc1 PO_S6
  s_waitcnt vmcnt(10)
  v_max3_u32 v4, v168, v169, v170
  v_max_u32 v4, v4, v171
  v_cmp_eq_u32 vcc, -1, v4
  s_bitset1_b32 s62, 6
  s_nop 0
  s_cbranch_vccnz PO_R6
  v_mfma_f32_32x32x16_bf16 v[48:63], v[248:251], v[168:171], v[48:63]
W44:
  s_cbranch_execz F_H2
  v_mfma_f32_32x32x16_bf16 v[64:79], a[112:115], v[168:171], v[64:79]
PO_S6:
  s_bitcmp1_b32 s62, 7
  s_cbranch_scc1 PO_S7
  s_waitcnt vmcnt(9)
  v_max3_u32 v4, v172, v173, v174
  v_max_u32 v4, v4, v175
  v_cmp_eq_u32 vcc, -1, v4
  s_bitset1_b32 s62, 7
  s_nop 0
  s_cbranch_vccnz PO_R7
  v_mfma_f32_32x32x16_bf16 v[48:63], v[252:255], v[172:175], v[48:63]
  v_mfma_f32_32x32x16_bf16 v[64:79], a[228:231], v[172:175], v[64:79]
PO_S7:
PO_G8:
  s_andn2_b32 s10, 3840, s62
  s_cbranch_scc0 PO_G12
  s_bitcmp1_b32 s62, 8
  s_cbranch_scc1 PO_S8
  s_waitcnt vmcnt(8)
  v_max3_u32 v4, v184, v185, v186
  v_max_u32 v4, v4, v187
  v_cmp_eq_u32 vcc, -1, v4
  s_bitset1_b32 s62, 8
  s_nop 0
  s_cbranch_vccnz PO_R8
  v_mfma_f32_32x32x16_bf16 v[32:47], a[232:235], v[184:187], v[32:47]
  v_mfma_f32_32x32x16_bf16 v[16:31], v[224:227], v[184:187], v[16:31]
PO_S8:
  s_bitcmp1_b32 s62, 9
  s_cbranch_scc1 PO_S9
  s_waitcnt vmcnt(7)
  v_max3_u32 v4, v188, v189, v190
  v_max_u32 v4, v4, v191
  v_cmp_eq_u32 vcc, -1, v4
  s_bitset1_b32 s62, 9
  s_nop 0
  s_cbranch_vccnz PO_R9
  v_mfma_f32_32x32x16_bf16 v[32:47], a[236:239], v[188:191], v[32:47]
  v_mfma_f32_32x32x16_bf16 v[16:31], v[228:231], v[188:191], v[16:31]
PO_S9:
  s_bitcmp1_b32 s62, 10
  s_cbranch_scc1 PO_S10
  s_waitcnt vmcnt(6)
  v_max3_u32 v4, v192, v193, v194
  v_max_u32 v4, v4, v195
  v_cmp_eq_u32 vcc, -1, v4
  s_bitset1_b32 s62, 10
  s_nop 0
  s_cbranch_vccnz PO_R10
  v_mfma_f32_32x32x16_bf16 v[32:47], a[240:243], v[192:195], v[32:47]
  v_mfma_f32_32x32x16_bf16 v[16:31], v[232:235], v[192:195], v[16:31]
PO_S10:
  s_bitcmp1_b32 s62, 11
  s_cbranch_scc1 PO_S11
  s_waitcnt vmcnt(5)
  v_max3_u32 v4, v196, v197, v198
  v_max_u32 v4, v4, v199
  v_cmp_eq_u32 vcc, -1, v4
  s_bitset1_b32 s62, 11
  s_nop 0
  s_cbranch_vccnz PO_R11
  v_mfma_f32_32x32x16_bf16 v[32:47], a[244:247], v[196:199], v[32:47]
  v_mfma_f32_32x32x16_bf16 v[16:31], v[236:239], v[196:199], v[16:31]
PO_S11:
PO_G12:
  s_andn2_b32 s10, 61440, s62
  s_cbranch_scc0 PO_G16
  s_bitcmp1_b32 s62, 12
  s_cbranch_scc1 PO_S12
  s_waitcnt vmcnt(4)
  v_max3_u32 v4, v200, v201, v202
  v_max_u32 v4, v4, v203
  v_cmp_eq_u32 vcc, -1, v4
  s_bitset1_b32 s62, 12
  s_nop 0
  s_cbranch_vccnz PO_R12
  v_mfma_f32_32x32x16_bf16 v[32:47], a[248:251], v[200:203], v[32:47]
  v_mfma_f32_32x32x16_bf16 v[16:31], v[240:243], v[200:203], v[16:31]
PO_S12:
  s_bitcmp1_b32 s62, 13
  s_cbranch_scc1 PO_S13
  s_waitcnt vmcnt(3)
  v_max3_u32 v4, v204, v205, v206
  v_max_u32 v4, v4, v207
  v_cmp_eq_u32 vcc, -1, v4
  s_bitset1_b32 s62, 13
  s_nop 0
  s_cbranch_vccnz PO_R13
  v_mfma_f32_32x32x16_bf16 v[32:47], a[252:255], v[204:207], v[32:47]
  v_mfma_f32_32x32x16_bf16 v[16:31], v[244:247], v[204:207], v[16:31]
PO_S13:
  s_bitcmp1_b32 s62, 14
  s_cbranch_scc1 PO_S14
  s_waitcnt vmcnt(2)
  v_max3_u32 v4, v216, v217, v218
  v_max_u32 v4, v4, v219
  v_cmp_eq_u32 vcc, -1, v4
  s_bitset1_b32 s62, 14
  s_nop 0
  s_cbranch_vccnz PO_R14
  v_mfma_f32_32x32x16_bf16 v[32:47], a[112:115], v[216:219], v[32:47]
  v_mfma_f32_32x32x16_bf16 v[16:31], v[248:251], v[216:219], v[16:31]
PO_S14:
  s_bitcmp1_b32 s62, 15
  s_cbranch_scc1 PO_S15
  s_waitcnt vmcnt(1)
  v_max3_u32 v4, v220, v221, v222
  v_max_u32 v4, v4, v223
  v_cmp_eq_u32 vcc, -1, v4
  s_bitset1_b32 s62, 15
  s_nop 0
  s_cbranch_vccnz PO_R15
  v_mfma_f32_32x32x16_bf16 v[32:47], a[228:231], v[220:223], v[32:47]
  v_mfma_f32_32x32x16_bf16 v[16:31], v[252:255], v[220:223], v[16:31]
PO_S15:
PO_G16:
  s_cmp_eq_u32 s62, 65535
  s_cbranch_scc1 PO_X
  s_waitcnt vmcnt(0)
  s_sub_u32 s63, s63, 1
  s_cmp_eq_u32 s63, 0
  s_cbranch_scc1 P_END
  s_branch PO_L
PO_R0:
  buffer_load_dwordx4 v[144:147], v2, s[36:39], s15 offen offset:0 sc1
  s_bitset0_b32 s62, 0
  s_branch PO_S0
PO_R1:
  buffer_load_dwordx4 v[148:151], v2, s[36:39], s15 offen offset:1024 sc1
  s_bitset0_b32 s62, 1
  s_branch PO_S1
PO_R2:
  buffer_load_dwordx4 v[152:155], v2, s[36:39], s15 offen offset:2048 sc1
  s_bitset0_b32 s62, 2
  s_branch PO_S2
PO_R3:
  buffer_load_dwordx4 v[156:159], v2, s[36:39], s15 offen offset:3072 sc1
  s_bitset0_b32 s62, 3
  s_branch PO_S3
PO_R4:
  buffer_load_dwordx4 v[160:163], v2, s[36:39], s75 offen offset:0 sc1
  s_bitset0_b32 s62, 4
  s_branch PO_S4
PO_R5:
  buffer_load_dwordx4 v[164:167], v2, s[36:39], s75 offen offset:1024 sc1
  s_bitset0_b32 s62, 5
  s_branch PO_S5
PO_R6:
  buffer_load_dwordx4 v[168:171], v2, s[36:39], s75 offen offset:2048 sc1
  s_bitset0_b32 s62, 6
  s_branch PO_S6
PO_R7:
  buffer_load_dwordx4 v[172:175], v2, s[36:39], s75 offen offset:3072 sc1
  s_bitset0_b32 s62, 7
  s_branch PO_S7
PO_R8:
  buffer_load_dwordx4 v[184:187], v2, s[36:39], s14 offen offset:0 sc1
  s_bitset0_b32 s62, 8
  s_branch PO_S8
PO_R9:
  buffer_load_dwordx4 v[188:191], v2, s[36:39], s14 offen offset:1024 sc1
  s_bitset0_b32 s62, 9
  s_branch PO_S9
PO_R10:
  buffer_load_dwordx4 v[192:195], v2, s[36:39], s14 offen offset:2048 sc1
  s_bitset0_b32 s62, 10
  s_branch PO_S10
PO_R11:
  buffer_load_dwordx4 v[196:199], v2, s[36:39], s14 offen offset:3072 sc1
  s_bitset0_b32 s62, 11
  s_branch PO_S11
PO_R12:
  buffer_load_dwordx4 v[200:203], v2, s[36:39], s74 offen offset:0 sc1
  s_bitset0_b32 s62, 12
  s_branch PO_S12
PO_R13:
  buffer_load_dwordx4 v[204:207], v2, s[36:39], s74 offen offset:1024 sc1
  s_bitset0_b32 s62, 13
  s_branch PO_S13
PO_R14:
  buffer_load_dwordx4 v[216:219], v2, s[36:39], s74 offen offset:2048 sc1
  s_bitset0_b32 s62, 14
  s_branch PO_S14
PO_R15:
  buffer_load_dwordx4 v[220:223], v2, s[36:39], s74 offen offset:3072 sc1
  s_bitset0_b32 s62, 15
  s_branch PO_S15
PO_X:
  s_nop 7
  s_nop 3
  ds_write_b128 v10, v[48:51] offset:0
  ds_write_b128 v10, v[52:55] offset:1024
  ds_write_b128 v10, v[56:59] offset:2048
  ds_write_b128 v10, v[60:63] offset:3072
  ds_write_b128 v11, v[64:67] offset:0
  ds_write_b128 v11, v[68:71] offset:1024
  ds_write_b128 v11, v[72:75] offset:2048
  ds_write_b128 v11, v[76:79] offset:3072
  s_branch PO_O
P_COLDE:
CT_H:
  s_sleep 4
  v_bfe_u32 v0, v1, 2, 2
  v_xor_b32 v0, s3, v0
  v_lshl_add_u32 v0, v0, 10, v225
  buffer_load_dword v226, v0, s[36:39], 0 offen sc1
  s_sub_u32 s63, s63, 1
  s_cmp_eq_u32 s63, 0
  s_cbranch_scc1 P_END
  s_waitcnt vmcnt(0)
  v_cmp_eq_u32 vcc, -1, v226
  s_nop 1
  s_cbranch_vccnz CT_H
  s_branch CT_B
CK0_H:
  global_load_dwordx4 v[160:163], v8, s[18:19] sc1
  global_load_dwordx4 v[164:167], v8, s[18:19] offset:1024 sc1
  s_sub_u32 s63, s63, 1
  s_cmp_eq_u32 s63, 0
  s_cbranch_scc1 P_END
  s_waitcnt vmcnt(0)
  v_max_u32 v0, v160, v164
  v_cmp_eq_u32 vcc, -1, v0
  s_nop 1
  s_cbranch_vccnz CK0_H
  s_branch CK0_B
CV0_H:
  global_load_dwordx4 v[168:171], v8, s[20:21] sc1
  global_load_dwordx4 v[172:175], v8, s[20:21] offset:1024 sc1
  s_sub_u32 s63, s63, 1
  s_cmp_eq_u32 s63, 0
  s_cbranch_scc1 P_END
  s_waitcnt vmcnt(0)
  v_max_u32 v0, v168, v172
  v_cmp_eq_u32 vcc, -1, v0
  s_nop 1
  s_cbranch_vccnz CV0_H
  s_branch CV0_B
CK1_H:
  global_load_dwordx4 v[176:179], v9, s[18:19] sc1
  global_load_dwordx4 v[180:183], v9, s[18:19] offset:1024 sc1
  s_sub_u32 s63, s63, 1
  s_cmp_eq_u32 s63, 0
  s_cbranch_scc1 P_END
  s_waitcnt vmcnt(0)
  v_max_u32 v0, v176, v180
  v_cmp_eq_u32 vcc, -1, v0
  s_nop 1
  s_cbranch_vccnz CK1_H
  s_branch CK1_B
CU_H:
  s_sleep 4
  v_lshrrev_b32 v0, 2, v1
  v_lshl_add_u32 v0, v0, 10, v225
  buffer_load_dword v224, v0, s[36:39], 0 offen sc1
  s_sub_u32 s63, s63, 1
  s_cmp_eq_u32 s63, 0
  s_cbranch_scc1 P_END
  s_waitcnt vmcnt(0)
  v_cmp_eq_u32 vcc, -1, v224
  s_nop 1
  s_cbranch_vccnz CU_H
  s_branch CU_B
CV1_H:
  global_load_dwordx4 v[184:187], v9, s[20:21] sc1
  global_load_dwordx4 v[188:191], v9, s[20:21] offset:1024 sc1
  s_sub_u32 s63, s63, 1
  s_cmp_eq_u32 s63, 0
  s_cbranch_scc1 P_END
  s_waitcnt vmcnt(0)
  v_max_u32 v0, v184, v188
  v_cmp_eq_u32 vcc, -1, v0
  s_nop 1
  s_cbranch_vccnz CV1_H
  s_branch CV1_B
CK2_H:
  global_load_dwordx4 v[192:195], v10, s[18:19] sc1
  global_load_dwordx4 v[196:199], v10, s[18:19] offset:1024 sc1
  s_sub_u32 s63, s63, 1
  s_cmp_eq_u32 s63, 0
  s_cbranch_scc1 P_END
  s_waitcnt vmcnt(0)
  v_max_u32 v0, v192, v196
  v_cmp_eq_u32 vcc, -1, v0
  s_nop 1
  s_cbranch_vccnz CK2_H
  s_branch CK2_B
CV2_H:
  global_load_dwordx4 v[200:203], v10, s[20:21] sc1
  global_load_dwordx4 v[204:207], v10, s[20:21] offset:1024 sc1
  s_sub_u32 s63, s63, 1
  s_cmp_eq_u32 s63, 0
  s_cbranch_scc1 P_END
  s_waitcnt vmcnt(0)
  v_max_u32 v0, v200, v204
  v_cmp_eq_u32 vcc, -1, v0
  s_nop 1
  s_cbranch_vccnz CV2_H
  s_branch CV2_B
CK3_H:
  global_load_dwordx4 v[208:211], v11, s[18:19] sc1
  global_load_dwordx4 v[212:215], v11, s[18:19] offset:1024 sc1
  s_sub_u32 s63, s63, 1
  s_cmp_eq_u32 s63, 0
  s_cbranch_scc1 P_END
  s_waitcnt vmcnt(0)
  v_max_u32 v0, v208, v212
  v_cmp_eq_u32 vcc, -1, v0
  s_nop 1
  s_cbranch_vccnz CK3_H
  s_branch CK3_B
CV3_H:
  global_load_dwordx4 v[216:219], v11, s[20:21] sc1
  global_load_dwordx4 v[220:223], v11, s[20:21] offset:1024 sc1
  s_sub_u32 s63, s63, 1
  s_cmp_eq_u32 s63, 0
  s_cbranch_scc1 P_END
  s_waitcnt vmcnt(0)
  v_max_u32 v0, v216, v220
  v_cmp_eq_u32 vcc, -1, v0
  s_nop 1
  s_cbranch_vccnz CV3_H
  s_branch CV3_B
CK4_H:
  global_load_dwordx4 v[160:163], v8, s[22:23] sc1
  global_load_dwordx4 v[164:167], v8, s[22:23] offset:1024 sc1
  s_sub_u32 s63, s63, 1
  s_cmp_eq_u32 s63, 0
  s_cbranch_scc1 P_END
  s_waitcnt vmcnt(0)
  v_max_u32 v0, v160, v164
  v_cmp_eq_u32 vcc, -1, v0
  s_nop 1
  s_cbranch_vccnz CK4_H
  s_branch CK4_B
CV4_H:
  global_load_dwordx4 v[168:171], v8, s[24:25] sc1
  global_load_dwordx4 v[172:175], v8, s[24:25] offset:1024 sc1
  s_sub_u32 s63, s63, 1
  s_cmp_eq_u32 s63, 0
  s_cbranch_scc1 P_END
  s_waitcnt vmcnt(0)
  v_max_u32 v0, v168, v172
  v_cmp_eq_u32 vcc, -1, v0
  s_nop 1
  s_cbranch_vccnz CV4_H
  s_branch CV4_B
CK5_H:
  global_load_dwordx4 v[176:179], v9, s[22:23] sc1
  global_load_dwordx4 v[180:183], v9, s[22:23] offset:1024 sc1
  s_sub_u32 s63, s63, 1
  s_cmp_eq_u32 s63, 0
  s_cbranch_scc1 P_END
  s_waitcnt vmcnt(0)
  v_max_u32 v0, v176, v180
  v_cmp_eq_u32 vcc, -1, v0
  s_nop 1
  s_cbranch_vccnz CK5_H
  s_branch CK5_B
CV5_H:
  global_load_dwordx4 v[184:187], v9, s[24:25] sc1
  global_load_dwordx4 v[188:191], v9, s[24:25] offset:1024 sc1
  s_sub_u32 s63, s63, 1
  s_cmp_eq_u32 s63, 0
  s_cbranch_scc1 P_END
  s_waitcnt vmcnt(0)
  v_max_u32 v0, v184, v188
  v_cmp_eq_u32 vcc, -1, v0
  s_nop 1
  s_cbranch_vccnz CV5_H
  s_branch CV5_B
CK6_H:
  global_load_dwordx4 v[192:195], v10, s[22:23] sc1
  global_load_dwordx4 v[196:199], v10, s[22:23] offset:1024 sc1
  s_sub_u32 s63, s63, 1
  s_cmp_eq_u32 s63, 0
  s_cbranch_scc1 P_END
  s_waitcnt vmcnt(0)
  v_max_u32 v0, v192, v196
  v_cmp_eq_u32 vcc, -1, v0
  s_nop 1
  s_cbranch_vccnz CK6_H
  s_branch CK6_B
CV6_H:
  global_load_dwordx4 v[200:203], v10, s[24:25] sc1
  global_load_dwordx4 v[204:207], v10, s[24:25] offset:1024 sc1
  s_sub_u32 s63, s63, 1
  s_cmp_eq_u32 s63, 0
  s_cbranch_scc1 P_END
  s_waitcnt vmcnt(0)
  v_max_u32 v0, v200, v204
  v_cmp_eq_u32 vcc, -1, v0
  s_nop 1
  s_cbranch_vccnz CV6_H
  s_branch CV6_B
CK7_H:
  global_load_dwordx4 v[208:211], v11, s[22:23] sc1
  global_load_dwordx4 v[212:215], v11, s[22:23] offset:1024 sc1
  s_sub_u32 s63, s63, 1
  s_cmp_eq_u32 s63, 0
  s_cbranch_scc1 P_END
  s_waitcnt vmcnt(0)
  v_max_u32 v0, v208, v212
  v_cmp_eq_u32 vcc, -1, v0
  s_nop 1
  s_cbranch_vccnz CK7_H
  s_branch CK7_B
CV7_H:
  global_load_dwordx4 v[216:219], v11, s[24:25] sc1
  global_load_dwordx4 v[220:223], v11, s[24:25] offset:1024 sc1
  s_sub_u32 s63, s63, 1
  s_cmp_eq_u32 s63, 0
  s_cbranch_scc1 P_END
  s_waitcnt vmcnt(0)
  v_max_u32 v0, v216, v220
  v_cmp_eq_u32 vcc, -1, v0
  s_nop 1
  s_cbranch_vccnz CV7_H
  s_branch CV7_B
CFCK_H:
  s_sleep 4
  v_min_u32 v0, 19, v1
  v_lshlrev_b32 v0, 7, v0
  buffer_load_dword v15, v0, s[36:39], s101 offen sc1
  s_sub_u32 s63, s63, 1
  s_cmp_eq_u32 s63, 0
  s_cbranch_scc1 P_END
  s_waitcnt vmcnt(0)
  v_cmp_eq_u32 vcc, -1, v15
  s_nop 1
  s_cbranch_vccnz CFCK_H
  s_branch CFCK_B
CK8_H:
  global_load_dwordx4 v[160:163], v8, s[26:27] sc1
  global_load_dwordx4 v[164:167], v8, s[26:27] offset:1024 sc1
  s_sub_u32 s63, s63, 1
  s_cmp_eq_u32 s63, 0
  s_cbranch_scc1 P_END
  s_waitcnt vmcnt(0)
  v_max_u32 v0, v160, v164
  v_cmp_eq_u32 vcc, -1, v0
  s_nop 1
  s_cbranch_vccnz CK8_H
  s_branch CK8_B
CV8_H:
  global_load_dwordx4 v[168:171], v8, s[34:35] sc1
  global_load_dwordx4 v[172:175], v8, s[34:35] offset:1024 sc1
  s_sub_u32 s63, s63, 1
  s_cmp_eq_u32 s63, 0
  s_cbranch_scc1 P_END
  s_waitcnt vmcnt(0)
  v_max_u32 v0, v168, v172
  v_cmp_eq_u32 vcc, -1, v0
  s_nop 1
  s_cbranch_vccnz CV8_H
  s_branch CV8_B
CK9_H:
  global_load_dwordx4 v[176:179], v9, s[26:27] sc1
  global_load_dwordx4 v[180:183], v9, s[26:27] offset:1024 sc1
  s_sub_u32 s63, s63, 1
  s_cmp_eq_u32 s63, 0
  s_cbranch_scc1 P_END
  s_waitcnt vmcnt(0)
  v_max_u32 v0, v176, v180
  v_cmp_eq_u32 vcc, -1, v0
  s_nop 1
  s_cbranch_vccnz CK9_H
  s_branch CK9_B
CV9_H:
  global_load_dwordx4 v[184:187], v9, s[34:35] sc1
  global_load_dwordx4 v[188:191], v9, s[34:35] offset:1024 sc1
  s_sub_u32 s63, s63, 1
  s_cmp_eq_u32 s63, 0
  s_cbranch_scc1 P_END
  s_waitcnt vmcnt(0)
  v_max_u32 v0, v184, v188
  v_cmp_eq_u32 vcc, -1, v0
  s_nop 1
  s_cbranch_vccnz CV9_H
  s_branch CV9_B
CK10_H:
  global_load_dwordx4 v[192:195], v10, s[26:27] sc1
  global_load_dwordx4 v[196:199], v10, s[26:27] offset:1024 sc1
  s_sub_u32 s63, s63, 1
  s_cmp_eq_u32 s63, 0
  s_cbranch_scc1 P_END
  s_waitcnt vmcnt(0)
  v_max_u32 v0, v192, v196
  v_cmp_eq_u32 vcc, -1, v0
  s_nop 1
  s_cbranch_vccnz CK10_H
  s_branch CK10_B
CV10_H:
  global_load_dwordx4 v[200:203], v10, s[34:35] sc1
  global_load_dwordx4 v[204:207], v10, s[34:35] offset:1024 sc1
  s_sub_u32 s63, s63, 1
  s_cmp_eq_u32 s63, 0
  s_cbranch_scc1 P_END
  s_waitcnt vmcnt(0)
  v_max_u32 v0, v200, v204
  v_cmp_eq_u32 vcc, -1, v0
  s_nop 1
  s_cbranch_vccnz CV10_H
  s_branch CV10_B
CK11_H:
  global_load_dwordx4 v[208:211], v11, s[26:27] sc1
  global_load_dwordx4 v[212:215], v11, s[26:27] offset:1024 sc1
  s_sub_u32 s63, s63, 1
  s_cmp_eq_u32 s63, 0
  s_cbranch_scc1 P_END
  s_waitcnt vmcnt(0)
  v_max_u32 v0, v208, v212
  v_cmp_eq_u32 vcc, -1, v0
  s_nop 1
  s_cbranch_vccnz CK11_H
  s_branch CK11_B
CV11_H:
  global_load_dwordx4 v[216:219], v11, s[34:35] sc1
  global_load_dwordx4 v[220:223], v11, s[34:35] offset:1024 sc1
  s_sub_u32 s63, s63, 1
  s_cmp_eq_u32 s63, 0
  s_cbranch_scc1 P_END
  s_waitcnt vmcnt(0)
  v_max_u32 v0, v216, v220
  v_cmp_eq_u32 vcc, -1, v0
  s_nop 1
  s_cbranch_vccnz CV11_H
  s_branch CV11_B
CK12_H:
  global_load_dwordx4 v[160:163], v8, s[16:17] sc1
  global_load_dwordx4 v[164:167], v8, s[16:17] offset:1024 sc1
  s_sub_u32 s63, s63, 1
  s_cmp_eq_u32 s63, 0
  s_cbranch_scc1 P_END
  s_waitcnt vmcnt(0)
  v_max_u32 v0, v160, v164
  v_cmp_eq_u32 vcc, -1, v0
  s_nop 1
  s_cbranch_vccnz CK12_H
  s_branch CK12_B
CV12_H:
  global_load_dwordx4 v[168:171], v8, s[28:29] sc1
  global_load_dwordx4 v[172:175], v8, s[28:29] offset:1024 sc1
  s_sub_u32 s63, s63, 1
  s_cmp_eq_u32 s63, 0
  s_cbranch_scc1 P_END
  s_waitcnt vmcnt(0)
  v_max_u32 v0, v168, v172
  v_cmp_eq_u32 vcc, -1, v0
  s_nop 1
  s_cbranch_vccnz CV12_H
  s_branch CV12_B
CK13_H:
  global_load_dwordx4 v[176:179], v9, s[16:17] sc1
  global_load_dwordx4 v[180:183], v9, s[16:17] offset:1024 sc1
  s_sub_u32 s63, s63, 1
  s_cmp_eq_u32 s63, 0
  s_cbranch_scc1 P_END
  s_waitcnt vmcnt(0)
  v_max_u32 v0, v176, v180
  v_cmp_eq_u32 vcc, -1, v0
  s_nop 1
  s_cbranch_vccnz CK13_H
  s_branch CK13_B
CV13_H:
  global_load_dwordx4 v[184:187], v9, s[28:29] sc1
  global_load_dwordx4 v[188:191], v9, s[28:29] offset:1024 sc1
  s_sub_u32 s63, s63, 1
  s_cmp_eq_u32 s63, 0
  s_cbranch_scc1 P_END
  s_waitcnt vmcnt(0)
  v_max_u32 v0, v184, v188
  v_cmp_eq_u32 vcc, -1, v0
  s_nop 1
  s_cbranch_vccnz CV13_H
  s_branch CV13_B
CK14_H:
  global_load_dwordx4 v[192:195], v10, s[16:17] sc1
  global_load_dwordx4 v[196:199], v10, s[16:17] offset:1024 sc1
  s_sub_u32 s63, s63, 1
  s_cmp_eq_u32 s63, 0
  s_cbranch_scc1 P_END
  s_waitcnt vmcnt(0)
  v_max_u32 v0, v192, v196
  v_cmp_eq_u32 vcc, -1, v0
  s_nop 1
  s_cbranch_vccnz CK14_H
  s_branch CK14_B
CFCK2_H:
  s_sleep 4
  v_min_u32 v0, 13, v1
  v_lshlrev_b32 v0, 7, v0
  buffer_load_dword v15, v0, s[36:39], s101 offen offset:2560 sc1
  s_sub_u32 s63, s63, 1
  s_cmp_eq_u32 s63, 0
  s_cbranch_scc1 P_END
  s_waitcnt vmcnt(0)
  v_cmp_eq_u32 vcc, -1, v15
  s_nop 1
  s_cbranch_vccnz CFCK2_H
  s_branch CFCK2_B
CV14_H:
  global_load_dwordx4 v[200:203], v10, s[28:29] sc1
  global_load_dwordx4 v[204:207], v10, s[28:29] offset:1024 sc1
  s_sub_u32 s63, s63, 1
  s_cmp_eq_u32 s63, 0
  s_cbranch_scc1 P_END
  s_waitcnt vmcnt(0)
  v_max_u32 v0, v200, v204
  v_cmp_eq_u32 vcc, -1, v0
  s_nop 1
  s_cbranch_vccnz CV14_H
  s_branch CV14_B
CK15_H:
  global_load_dwordx4 v[208:211], v11, s[16:17] sc1
  global_load_dwordx4 v[212:215], v11, s[16:17] offset:1024 sc1
  s_sub_u32 s63, s63, 1
  s_cmp_eq_u32 s63, 0
  s_cbranch_scc1 P_END
  s_waitcnt vmcnt(0)
  v_max_u32 v0, v208, v212
  v_cmp_eq_u32 vcc, -1, v0
  s_nop 1
  s_cbranch_vccnz CK15_H
  s_branch CK15_B
CV15_H:
  global_load_dwordx4 v[216:219], v11, s[28:29] sc1
  global_load_dwordx4 v[220:223], v11, s[28:29] offset:1024 sc1
  s_sub_u32 s63, s63, 1
  s_cmp_eq_u32 s63, 0
  s_cbranch_scc1 P_END
  s_waitcnt vmcnt(0)
  v_max_u32 v0, v216, v220
  v_cmp_eq_u32 vcc, -1, v0
  s_nop 1
  s_cbranch_vccnz CV15_H
  s_branch CV15_B
P_EPI:
  v_mfma_f32_32x32x16_bf16 v[96:111], v[216:219], v[152:155], v[96:111]
  v_mfma_f32_32x32x16_bf16 v[96:111], v[220:223], v[156:159], v[96:111]
  s_mul_i32 s10, s4, 12288
  v_add_u32 v7, s10, v2
  s_nop 7
  ds_write_b128 v7, v[48:51] offset:0
  ds_write_b128 v7, v[52:55] offset:1024
  ds_write_b128 v7, v[56:59] offset:2048
  ds_write_b128 v7, v[60:63] offset:3072
  ds_write_b128 v7, v[64:67] offset:4096
  ds_write_b128 v7, v[68:71] offset:5120
  ds_write_b128 v7, v[72:75] offset:6144
  ds_write_b128 v7, v[76:79] offset:7168
  s_add_u32 s10, s4, 3
  s_and_b32 s10, s10, 3
  s_mul_i32 s10, s10, 12288
  v_add_u32 v4, s10, v2
  s_add_u32 s10, s4, 2
  s_and_b32 s10, s10, 3
  s_mul_i32 s10, s10, 12288
  s_add_u32 s10, s10, 4096
  v_add_u32 v5, s10, v2
  s_add_u32 s10, s4, 1
  s_and_b32 s10, s10, 3
  s_mul_i32 s10, s10, 12288
  s_add_u32 s10, s10, 8192
  v_add_u32 v6, s10, v2
  ds_write_b128 v7, v[80:83] offset:8192
  ds_write_b128 v7, v[84:87] offset:9216
  ds_write_b128 v7, v[88:91] offset:10240
  ds_write_b128 v7, v[92:95] offset:11264
  s_waitcnt lgkmcnt(0)
  s_branch P_EPI2
P_BAD:
  s_cmp_lg_u32 s12, 0
  s_cbranch_scc1 P_ST
  v_mov_b32 v6, 1
  s_branch P_NST
P_SCAN:
  s_mov_b32 s63, 30000
  s_waitcnt lgkmcnt(0)
  s_mov_b32 s12, 1
  s_mul_i32 s13, s7, 7
  s_lshr_b32 s13, s13, 1
  s_lshl_b32 s13, s13, 9
  s_mul_i32 s11, s4, 61440
  s_add_u32 s11, s11, s13
  s_add_u32 s11, s11, 2097152
  s_lshl_b32 s10, s7, 11
  s_sub_u32 s10, s10, s13
  s_add_u32 s10, s10, 28672
  v_add_u32 v3, s10, v2
  s_mov_b32 s8, s11
  s_mov_b32 s13, 16
  v_mov_b32 v8, 0xff800000
  v_mov_b32 v9, 0xff800000
  v_mov_b32 v10, 0xff800000
  v_mov_b32 v11, 0xff800000
P_SLOOP:
  buffer_load_dwordx4 v[160:163], v2, s[36:39], s8 offen sc1
  buffer_load_dwordx4 v[164:167], v2, s[36:39], s8 offen offset:1024 sc1
  buffer_load_dwordx4 v[168:171], v3, s[36:39], s8 offen sc1
  buffer_load_dwordx4 v[172:175], v3, s[36:39], s8 offen offset:1024 sc1
  s_sub_u32 s63, s63, 1
  s_cmp_eq_u32 s63, 0
  s_cbranch_scc1 P_END
  s_waitcnt vmcnt(0)
  v_max3_u32 v0, v160, v164, v168
  v_max_u32 v0, v0, v172
  v_cmp_eq_u32 vcc, -1, v0
  s_nop 1
  s_cbranch_vccnz P_SLOOP
  s_add_u32 s8, s8, 245760
  s_waitcnt vmcnt(0)
  v_mfma_f32_32x32x16_bf16 v[48:63], v[160:163], v[16:19], 0
  v_mfma_f32_32x32x16_bf16 v[48:63], v[164:167], v[20:23], v[48:63]
  v_mfma_f32_32x32x16_bf16 v[64:79], v[160:163], v[24:27], 0
  v_mfma_f32_32x32x16_bf16 v[64:79], v[164:167], v[28:31], v[64:79]
  v_mfma_f32_32x32x16_bf16 v[80:95], v[160:163], v[32:35], 0
  v_mfma_f32_32x32x16_bf16 v[80:95], v[164:167], v[36:39], v[80:95]
  v_mfma_f32_32x32x16_bf16 v[96:111], v[160:163], v[40:43], 0
  v_mfma_f32_32x32x16_bf16 v[96:111], v[164:167], v[44:47], v[96:111]
  s_nop 5
  v_max3_f32 v8, v8, v48, v49
  v_max3_f32 v8, v8, v50, v51
  v_max3_f32 v8, v8, v52, v53
  v_max3_f32 v8, v8, v54, v55
  v_max3_f32 v8, v8, v56, v57
  v_max3_f32 v8, v8, v58, v59
  v_max3_f32 v8, v8, v60, v61
  v_max3_f32 v8, v8, v62, v63
  v_max3_f32 v9, v9, v64, v65
  v_max3_f32 v9, v9, v66, v67
  v_max3_f32 v9, v9, v68, v69
  v_max3_f32 v9, v9, v70, v71
  v_max3_f32 v9, v9, v72, v73
  v_max3_f32 v9, v9, v74, v75
  v_max3_f32 v9, v9, v76, v77
  v_max3_f32 v9, v9, v78, v79
  v_max3_f32 v10, v10, v80, v81
  v_max3_f32 v10, v10, v82, v83
  v_max3_f32 v10, v10, v84, v85
  v_max3_f32 v10, v10, v86, v87
  v_max3_f32 v10, v10, v88, v89
  v_max3_f32 v10, v10, v90, v91
  v_max3_f32 v10, v10, v92, v93
  v_max3_f32 v10, v10, v94, v95
  v_max3_f32 v11, v11, v96, v97
  v_max3_f32 v11, v11, v98, v99
  v_max3_f32 v11, v11, v100, v101
  v_max3_f32 v11, v11, v102, v103
  v_max3_f32 v11, v11, v104, v105
  v_max3_f32 v11, v11, v106, v107
  v_max3_f32 v11, v11, v108, v109
  v_max3_f32 v11, v11, v110, v111
  s_sub_u32 s13, s13, 1
  s_cmp_lg_u32 s13, 0
  s_cbranch_scc1 P_SLOOP
  v_and_b32 v4, 31, v1
  v_lshlrev_b32 v4, 4, v4
  v_mov_b32 v12, v8
  s_nop 1
  v_permlane32_swap_b32 v8, v12
  v_max_f32 v8, v8, v12
  s_add_u32 s10, s4, 0
  s_and_b32 s10, s10, 3
  s_lshl_b32 s10, s10, 9
  s_add_u32 s10, s10, 61504
  v_add_u32 v112, s10, v4
  s_lshl_b32 s10, s4, 2
  v_add_u32 v5, s10, v112
  ds_write_b32 v5, v8
  v_mov_b32 v12, v9
  s_nop 1
  v_permlane32_swap_b32 v9, v12
  v_max_f32 v9, v9, v12
  s_add_u32 s10, s4, 1
  s_and_b32 s10, s10, 3
  s_lshl_b32 s10, s10, 9
  s_add_u32 s10, s10, 61504
  v_add_u32 v113, s10, v4
  s_lshl_b32 s10, s4, 2
  v_add_u32 v5, s10, v113
  ds_write_b32 v5, v9
  v_mov_b32 v12, v10
  s_nop 1
  v_permlane32_swap_b32 v10, v12
  v_max_f32 v10, v10, v12
  s_add_u32 s10, s4, 2
  s_and_b32 s10, s10, 3
  s_lshl_b32 s10, s10, 9
  s_add_u32 s10, s10, 61504
  v_add_u32 v114, s10, v4
  s_lshl_b32 s10, s4, 2
  v_add_u32 v5, s10, v114
  ds_write_b32 v5, v10
  v_mov_b32 v12, v11
  s_nop 1
  v_permlane32_swap_b32 v11, v12
  v_max_f32 v11, v11, v12
  s_add_u32 s10, s4, 3
  s_and_b32 s10, s10, 3
  s_lshl_b32 s10, s10, 9
  s_add_u32 s10, s10, 61504
  v_add_u32 v115, s10, v4
  s_lshl_b32 s10, s4, 2
  v_add_u32 v5, s10, v115
  ds_write_b32 v5, v11
  s_waitcnt lgkmcnt(0)
  s_barrier
  s_mov_b32 s15, 0x07060302
  ds_read_b128 v[48:51], v112
  ds_read_b128 v[52:55], v113
  ds_read_b128 v[56:59], v114
  ds_read_b128 v[60:63], v115
  s_waitcnt lgkmcnt(0)
  v_max3_f32 v48, v48, v49, v50
  v_max_f32 v8, v48, v51
  v_max3_f32 v52, v52, v53, v54
  v_max_f32 v9, v52, v55
  v_max3_f32 v56, v56, v57, v58
  v_max_f32 v10, v56, v59
  v_max3_f32 v60, v60, v61, v62
  v_max_f32 v11, v60, v63
  s_barrier
  s_add_u32 s46, s11, 3932160
  s_mov_b32 s8, s11
  buffer_load_dwordx4 v[160:163], v2, s[36:39], s8 offen sc1
  buffer_load_dwordx4 v[164:167], v2, s[36:39], s8 offen offset:1024 sc1
  buffer_load_dwordx4 v[168:171], v3, s[36:39], s8 offen sc1
  buffer_load_dwordx4 v[172:175], v3, s[36:39], s8 offen offset:1024 sc1
  s_add_u32 s8, s8, 245760
  s_cmp_eq_u32 s8, s46
  s_cselect_b32 s8, s11, s8
  buffer_load_dwordx4 v[176:179], v2, s[36:39], s8 offen sc1
  buffer_load_dwordx4 v[180:183], v2, s[36:39], s8 offen offset:1024 sc1
  buffer_load_dwordx4 v[184:187], v3, s[36:39], s8 offen sc1
  buffer_load_dwordx4 v[188:191], v3, s[36:39], s8 offen offset:1024 sc1
  s_add_u32 s8, s8, 245760
  s_cmp_eq_u32 s8, s46
  s_cselect_b32 s8, s11, s8
  buffer_load_dwordx4 v[192:195], v2, s[36:39], s8 offen sc1
  buffer_load_dwordx4 v[196:199], v2, s[36:39], s8 offen offset:1024 sc1
  buffer_load_dwordx4 v[200:203], v3, s[36:39], s8 offen sc1
  buffer_load_dwordx4 v[204:207], v3, s[36:39], s8 offen offset:1024 sc1
  s_add_u32 s8, s8, 245760
  s_cmp_eq_u32 s8, s46
  s_cselect_b32 s8, s11, s8
  v_mov_b32 v48, 0
  v_mov_b32 v49, 0
  v_mov_b32 v50, 0
  v_mov_b32 v51, 0
  v_mov_b32 v52, 0
  v_mov_b32 v53, 0
  v_mov_b32 v54, 0
  v_mov_b32 v55, 0
  v_mov_b32 v56, 0
  v_mov_b32 v57, 0
  v_mov_b32 v58, 0
  v_mov_b32 v59, 0
  v_mov_b32 v60, 0
  v_mov_b32 v61, 0
  v_mov_b32 v62, 0
  v_mov_b32 v63, 0
  v_mov_b32 v64, 0
  v_mov_b32 v65, 0
  v_mov_b32 v66, 0
  v_mov_b32 v67, 0
  v_mov_b32 v68, 0
  v_mov_b32 v69, 0
  v_mov_b32 v70, 0
  v_mov_b32 v71, 0
  v_mov_b32 v72, 0
  v_mov_b32 v73, 0
  v_mov_b32 v74, 0
  v_mov_b32 v75, 0
  v_mov_b32 v76, 0
  v_mov_b32 v77, 0
  v_mov_b32 v78, 0
  v_mov_b32 v79, 0
  v_mov_b32 v80, 0
  v_mov_b32 v81, 0
  v_mov_b32 v82, 0
  v_mov_b32 v83, 0
  v_mov_b32 v84, 0
  v_mov_b32 v85, 0
  v_mov_b32 v86, 0
  v_mov_b32 v87, 0
  v_mov_b32 v88, 0
  v_mov_b32 v89, 0
  v_mov_b32 v90, 0
  v_mov_b32 v91, 0
  v_mov_b32 v92, 0
  v_mov_b32 v93, 0
  v_mov_b32 v94, 0
  v_mov_b32 v95, 0
  v_mov_b32 v96, 0
  v_mov_b32 v97, 0
  v_mov_b32 v98, 0
  v_mov_b32 v99, 0
  v_mov_b32 v100, 0
  v_mov_b32 v101, 0
  v_mov_b32 v102, 0
  v_mov_b32 v103, 0
  v_mov_b32 v104, 0
  v_mov_b32 v105, 0
  v_mov_b32 v106, 0
  v_mov_b32 v107, 0
  v_mov_b32 v108, 0
  v_mov_b32 v109, 0
  v_mov_b32 v110, 0
  v_mov_b32 v111, 0
  v_mov_b32 v152, 0
  v_mov_b32 v153, 0
  v_mov_b32 v154, 0
  v_mov_b32 v155, 0
  v_mov_b32 v156, 0
  v_mov_b32 v157, 0
  v_mov_b32 v158, 0
  v_mov_b32 v159, 0
  v_mov_b32 v216, 0
  v_mov_b32 v217, 0
  v_mov_b32 v218, 0
  v_mov_b32 v219, 0
  v_mov_b32 v220, 0
  v_mov_b32 v221, 0
  v_mov_b32 v222, 0
  v_mov_b32 v223, 0
  s_mov_b32 s13, 4
  s_waitcnt vmcnt(10)
  v_mfma_f32_32x32x16_bf16 v[112:127], v[160:163], v[16:19], 0
  v_mfma_f32_32x32x16_bf16 v[112:127], v[164:167], v[20:23], v[112:127]
  s_nop 7
  s_nop 3
P_LOOP:
  v_mfma_f32_32x32x16_bf16 v[128:143], v[160:163], v[24:27], 0
  v_sub_f32 v112, v112, v8
  v_sub_f32 v113, v113, v8
  v_sub_f32 v114, v114, v8
  v_sub_f32 v115, v115, v8
  v_exp_f32 v112, v112
  v_exp_f32 v113, v113
  v_exp_f32 v114, v114
  v_exp_f32 v115, v115
  v_cvt_pk_bf16_f32 v144, v112, v113
  v_cvt_pk_bf16_f32 v145, v114, v115
  v_mfma_f32_32x32x16_bf16 v[128:143], v[164:167], v[28:31], v[128:143]
  v_sub_f32 v116, v116, v8
  v_sub_f32 v117, v117, v8
  v_sub_f32 v118, v118, v8
  v_sub_f32 v119, v119, v8
  v_exp_f32 v116, v116
  v_exp_f32 v117, v117
  v_exp_f32 v118, v118
  v_exp_f32 v119, v119
  v_cvt_pk_bf16_f32 v146, v116, v117
  v_cvt_pk_bf16_f32 v147, v118, v119
  v_mfma_f32_32x32x16_bf16 v[96:111], v[216:219], v[152:155], v[96:111]
  v_sub_f32 v120, v120, v8
  v_sub_f32 v121, v121, v8
  v_sub_f32 v122, v122, v8
  v_sub_f32 v123, v123, v8
  v_exp_f32 v120, v120
  v_exp_f32 v121, v121
  v_exp_f32 v122, v122
  v_exp_f32 v123, v123
  v_cvt_pk_bf16_f32 v148, v120, v121
  v_cvt_pk_bf16_f32 v149, v122, v123
  v_mfma_f32_32x32x16_bf16 v[96:111], v[220:223], v[156:159], v[96:111]
  v_sub_f32 v124, v124, v8
  v_sub_f32 v125, v125, v8
  v_sub_f32 v126, v126, v8
  v_sub_f32 v127, v127, v8
  v_exp_f32 v124, v124
  v_exp_f32 v125, v125
  v_exp_f32 v126, v126
  v_exp_f32 v127, v127
  v_cvt_pk_bf16_f32 v150, v124, v125
  v_cvt_pk_bf16_f32 v151, v126, v127
  v_mfma_f32_32x32x16_bf16 v[112:127], v[160:163], v[32:35], 0
  v_sub_f32 v128, v128, v9
  v_sub_f32 v129, v129, v9
  v_sub_f32 v130, v130, v9
  v_sub_f32 v131, v131, v9
  v_exp_f32 v128, v128
  v_exp_f32 v129, v129
  v_exp_f32 v130, v130
  v_exp_f32 v131, v131
  v_cvt_pk_bf16_f32 v152, v128, v129
  v_cvt_pk_bf16_f32 v153, v130, v131
  v_mfma_f32_32x32x16_bf16 v[112:127], v[164:167], v[36:39], v[112:127]
  v_sub_f32 v132, v132, v9
  v_sub_f32 v133, v133, v9
  v_sub_f32 v134, v134, v9
  v_sub_f32 v135, v135, v9
  v_exp_f32 v132, v132
  v_exp_f32 v133, v133
  v_exp_f32 v134, v134
  v_exp_f32 v135, v135
  v_cvt_pk_bf16_f32 v154, v132, v133
  v_cvt_pk_bf16_f32 v155, v134, v135
  s_waitcnt vmcnt(8)
  v_mfma_f32_32x32x16_bf16 v[48:63], v[168:171], v[144:147], v[48:63]
  v_sub_f32 v136, v136, v9
  v_sub_f32 v137, v137, v9
  v_sub_f32 v138, v138, v9
  v_sub_f32 v139, v139, v9
  v_exp_f32 v136, v136
  v_exp_f32 v137, v137
  v_exp_f32 v138, v138
  v_exp_f32 v139, v139
  v_cvt_pk_bf16_f32 v156, v136, v137
  v_cvt_pk_bf16_f32 v157, v138, v139
  v_mfma_f32_32x32x16_bf16 v[48:63], v[172:175], v[148:151], v[48:63]
  buffer_load_dwordx4 v[208:211], v2, s[36:39], s8 offen sc1
  buffer_load_dwordx4 v[212:215], v2, s[36:39], s8 offen offset:1024 sc1
  buffer_load_dwordx4 v[216:219], v3, s[36:39], s8 offen sc1
  buffer_load_dwordx4 v[220:223], v3, s[36:39], s8 offen offset:1024 sc1
  s_add_u32 s8, s8, 245760
  s_cmp_eq_u32 s8, s46
  s_cselect_b32 s8, s11, s8
  v_sub_f32 v140, v140, v9
  v_sub_f32 v141, v141, v9
  v_sub_f32 v142, v142, v9
  v_sub_f32 v143, v143, v9
  v_exp_f32 v140, v140
  v_exp_f32 v141, v141
  v_exp_f32 v142, v142
  v_exp_f32 v143, v143
  v_cvt_pk_bf16_f32 v158, v140, v141
  v_cvt_pk_bf16_f32 v159, v142, v143
  v_mfma_f32_32x32x16_bf16 v[128:143], v[160:163], v[40:43], 0
  v_sub_f32 v112, v112, v10
  v_sub_f32 v113, v113, v10
  v_sub_f32 v114, v114, v10
  v_sub_f32 v115, v115, v10
  v_exp_f32 v112, v112
  v_exp_f32 v113, v113
  v_exp_f32 v114, v114
  v_exp_f32 v115, v115
  v_cvt_pk_bf16_f32 v144, v112, v113
  v_cvt_pk_bf16_f32 v145, v114, v115
  v_mfma_f32_32x32x16_bf16 v[128:143], v[164:167], v[44:47], v[128:143]
  v_sub_f32 v116, v116, v10
  v_sub_f32 v117, v117, v10
  v_sub_f32 v118, v118, v10
  v_sub_f32 v119, v119, v10
  v_exp_f32 v116, v116
  v_exp_f32 v117, v117
  v_exp_f32 v118, v118
  v_exp_f32 v119, v119
  v_cvt_pk_bf16_f32 v146, v116, v117
  v_cvt_pk_bf16_f32 v147, v118, v119
  v_mfma_f32_32x32x16_bf16 v[64:79], v[168:171], v[152:155], v[64:79]
  v_sub_f32 v120, v120, v10
  v_sub_f32 v121, v121, v10
  v_sub_f32 v122, v122, v10
  v_sub_f32 v123, v123, v10
  v_exp_f32 v120, v120
  v_exp_f32 v121, v121
  v_exp_f32 v122, v122
  v_exp_f32 v123, v123
  v_cvt_pk_bf16_f32 v148, v120, v121
  v_cvt_pk_bf16_f32 v149, v122, v123
  v_mfma_f32_32x32x16_bf16 v[64:79], v[172:175], v[156:159], v[64:79]
  v_sub_f32 v124, v124, v10
  v_sub_f32 v125, v125, v10
  v_sub_f32 v126, v126, v10
  v_sub_f32 v127, v127, v10
  v_exp_f32 v124, v124
  v_exp_f32 v125, v125
  v_exp_f32 v126, v126
  v_exp_f32 v127, v127
  v_cvt_pk_bf16_f32 v150, v124, v125
  v_cvt_pk_bf16_f32 v151, v126, v127
  s_waitcnt vmcnt(10)
  v_mfma_f32_32x32x16_bf16 v[112:127], v[176:179], v[16:19], 0
  v_sub_f32 v128, v128, v11
  v_sub_f32 v129, v129, v11
  v_sub_f32 v130, v130, v11
  v_sub_f32 v131, v131, v11
  v_exp_f32 v128, v128
  v_exp_f32 v129, v129
  v_exp_f32 v130, v130
  v_exp_f32 v131, v131
  v_cvt_pk_bf16_f32 v152, v128, v129
  v_cvt_pk_bf16_f32 v153, v130, v131
  v_mfma_f32_32x32x16_bf16 v[112:127], v[180:183], v[20:23], v[112:127]
  v_sub_f32 v132, v132, v11
  v_sub_f32 v133, v133, v11
  v_sub_f32 v134, v134, v11
  v_sub_f32 v135, v135, v11
  v_exp_f32 v132, v132
  v_exp_f32 v133, v133
  v_exp_f32 v134, v134
  v_exp_f32 v135, v135
  v_cvt_pk_bf16_f32 v154, v132, v133
  v_cvt_pk_bf16_f32 v155, v134, v135
  v_mfma_f32_32x32x16_bf16 v[80:95], v[168:171], v[144:147], v[80:95]
  v_sub_f32 v136, v136, v11
  v_sub_f32 v137, v137, v11
  v_sub_f32 v138, v138, v11
  v_sub_f32 v139, v139, v11
  v_exp_f32 v136, v136
  v_exp_f32 v137, v137
  v_exp_f32 v138, v138
  v_exp_f32 v139, v139
  v_cvt_pk_bf16_f32 v156, v136, v137
  v_cvt_pk_bf16_f32 v157, v138, v139
  v_mfma_f32_32x32x16_bf16 v[80:95], v[172:175], v[148:151], v[80:95]
  v_sub_f32 v140, v140, v11
  v_sub_f32 v141, v141, v11
  v_sub_f32 v142, v142, v11
  v_sub_f32 v143, v143, v11
  v_exp_f32 v140, v140
  v_exp_f32 v141, v141
  v_exp_f32 v142, v142
  v_exp_f32 v143, v143
  v_cvt_pk_bf16_f32 v158, v140, v141
  v_cvt_pk_bf16_f32 v159, v142, v143
  v_mfma_f32_32x32x16_bf16 v[128:143], v[176:179], v[24:27], 0
  v_sub_f32 v112, v112, v8
  v_sub_f32 v113, v113, v8
  v_sub_f32 v114, v114, v8
  v_sub_f32 v115, v115, v8
  v_exp_f32 v112, v112
  v_exp_f32 v113, v113
  v_exp_f32 v114, v114
  v_exp_f32 v115, v115
  v_cvt_pk_bf16_f32 v144, v112, v113
  v_cvt_pk_bf16_f32 v145, v114, v115
  v_mfma_f32_32x32x16_bf16 v[128:143], v[180:183], v[28:31], v[128:143]
  v_sub_f32 v116, v116, v8
  v_sub_f32 v117, v117, v8
  v_sub_f32 v118, v118, v8
  v_sub_f32 v119, v119, v8
  v_exp_f32 v116, v116
  v_exp_f32 v117, v117
  v_exp_f32 v118, v118
  v_exp_f32 v119, v119
  v_cvt_pk_bf16_f32 v146, v116, v117
  v_cvt_pk_bf16_f32 v147, v118, v119
  v_mfma_f32_32x32x16_bf16 v[96:111], v[168:171], v[152:155], v[96:111]
  v_sub_f32 v120, v120, v8
  v_sub_f32 v121, v121, v8
  v_sub_f32 v122, v122, v8
  v_sub_f32 v123, v123, v8
  v_exp_f32 v120, v120
  v_exp_f32 v121, v121
  v_exp_f32 v122, v122
  v_exp_f32 v123, v123
  v_cvt_pk_bf16_f32 v148, v120, v121
  v_cvt_pk_bf16_f32 v149, v122, v123
  v_mfma_f32_32x32x16_bf16 v[96:111], v[172:175], v[156:159], v[96:111]
  v_sub_f32 v124, v124, v8
  v_sub_f32 v125, v125, v8
  v_sub_f32 v126, v126, v8
  v_sub_f32 v127, v127, v8
  v_exp_f32 v124, v124
  v_exp_f32 v125, v125
  v_exp_f32 v126, v126
  v_exp_f32 v127, v127
  v_cvt_pk_bf16_f32 v150, v124, v125
  v_cvt_pk_bf16_f32 v151, v126, v127
  v_mfma_f32_32x32x16_bf16 v[112:127], v[176:179], v[32:35], 0
  v_sub_f32 v128, v128, v9
  v_sub_f32 v129, v129, v9
  v_sub_f32 v130, v130, v9
  v_sub_f32 v131, v131, v9
  v_exp_f32 v128, v128
  v_exp_f32 v129, v129
  v_exp_f32 v130, v130
  v_exp_f32 v131, v131
  v_cvt_pk_bf16_f32 v152, v128, v129
  v_cvt_pk_bf16_f32 v153, v130, v131
  v_mfma_f32_32x32x16_bf16 v[112:127], v[180:183], v[36:39], v[112:127]
  v_sub_f32 v132, v132, v9
  v_sub_f32 v133, v133, v9
  v_sub_f32 v134, v134, v9
  v_sub_f32 v135, v135, v9
  v_exp_f32 v132, v132
  v_exp_f32 v133, v133
  v_exp_f32 v134, v134
  v_exp_f32 v135, v135
  v_cvt_pk_bf16_f32 v154, v132, v133
  v_cvt_pk_bf16_f32 v155, v134, v135
  s_waitcnt vmcnt(8)
  v_mfma_f32_32x32x16_bf16 v[48:63], v[184:187], v[144:147], v[48:63]
  v_sub_f32 v136, v136, v9
  v_sub_f32 v137, v137, v9
  v_sub_f32 v138, v138, v9
  v_sub_f32 v139, v139, v9
  v_exp_f32 v136, v136
  v_exp_f32 v137, v137
  v_exp_f32 v138, v138
  v_exp_f32 v139, v139
  v_cvt_pk_bf16_f32 v156, v136, v137
  v_cvt_pk_bf16_f32 v157, v138, v139
  v_mfma_f32_32x32x16_bf16 v[48:63], v[188:191], v[148:151], v[48:63]
  buffer_load_dwordx4 v[160:163], v2, s[36:39], s8 offen sc1
  buffer_load_dwordx4 v[164:167], v2, s[36:39], s8 offen offset:1024 sc1
  buffer_load_dwordx4 v[168:171], v3, s[36:39], s8 offen sc1
  buffer_load_dwordx4 v[172:175], v3, s[36:39], s8 offen offset:1024 sc1
  s_add_u32 s8, s8, 245760
  s_cmp_eq_u32 s8, s46
  s_cselect_b32 s8, s11, s8
  v_sub_f32 v140, v140, v9
  v_sub_f32 v141, v141, v9
  v_sub_f32 v142, v142, v9
  v_sub_f32 v143, v143, v9
  v_exp_f32 v140, v140
  v_exp_f32 v141, v141
  v_exp_f32 v142, v142
  v_exp_f32 v143, v143
  v_cvt_pk_bf16_f32 v158, v140, v141
  v_cvt_pk_bf16_f32 v159, v142, v143
  v_mfma_f32_32x32x16_bf16 v[128:143], v[176:179], v[40:43], 0
  v_sub_f32 v112, v112, v10
  v_sub_f32 v113, v113, v10
  v_sub_f32 v114, v114, v10
  v_sub_f32 v115, v115, v10
  v_exp_f32 v112, v112
  v_exp_f32 v113, v113
  v_exp_f32 v114, v114
  v_exp_f32 v115, v115
  v_cvt_pk_bf16_f32 v144, v112, v113
  v_cvt_pk_bf16_f32 v145, v114, v115
  v_mfma_f32_32x32x16_bf16 v[128:143], v[180:183], v[44:47], v[128:143]
  v_sub_f32 v116, v116, v10
  v_sub_f32 v117, v117, v10
  v_sub_f32 v118, v118, v10
  v_sub_f32 v119, v119, v10
  v_exp_f32 v116, v116
  v_exp_f32 v117, v117
  v_exp_f32 v118, v118
  v_exp_f32 v119, v119
  v_cvt_pk_bf16_f32 v146, v116, v117
  v_cvt_pk_bf16_f32 v147, v118, v119
  v_mfma_f32_32x32x16_bf16 v[64:79], v[184:187], v[152:155], v[64:79]
  v_sub_f32 v120, v120, v10
  v_sub_f32 v121, v121, v10
  v_sub_f32 v122, v122, v10
  v_sub_f32 v123, v123, v10
  v_exp_f32 v120, v120
  v_exp_f32 v121, v121
  v_exp_f32 v122, v122
  v_exp_f32 v123, v123
  v_cvt_pk_bf16_f32 v148, v120, v121
  v_cvt_pk_bf16_f32 v149, v122, v123
  v_mfma_f32_32x32x16_bf16 v[64:79], v[188:191], v[156:159], v[64:79]
  v_sub_f32 v124, v124, v10
  v_sub_f32 v125, v125, v10
  v_sub_f32 v126, v126, v10
  v_sub_f32 v127, v127, v10
  v_exp_f32 v124, v124
  v_exp_f32 v125, v125
  v_exp_f32 v126, v126
  v_exp_f32 v127, v127
  v_cvt_pk_bf16_f32 v150, v124, v125
  v_cvt_pk_bf16_f32 v151, v126, v127
  s_waitcnt vmcnt(10)
  v_mfma_f32_32x32x16_bf16 v[112:127], v[192:195], v[16:19], 0
  v_sub_f32 v128, v128, v11
  v_sub_f32 v129, v129, v11
  v_sub_f32 v130, v130, v11
  v_sub_f32 v131, v131, v11
  v_exp_f32 v128, v128
  v_exp_f32 v129, v129
  v_exp_f32 v130, v130
  v_exp_f32 v131, v131
  v_cvt_pk_bf16_f32 v152, v128, v129
  v_cvt_pk_bf16_f32 v153, v130, v131
  v_mfma_f32_32x32x16_bf16 v[112:127], v[196:199], v[20:23], v[112:127]
  v_sub_f32 v132, v132, v11
  v_sub_f32 v133, v133, v11
  v_sub_f32 v134, v134, v11
  v_sub_f32 v135, v135, v11
  v_exp_f32 v132, v132
  v_exp_f32 v133, v133
  v_exp_f32 v134, v134
  v_exp_f32 v135, v135
  v_cvt_pk_bf16_f32 v154, v132, v133
  v_cvt_pk_bf16_f32 v155, v134, v135
  v_mfma_f32_32x32x16_bf16 v[80:95], v[184:187], v[144:147], v[80:95]
  v_sub_f32 v136, v136, v11
  v_sub_f32 v137, v137, v11
  v_sub_f32 v138, v138, v11
  v_sub_f32 v139, v139, v11
  v_exp_f32 v136, v136
  v_exp_f32 v137, v137
  v_exp_f32 v138, v138
  v_exp_f32 v139, v139
  v_cvt_pk_bf16_f32 v156, v136, v137
  v_cvt_pk_bf16_f32 v157, v138, v139
  v_mfma_f32_32x32x16_bf16 v[80:95], v[188:191], v[148:151], v[80:95]
  v_sub_f32 v140, v140, v11
  v_sub_f32 v141, v141, v11
  v_sub_f32 v142, v142, v11
  v_sub_f32 v143, v143, v11
  v_exp_f32 v140, v140
  v_exp_f32 v141, v141
  v_exp_f32 v142, v142
  v_exp_f32 v143, v143
  v_cvt_pk_bf16_f32 v158, v140, v141
  v_cvt_pk_bf16_f32 v159, v142, v143
  v_mfma_f32_32x32x16_bf16 v[128:143], v[192:195], v[24:27], 0
  v_sub_f32 v112, v112, v8
  v_sub_f32 v113, v113, v8
  v_sub_f32 v114, v114, v8
  v_sub_f32 v115, v115, v8
  v_exp_f32 v112, v112
  v_exp_f32 v113, v113
  v_exp_f32 v114, v114
  v_exp_f32 v115, v115
  v_cvt_pk_bf16_f32 v144, v112, v113
  v_cvt_pk_bf16_f32 v145, v114, v115
  v_mfma_f32_32x32x16_bf16 v[128:143], v[196:199], v[28:31], v[128:143]
  v_sub_f32 v116, v116, v8
  v_sub_f32 v117, v117, v8
  v_sub_f32 v118, v118, v8
  v_sub_f32 v119, v119, v8
  v_exp_f32 v116, v116
  v_exp_f32 v117, v117
  v_exp_f32 v118, v118
  v_exp_f32 v119, v119
  v_cvt_pk_bf16_f32 v146, v116, v117
  v_cvt_pk_bf16_f32 v147, v118, v119
  v_mfma_f32_32x32x16_bf16 v[96:111], v[184:187], v[152:155], v[96:111]
  v_sub_f32 v120, v120, v8
  v_sub_f32 v121, v121, v8
  v_sub_f32 v122, v122, v8
  v_sub_f32 v123, v123, v8
  v_exp_f32 v120, v120
  v_exp_f32 v121, v121
  v_exp_f32 v122, v122
  v_exp_f32 v123, v123
  v_cvt_pk_bf16_f32 v148, v120, v121
  v_cvt_pk_bf16_f32 v149, v122, v123
  v_mfma_f32_32x32x16_bf16 v[96:111], v[188:191], v[156:159], v[96:111]
  v_sub_f32 v124, v124, v8
  v_sub_f32 v125, v125, v8
  v_sub_f32 v126, v126, v8
  v_sub_f32 v127, v127, v8
  v_exp_f32 v124, v124
  v_exp_f32 v125, v125
  v_exp_f32 v126, v126
  v_exp_f32 v127, v127
  v_cvt_pk_bf16_f32 v150, v124, v125
  v_cvt_pk_bf16_f32 v151, v126, v127
  v_mfma_f32_32x32x16_bf16 v[112:127], v[192:195], v[32:35], 0
  v_sub_f32 v128, v128, v9
  v_sub_f32 v129, v129, v9
  v_sub_f32 v130, v130, v9
  v_sub_f32 v131, v131, v9
  v_exp_f32 v128, v128
  v_exp_f32 v129, v129
  v_exp_f32 v130, v130
  v_exp_f32 v131, v131
  v_cvt_pk_bf16_f32 v152, v128, v129
  v_cvt_pk_bf16_f32 v153, v130, v131
  v_mfma_f32_32x32x16_bf16 v[112:127], v[196:199], v[36:39], v[112:127]
  v_sub_f32 v132, v132, v9
  v_sub_f32 v133, v133, v9
  v_sub_f32 v134, v134, v9
  v_sub_f32 v135, v135, v9
  v_exp_f32 v132, v132
  v_exp_f32 v133, v133
  v_exp_f32 v134, v134
  v_exp_f32 v135, v135
  v_cvt_pk_bf16_f32 v154, v132, v133
  v_cvt_pk_bf16_f32 v155, v134, v135
  s_waitcnt vmcnt(8)
  v_mfma_f32_32x32x16_bf16 v[48:63], v[200:203], v[144:147], v[48:63]
  v_sub_f32 v136, v136, v9
  v_sub_f32 v137, v137, v9
  v_sub_f32 v138, v138, v9
  v_sub_f32 v139, v139, v9
  v_exp_f32 v136, v136
  v_exp_f32 v137, v137
  v_exp_f32 v138, v138
  v_exp_f32 v139, v139
  v_cvt_pk_bf16_f32 v156, v136, v137
  v_cvt_pk_bf16_f32 v157, v138, v139
  v_mfma_f32_32x32x16_bf16 v[48:63], v[204:207], v[148:151], v[48:63]
  buffer_load_dwordx4 v[176:179], v2, s[36:39], s8 offen sc1
  buffer_load_dwordx4 v[180:183], v2, s[36:39], s8 offen offset:1024 sc1
  buffer_load_dwordx4 v[184:187], v3, s[36:39], s8 offen sc1
  buffer_load_dwordx4 v[188:191], v3, s[36:39], s8 offen offset:1024 sc1
  s_add_u32 s8, s8, 245760
  s_cmp_eq_u32 s8, s46
  s_cselect_b32 s8, s11, s8
  v_sub_f32 v140, v140, v9
  v_sub_f32 v141, v141, v9
  v_sub_f32 v142, v142, v9
  v_sub_f32 v143, v143, v9
  v_exp_f32 v140, v140
  v_exp_f32 v141, v141
  v_exp_f32 v142, v142
  v_exp_f32 v143, v143
  v_cvt_pk_bf16_f32 v158, v140, v141
  v_cvt_pk_bf16_f32 v159, v142, v143
  v_mfma_f32_32x32x16_bf16 v[128:143], v[192:195], v[40:43], 0
  v_sub_f32 v112, v112, v10
  v_sub_f32 v113, v113, v10
  v_sub_f32 v114, v114, v10
  v_sub_f32 v115, v115, v10
  v_exp_f32 v112, v112
  v_exp_f32 v113, v113
  v_exp_f32 v114, v114
  v_exp_f32 v115, v115
  v_cvt_pk_bf16_f32 v144, v112, v113
  v_cvt_pk_bf16_f32 v145, v114, v115
  v_mfma_f32_32x32x16_bf16 v[128:143], v[196:199], v[44:47], v[128:143]
  v_sub_f32 v116, v116, v10
  v_sub_f32 v117, v117, v10
  v_sub_f32 v118, v118, v10
  v_sub_f32 v119, v119, v10
  v_exp_f32 v116, v116
  v_exp_f32 v117, v117
  v_exp_f32 v118, v118
  v_exp_f32 v119, v119
  v_cvt_pk_bf16_f32 v146, v116, v117
  v_cvt_pk_bf16_f32 v147, v118, v119
  v_mfma_f32_32x32x16_bf16 v[64:79], v[200:203], v[152:155], v[64:79]
  v_sub_f32 v120, v120, v10
  v_sub_f32 v121, v121, v10
  v_sub_f32 v122, v122, v10
  v_sub_f32 v123, v123, v10
  v_exp_f32 v120, v120
  v_exp_f32 v121, v121
  v_exp_f32 v122, v122
  v_exp_f32 v123, v123
  v_cvt_pk_bf16_f32 v148, v120, v121
  v_cvt_pk_bf16_f32 v149, v122, v123
  v_mfma_f32_32x32x16_bf16 v[64:79], v[204:207], v[156:159], v[64:79]
  v_sub_f32 v124, v124, v10
  v_sub_f32 v125, v125, v10
  v_sub_f32 v126, v126, v10
  v_sub_f32 v127, v127, v10
  v_exp_f32 v124, v124
  v_exp_f32 v125, v125
  v_exp_f32 v126, v126
  v_exp_f32 v127, v127
  v_cvt_pk_bf16_f32 v150, v124, v125
  v_cvt_pk_bf16_f32 v151, v126, v127
  s_waitcnt vmcnt(10)
  v_mfma_f32_32x32x16_bf16 v[112:127], v[208:211], v[16:19], 0
  v_sub_f32 v128, v128, v11
  v_sub_f32 v129, v129, v11
  v_sub_f32 v130, v130, v11
  v_sub_f32 v131, v131, v11
  v_exp_f32 v128, v128
  v_exp_f32 v129, v129
  v_exp_f32 v130, v130
  v_exp_f32 v131, v131
  v_cvt_pk_bf16_f32 v152, v128, v129
  v_cvt_pk_bf16_f32 v153, v130, v131
  v_mfma_f32_32x32x16_bf16 v[112:127], v[212:215], v[20:23], v[112:127]
  v_sub_f32 v132, v132, v11
  v_sub_f32 v133, v133, v11
  v_sub_f32 v134, v134, v11
  v_sub_f32 v135, v135, v11
  v_exp_f32 v132, v132
  v_exp_f32 v133, v133
  v_exp_f32 v134, v134
  v_exp_f32 v135, v135
  v_cvt_pk_bf16_f32 v154, v132, v133
  v_cvt_pk_bf16_f32 v155, v134, v135
  v_mfma_f32_32x32x16_bf16 v[80:95], v[200:203], v[144:147], v[80:95]
  v_sub_f32 v136, v136, v11
  v_sub_f32 v137, v137, v11
  v_sub_f32 v138, v138, v11
  v_sub_f32 v139, v139, v11
  v_exp_f32 v136, v136
  v_exp_f32 v137, v137
  v_exp_f32 v138, v138
  v_exp_f32 v139, v139
  v_cvt_pk_bf16_f32 v156, v136, v137
  v_cvt_pk_bf16_f32 v157, v138, v139
  v_mfma_f32_32x32x16_bf16 v[80:95], v[204:207], v[148:151], v[80:95]
  v_sub_f32 v140, v140, v11
  v_sub_f32 v141, v141, v11
  v_sub_f32 v142, v142, v11
  v_sub_f32 v143, v143, v11
  v_exp_f32 v140, v140
  v_exp_f32 v141, v141
  v_exp_f32 v142, v142
  v_exp_f32 v143, v143
  v_cvt_pk_bf16_f32 v158, v140, v141
  v_cvt_pk_bf16_f32 v159, v142, v143
  v_mfma_f32_32x32x16_bf16 v[128:143], v[208:211], v[24:27], 0
  v_sub_f32 v112, v112, v8
  v_sub_f32 v113, v113, v8
  v_sub_f32 v114, v114, v8
  v_sub_f32 v115, v115, v8
  v_exp_f32 v112, v112
  v_exp_f32 v113, v113
  v_exp_f32 v114, v114
  v_exp_f32 v115, v115
  v_cvt_pk_bf16_f32 v144, v112, v113
  v_cvt_pk_bf16_f32 v145, v114, v115
  v_mfma_f32_32x32x16_bf16 v[128:143], v[212:215], v[28:31], v[128:143]
  v_sub_f32 v116, v116, v8
  v_sub_f32 v117, v117, v8
  v_sub_f32 v118, v118, v8
  v_sub_f32 v119, v119, v8
  v_exp_f32 v116, v116
  v_exp_f32 v117, v117
  v_exp_f32 v118, v118
  v_exp_f32 v119, v119
  v_cvt_pk_bf16_f32 v146, v116, v117
  v_cvt_pk_bf16_f32 v147, v118, v119
  v_mfma_f32_32x32x16_bf16 v[96:111], v[200:203], v[152:155], v[96:111]
  v_sub_f32 v120, v120, v8
  v_sub_f32 v121, v121, v8
  v_sub_f32 v122, v122, v8
  v_sub_f32 v123, v123, v8
  v_exp_f32 v120, v120
  v_exp_f32 v121, v121
  v_exp_f32 v122, v122
  v_exp_f32 v123, v123
  v_cvt_pk_bf16_f32 v148, v120, v121
  v_cvt_pk_bf16_f32 v149, v122, v123
  v_mfma_f32_32x32x16_bf16 v[96:111], v[204:207], v[156:159], v[96:111]
  v_sub_f32 v124, v124, v8
  v_sub_f32 v125, v125, v8
  v_sub_f32 v126, v126, v8
  v_sub_f32 v127, v127, v8
  v_exp_f32 v124, v124
  v_exp_f32 v125, v125
  v_exp_f32 v126, v126
  v_exp_f32 v127, v127
  v_cvt_pk_bf16_f32 v150, v124, v125
  v_cvt_pk_bf16_f32 v151, v126, v127
  v_mfma_f32_32x32x16_bf16 v[112:127], v[208:211], v[32:35], 0
  v_sub_f32 v128, v128, v9
  v_sub_f32 v129, v129, v9
  v_sub_f32 v130, v130, v9
  v_sub_f32 v131, v131, v9
  v_exp_f32 v128, v128
  v_exp_f32 v129, v129
  v_exp_f32 v130, v130
  v_exp_f32 v131, v131
  v_cvt_pk_bf16_f32 v152, v128, v129
  v_cvt_pk_bf16_f32 v153, v130, v131
  v_mfma_f32_32x32x16_bf16 v[112:127], v[212:215], v[36:39], v[112:127]
  v_sub_f32 v132, v132, v9
  v_sub_f32 v133, v133, v9
  v_sub_f32 v134, v134, v9
  v_sub_f32 v135, v135, v9
  v_exp_f32 v132, v132
  v_exp_f32 v133, v133
  v_exp_f32 v134, v134
  v_exp_f32 v135, v135
  v_cvt_pk_bf16_f32 v154, v132, v133
  v_cvt_pk_bf16_f32 v155, v134, v135
  s_waitcnt vmcnt(8)
  v_mfma_f32_32x32x16_bf16 v[48:63], v[216:219], v[144:147], v[48:63]
  v_sub_f32 v136, v136, v9
  v_sub_f32 v137, v137, v9
  v_sub_f32 v138, v138, v9
  v_sub_f32 v139, v139, v9
  v_exp_f32 v136, v136
  v_exp_f32 v137, v137
  v_exp_f32 v138, v138
  v_exp_f32 v139, v139
  v_cvt_pk_bf16_f32 v156, v136, v137
  v_cvt_pk_bf16_f32 v157, v138, v139
  v_mfma_f32_32x32x16_bf16 v[48:63], v[220:223], v[148:151], v[48:63]
  buffer_load_dwordx4 v[192:195], v2, s[36:39], s8 offen sc1
  buffer_load_dwordx4 v[196:199], v2, s[36:39], s8 offen offset:1024 sc1
  buffer_load_dwordx4 v[200:203], v3, s[36:39], s8 offen sc1
  buffer_load_dwordx4 v[204:207], v3, s[36:39], s8 offen offset:1024 sc1
  s_add_u32 s8, s8, 245760
  s_cmp_eq_u32 s8, s46
  s_cselect_b32 s8, s11, s8
  v_sub_f32 v140, v140, v9
  v_sub_f32 v141, v141, v9
  v_sub_f32 v142, v142, v9
  v_sub_f32 v143, v143, v9
  v_exp_f32 v140, v140
  v_exp_f32 v141, v141
  v_exp_f32 v142, v142
  v_exp_f32 v143, v143
  v_cvt_pk_bf16_f32 v158, v140, v141
  v_cvt_pk_bf16_f32 v159, v142, v143
  v_mfma_f32_32x32x16_bf16 v[128:143], v[208:211], v[40:43], 0
  v_sub_f32 v112, v112, v10
  v_sub_f32 v113, v113, v10
  v_sub_f32 v114, v114, v10
  v_sub_f32 v115, v115, v10
  v_exp_f32 v112, v112
  v_exp_f32 v113, v113
  v_exp_f32 v114, v114
  v_exp_f32 v115, v115
  v_cvt_pk_bf16_f32 v144, v112, v113
  v_cvt_pk_bf16_f32 v145, v114, v115
  v_mfma_f32_32x32x16_bf16 v[128:143], v[212:215], v[44:47], v[128:143]
  v_sub_f32 v116, v116, v10
  v_sub_f32 v117, v117, v10
  v_sub_f32 v118, v118, v10
  v_sub_f32 v119, v119, v10
  v_exp_f32 v116, v116
  v_exp_f32 v117, v117
  v_exp_f32 v118, v118
  v_exp_f32 v119, v119
  v_cvt_pk_bf16_f32 v146, v116, v117
  v_cvt_pk_bf16_f32 v147, v118, v119
  v_mfma_f32_32x32x16_bf16 v[64:79], v[216:219], v[152:155], v[64:79]
  v_sub_f32 v120, v120, v10
  v_sub_f32 v121, v121, v10
  v_sub_f32 v122, v122, v10
  v_sub_f32 v123, v123, v10
  v_exp_f32 v120, v120
  v_exp_f32 v121, v121
  v_exp_f32 v122, v122
  v_exp_f32 v123, v123
  v_cvt_pk_bf16_f32 v148, v120, v121
  v_cvt_pk_bf16_f32 v149, v122, v123
  v_mfma_f32_32x32x16_bf16 v[64:79], v[220:223], v[156:159], v[64:79]
  v_sub_f32 v124, v124, v10
  v_sub_f32 v125, v125, v10
  v_sub_f32 v126, v126, v10
  v_sub_f32 v127, v127, v10
  v_exp_f32 v124, v124
  v_exp_f32 v125, v125
  v_exp_f32 v126, v126
  v_exp_f32 v127, v127
  v_cvt_pk_bf16_f32 v150, v124, v125
  v_cvt_pk_bf16_f32 v151, v126, v127
  s_waitcnt vmcnt(10)
  v_mfma_f32_32x32x16_bf16 v[112:127], v[160:163], v[16:19], 0
  v_sub_f32 v128, v128, v11
  v_sub_f32 v129, v129, v11
  v_sub_f32 v130, v130, v11
  v_sub_f32 v131, v131, v11
  v_exp_f32 v128, v128
  v_exp_f32 v129, v129
  v_exp_f32 v130, v130
  v_exp_f32 v131, v131
  v_cvt_pk_bf16_f32 v152, v128, v129
  v_cvt_pk_bf16_f32 v153, v130, v131
  v_mfma_f32_32x32x16_bf16 v[112:127], v[164:167], v[20:23], v[112:127]
  v_sub_f32 v132, v132, v11
  v_sub_f32 v133, v133, v11
  v_sub_f32 v134, v134, v11
  v_sub_f32 v135, v135, v11
  v_exp_f32 v132, v132
  v_exp_f32 v133, v133
  v_exp_f32 v134, v134
  v_exp_f32 v135, v135
  v_cvt_pk_bf16_f32 v154, v132, v133
  v_cvt_pk_bf16_f32 v155, v134, v135
  v_mfma_f32_32x32x16_bf16 v[80:95], v[216:219], v[144:147], v[80:95]
  v_sub_f32 v136, v136, v11
  v_sub_f32 v137, v137, v11
  v_sub_f32 v138, v138, v11
  v_sub_f32 v139, v139, v11
  v_exp_f32 v136, v136
  v_exp_f32 v137, v137
  v_exp_f32 v138, v138
  v_exp_f32 v139, v139
  v_cvt_pk_bf16_f32 v156, v136, v137
  v_cvt_pk_bf16_f32 v157, v138, v139
  v_mfma_f32_32x32x16_bf16 v[80:95], v[220:223], v[148:151], v[80:95]
  v_sub_f32 v140, v140, v11
  v_sub_f32 v141, v141, v11
  v_sub_f32 v142, v142, v11
  v_sub_f32 v143, v143, v11
  v_exp_f32 v140, v140
  v_exp_f32 v141, v141
  v_exp_f32 v142, v142
  v_exp_f32 v143, v143
  v_cvt_pk_bf16_f32 v158, v140, v141
  v_cvt_pk_bf16_f32 v159, v142, v143
  s_sub_u32 s13, s13, 1
  s_cmp_lg_u32 s13, 0
  s_cbranch_scc1 P_LOOP
  s_waitcnt vmcnt(0)
  s_branch P_EPI
P_END:
  s_endpgm
.section .rodata,"a"
.p2align 6
.amdhsa_kernel kp_kernel
  .amdhsa_next_free_vgpr 512
  .amdhsa_next_free_sgpr 102
  .amdhsa_accum_offset 256
  .amdhsa_group_segment_fixed_size 0
  .amdhsa_kernarg_size 72
  .amdhsa_user_sgpr_count 2
  .amdhsa_user_sgpr_kernarg_segment_ptr 1
  .amdhsa_system_sgpr_workgroup_id_x 1
.end_amdhsa_kernel
```
